```python
import torch

def _softmax(x, axis=-1):
    return torch.softmax(x, dim=axis)

def _gelu(x):
    return torch.nn.functional.gelu(x, approximate='tanh')

def _silu(x):
    return torch.nn.functional.silu(x)

def _sigmoid(x):
    return torch.sigmoid(x)

def _layernorm(x, axis=-1, eps=1e-05):
    m = x.mean(dim=axis, keepdim=True)
    v = x.var(dim=axis, keepdim=True, unbiased=False)
    return (x - m) / torch.sqrt(v + eps)

def _scatter_add(tgt, idx, src, axis=0):
    return tgt.clone().index_add_(axis, idx, src)

def _segment_sum(src, seg, n):
    out = torch.zeros((n,) + src.shape[1:], dtype=src.dtype)
    return out.index_add_(0, seg, src)

def _pad(x, pw):
    flat = tuple((v for pair in reversed(pw) for v in pair))
    return torch.nn.functional.pad(x, flat)
kernel_name = 'adaLN_cond__sliding_local_dilated__moe_arch_mod__prompt'

def setup_inputs():

    _w = lambda a: (lambda t: t.to(torch.bfloat16) if t.is_floating_point() else t)(torch.as_tensor(a))

    def _A_setup():
        B, S, D = (1, 2048, 640)
        return {'x': _w((lambda *s: torch.randn(*s, dtype=torch.bfloat16) * 0.05)(B, S, D)), 'wqkv': _w((lambda *s: torch.randn(*s, dtype=torch.bfloat16) * 0.05)(D, 3 * D)), 'wo': _w((lambda *s: torch.randn(*s, dtype=torch.bfloat16) * 0.05)(D, D))}
    _A_in = _A_setup()

    def _B_setup():
        B, S, D, F, C = (1, 2048, 640, 1728, 1)
        return {'x': _w((lambda *s: torch.randn(*s, dtype=torch.bfloat16) * 0.05)(B, S, D)), 'w_r': _w((lambda *s: torch.randn(*s, dtype=torch.bfloat16) * 3.2)(D)), 'w_gate': _w((lambda *s: torch.randn(*s, dtype=torch.bfloat16) * 0.1)(D, F)), 'w_up': _w((lambda *s: torch.randn(*s, dtype=torch.bfloat16) * 0.1)(D, F)), 'w_down': _w((lambda *s: torch.randn(*s, dtype=torch.bfloat16) * 0.1)(F, D))}
    _B_in = _B_setup()
    return {'A_x': _A_in['x'], 'A_wqkv': _A_in['wqkv'], 'A_wo': _A_in['wo'], 'B_x': _B_in['x'], 'B_w_r': _B_in['w_r'], 'B_w_gate': _B_in['w_gate'], 'B_w_up': _B_in['w_up'], 'B_w_down': _B_in['w_down'], 'c': _w((lambda *s: torch.randn(*s, dtype=torch.bfloat16) * 0.1)(1, 640) * 8.0), 'w_mod': _w((lambda *s: torch.randn(*s, dtype=torch.bfloat16) * 0.1)(640, 6 * 640) * 640 ** (-0.5) * 8.0)}

def reference(A_x, A_wqkv, A_wo, B_x, B_w_r, B_w_gate, B_w_up, B_w_down, c, w_mod):

    def _A_ref(x, wqkv, wo):
        B, S, D = x.shape
        H = 32
        Dh = D // H
        W, dil = (8, 2)
        qkv = (lambda x, *d: x.permute(*d))((x @ wqkv).reshape(B, S, 3, H, Dh), 2, 0, 3, 1, 4)
        q, k, v = (qkv[0], qkv[1], qkv[2])
        scale = Dh ** (-0.5)
        pos = torch.arange(S)
        off = torch.arange(W) * dil
        idx = pos[:, None] - off[None, :]
        mask = idx >= 0
        idx_c = torch.where(mask, idx, 0).reshape(-1)
        kg = k[:, :, idx_c, :].reshape(B, H, S, W, Dh)
        vg = v[:, :, idx_c, :].reshape(B, H, S, W, Dh)
        logits = torch.einsum('bhsd,bhswd->bhsw', q, kg) * scale
        logits = torch.where(mask[None, None, :, :], logits, -1000000000.0)
        attn = _softmax(logits, axis=-1)
        o = torch.einsum('bhsw,bhswd->bhsd', attn, vg)
        return (lambda x, *d: x.permute(*d))(o, 0, 2, 1, 3).reshape(B, S, D) @ wo

    def _B_ref(x, w_r, w_gate, w_up, w_down):
        B, S, D = x.shape
        C = 1
        r = x @ w_r
        idx = torch.argsort(-r, axis=-1)[:, :C]
        idx_e = (lambda x, n, axis: torch.repeat_interleave(x, n, dim=axis))(idx.reshape(B, C, 1), D, axis=2)
        x_sel = (lambda x, i, axis: torch.take_along_dim(x, i, dim=axis))(x, idx_e, axis=1)
        g = _silu(x_sel @ w_gate)
        u = x_sel @ w_up
        y = g * u @ w_down
        r_sel = _sigmoid((lambda x, i, axis: torch.take_along_dim(x, i, dim=axis))(r, idx, axis=1))
        y = y * r_sel.reshape(B, C, 1)
        b_off = (torch.arange(B) * S).reshape(B, 1)
        flat_idx = (idx + b_off).reshape(B * C)
        zero = (x * 0.0).reshape(B * S, D)
        upd = _scatter_add(zero, flat_idx, y.reshape(B * C, D), axis=0)
        return x + upd.reshape(B, S, D)
    x = A_x
    mod = (_silu(c) @ w_mod).reshape(c.shape[0], 6, 1, -1)
    sa, ca, ga, sb, cb, gb = (mod[:, 0].clone(), mod[:, 1].clone(), mod[:, 2].clone(), mod[:, 3].clone(), mod[:, 4].clone(), mod[:, 5].clone())
    h = _layernorm(x, axis=-1) * (1 + ca) + sa
    x = x + ga * _A_ref(h, A_wqkv, A_wo)
    h = _layernorm(x, axis=-1) * (1 + cb) + sb
    x = x + gb * _B_ref(h, B_w_r, B_w_gate, B_w_up, B_w_down)
    return x
```

```asm
; @launch grid=(256,1,1) block=(256,1,1) lds=163840
.amdgcn_target "amdgcn-amd-amdhsa--gfx950"
.text
.globl adaLN_cond__sliding_local_dilated__moe_arch_mod__prompt_kernel
.p2align 8
.type adaLN_cond__sliding_local_dilated__moe_arch_mod__prompt_kernel,@function
adaLN_cond__sliding_local_dilated__moe_arch_mod__prompt_kernel:
    s_cmp_ge_u32 s2, 256
    s_cbranch_scc1 L_exit
    s_load_dwordx8 s[64:71], s[0:1], 64
    s_load_dwordx2 s[72:73], s[0:1], 96
    s_load_dwordx16 s[48:63], s[0:1], 0
    s_getpc_b64 s[74:75]
L_pc:
    s_and_b32 s94, s2, 7
    s_lshr_b32 s95, s2, 3
    s_sub_u32 s96, s95, 24
    s_lshl_b32 s96, s96, 13
    v_lshl_add_u32 v2, v0, 7, s96
    v_cmp_gt_u32 vcc, 64, v0
    s_mov_b32 s97, L_code_end-L_pc-4
    v_cmp_gt_u32 s[98:99], s97, v2
    v_lshrrev_b32 v3, 6, v0
    s_and_b64 exec, vcc, s[98:99]
    s_cbranch_execz L_nopf
    global_load_dword v253, v2, s[74:75]
L_nopf:
    s_mov_b64 exec, -1
    v_readfirstlane_b32 s3, v3
    s_and_b32 s96, s94, 3
    s_mov_b32 s85, s2
    v_lshrrev_b32 v6, 3, v0
    v_and_b32 v7, 7, v0
    v_mul_u32_u24 v40, 7680, v6
    v_lshl_add_u32 v40, v7, 4, v40
    v_lshlrev_b32 v44, 1, v0
    s_lshr_b32 s97, s85, 2
    s_min_u32 s97, s97, 59
    s_lshl_b32 s82, s97, 7
    s_mul_i32 s83, s96, 320
    s_mul_i32 s96, s96, 1228800
    s_add_u32 s82, s82, s96
    s_lshl_b32 s78, s3, 10
    s_add_u32 m0, s78, 110592
    s_mov_b32 s22, 0x4b0000
    s_mov_b32 s23, 0x20000
    s_mov_b32 s34, 0x500
    s_mov_b32 s35, 0x20000
    s_waitcnt lgkmcnt(0)
    s_mov_b64 s[32:33], s[64:65]
    s_mov_b64 s[20:21], s[66:67]
    buffer_load_ushort v60, v44, s[32:35], s83 offen
    buffer_load_dwordx4 v40, s[20:23], s82 offen lds
    s_add_u32 m0, m0, 4096
    s_add_u32 s82, s82, 245760
    buffer_load_dwordx4 v40, s[20:23], s82 offen lds
    s_add_u32 m0, m0, 4096
    s_add_u32 s82, s82, 245760
    buffer_load_dwordx4 v40, s[20:23], s82 offen lds
    s_add_u32 m0, m0, 4096
    s_add_u32 s82, s82, 245760
    buffer_load_dwordx4 v40, s[20:23], s82 offen lds
    s_add_u32 m0, m0, 4096
    s_add_u32 s82, s82, 245760
    buffer_load_dwordx4 v40, s[20:23], s82 offen lds
    s_load_dword s6, s[72:73], 0
    v_and_b32 v1, 63, v0
    s_lshr_b32 s96, s94, 0
    s_lshl_b32 s4, s96, 1
    s_lshr_b32 s96, s95, 4
    s_add_u32 s4, s4, s96
    s_and_b32 s5, s95, 15
    s_lshr_b32 s88, s5, 3
    s_and_b32 s87, s5, 7
    s_mov_b64 s[8:9], s[48:49]
    s_mov_b32 s10, 0x280000
    s_mov_b32 s11, 0x20000
    s_lshl_b32 s48, s4, 7
    v_lshrrev_b32 v10, 5, v1
    v_and_b32 v11, 31, v1
    s_lshl_b32 s96, s5, 3
    s_add_u32 s96, s96, s48
    s_lshl_b32 s97, s3, 1
    s_add_u32 s96, s96, s97
    v_add_u32 v62, s96, v10
    v_mul_u32_u24 v53, 1280, v62
    v_lshl_add_u32 v2, v11, 3, v53
    v_lshl_add_u32 v53, v11, 4, v53
    buffer_load_dwordx4 v[160:163], v53, s[8:11], 0 offen offset:0
    buffer_load_dwordx4 v[164:167], v53, s[8:11], 0 offen offset:512
    buffer_load_dwordx2 v[168:169], v2, s[8:11], 0 offen offset:1024
    v_mul_u32_u24 v3, 13, v1
    v_lshrrev_b32 v3, 6, v3
    v_mul_u32_u24 v4, 5, v3
    v_sub_u32 v4, v1, v4
    s_mul_i32 s96, s3, 1280
    s_mul_i32 s97, s5, 80
    s_add_u32 s96, s96, s97
    s_lshl_b32 s97, s87, 1
    s_add_u32 s97, s97, s88
    s_mul_i32 s97, s97, 80
    s_movk_i32 s98, 3840
    s_mov_b32 s18, 2457600
    s_cmp_eq_u32 s3, 3
    s_cselect_b32 s98, 1280, s98
    s_cselect_b32 s96, s97, s96
    s_cselect_b64 s[16:17], s[52:53], s[50:51]
    s_cselect_b32 s18, 819200, s18
    s_cselect_b32 s13, 0xffff, -1
    s_mov_b32 s19, 0x20000
    s_mul_i32 s97, s98, 40
    s_mul_i32 s97, s97, s4
    s_add_u32 s96, s96, s97
    s_mul_i32 s99, s98, 10
    v_mul_lo_u32 v3, v3, s98
    v_lshl_add_u32 v55, v4, 4, v3
    s_mov_b32 s86, s96
    s_mov_b32 s89, s99
    v_lshlrev_b32 v62, 4, v62
    v_and_b32 v14, 15, v1
    v_lshrrev_b32 v15, 4, v1
    v_xor_b32 v19, v14, v15
    v_lshlrev_b32 v19, 4, v19
    v_mul_u32_u24 v2, 1280, v15
    v_add_u32 v236, v2, v19
    v_add_u32 v3, 4096, v2
    v_xad_u32 v237, v19, 64, v3
    v_add_u32 v3, 8192, v2
    s_movk_i32 s96, 128
    v_xad_u32 v238, v19, s96, v3
    v_add_u32 v3, 12288, v2
    s_movk_i32 s96, 192
    v_xad_u32 v239, v19, s96, v3
    s_lshl_b32 s96, s3, 5
    s_add_u32 s96, s96, s48
    s_mul_i32 s79, s96, 1280
    s_lshl_b32 s96, s3, 2
    s_add_u32 s96, s96, s48
    s_sub_u32 s96, s96, 16
    v_add_u32 v3, s96, v15
    v_max_i32 v3, 0, v3
    v_mul_u32_u24 v3, 1280, v3
    s_lshl_b32 s96, s3, 6
    v_xad_u32 v240, v19, s96, v3
    s_mul_i32 s76, s5, 5
    s_lshr_b32 s76, s76, 4
    s_lshl_b32 s77, s76, 8
    s_lshl_b32 s49, s3, 13
    s_mov_b64 s[24:25], s[72:73]
    s_mov_b32 s26, 0xc00000
    s_mov_b32 s27, 0x20000
    s_mov_b64 s[36:37], s[56:57]
    s_mov_b32 s38, 0x500
    s_mov_b32 s39, 0x20000
    s_mov_b64 s[28:29], s[68:69]
    s_mov_b32 s30, 0x280000
    s_mov_b32 s31, 0x20000
    s_mov_b64 s[40:41], s[58:59]
    s_mov_b32 s42, 0x21c000
    s_mov_b32 s43, 0x20000
    s_mov_b64 s[44:45], s[60:61]
    s_mov_b32 s46, 0x21c000
    s_mov_b32 s47, 0x20000
    s_mov_b64 s[32:33], s[62:63]
    s_mov_b32 s34, 2211840
    s_mov_b32 s84, 0xffff0000
    s_mov_b32 s94, s87
    s_lshl_b32 s95, s4, 1
    s_add_u32 s95, s95, s88
    s_lshl_b32 s93, s95, 3
    s_add_u32 s93, s93, s94
    s_mov_b32 s70, 0xd0000
    s_mov_b32 s65, 0x8000
    v_lshrrev_b32 v2, 2, v14
    v_and_b32 v3, 3, v14
    v_lshlrev_b32 v3, 3, v3
    s_lshl_b32 s52, s3, 5
    s_add_u32 s52, s52, 110592
    v_lshl_add_u32 v4, v15, 3, v2
    v_lshlrev_b32 v4, 7, v4
    v_add3_u32 v42, v4, v3, s52
    s_mov_b32 s52, 160512
    v_lshl_add_u32 v41, v15, 4, s52
    v_add_u32 v44, s52, v44
    v_lshlrev_b32 v43, 3, v14
    s_lshl_b32 s83, s85, 9
    s_lshl_b32 s52, s3, 7
    s_add_u32 s83, s83, s52
    s_add_u32 s83, s83, 0xd0000
    v_mov_b32 v56, -1
    v_mov_b32 v57, -1
    v_mov_b32 v58, -1
    v_mov_b32 v59, -1
    s_lshl_b32 s52, s3, 2
    v_add_u32 v4, s52, v15
    v_mul_u32_u24 v5, 13, v4
    v_lshrrev_b32 v5, 6, v5
    v_mul_u32_u24 v6, 5, v5
    v_sub_u32 v6, v4, v6
    v_mul_u32_u24 v2, 80, v2
    s_mov_b32 s52, 147456
    v_add3_u32 v2, v2, v3, s52
    v_mul_u32_u24 v4, 640, v4
    v_add_u32 v45, v4, v2
    v_mul_u32_u24 v4, 320, v6
    v_lshl_add_u32 v4, v5, 5, v4
    v_add_u32 v46, v4, v2
    v_mul_u32_u24 v7, 40, v5
    v_add_u32 v7, v7, v14
    v_lshrrev_b32 v8, 4, v7
    v_mul_u32_u24 v8, 768, v8
    v_lshl_add_u32 v8, v7, 4, v8
    s_mul_i32 s53, s4, 5
    v_add_u32 v9, s53, v6
    v_lshl_add_u32 v8, v9, 8, v8
    v_lshrrev_b32 v4, 2, v9
    v_mul_u32_u24 v4, 7168, v4
    v_add_u32 v47, v4, v8
    s_mul_i32 s75, s5, 167936
    s_add_u32 s75, s75, 0x800000
    v_lshlrev_b32 v7, 3, v7
    v_lshl_add_u32 v7, v6, 10, v7
    v_add_u32 v51, s52, v7
    v_and_b32 v4, 7, v14
    v_lshl_add_u32 v4, v9, 3, v4
    v_cmp_gt_u32 vcc, 8, v14
    v_add_u32 v7, 640, v4
    s_mov_b32 s12, -1
    v_cndmask_b32 v4, v4, v7, vcc
    v_cndmask_b32 v50, 0, 1.0, vcc
    s_and_b64 s[14:15], s[12:13], vcc
    v_lshrrev_b32 v7, 6, v4
    v_mul_u32_u24 v7, 1536, v7
    v_lshl_add_u32 v49, v4, 3, v7
    v_lshl_add_u32 v4, v5, 4, v14
    v_mul_u32_u24 v7, 1280, v6
    v_lshl_add_u32 v7, v4, 4, v7
    s_mul_i32 s53, s4, -3840
    s_add_u32 s53, s53, 76800
    v_cmp_eq_u32 vcc, 4, v6
    v_add_u32 v8, s53, v7
    v_mov_b32 v9, 0x7ff00000
    v_cndmask_b32 v7, v7, v8, vcc
    v_cmp_gt_u32 vcc, 40, v4
    s_mul_i32 s53, s87, 102400
    s_mul_i32 s54, s4, 5120
    v_cndmask_b32 v48, v9, v7, vcc
    s_add_u32 s60, s53, 0x700000
    s_add_u32 s53, s60, s54
    s_mul_i32 s54, s88, 640
    s_add_u32 s81, s53, s54
    s_lshl_b32 s52, s5, 11
    s_add_u32 s51, s52, 0x3c0000
    s_lshl_b32 s52, s4, 7
    s_add_u32 s50, s52, s51
    v_lshlrev_b32 v52, 7, v14
    v_lshlrev_b32 v26, 4, v1
    v_lshlrev_b32 v2, 8, v14
    v_add_u32 v2, 73728, v2
    v_add_u32 v20, v2, v19
    v_xad_u32 v21, v19, 64, v2
    s_movk_i32 s52, 128
    v_xad_u32 v22, v19, s52, v2
    s_movk_i32 s52, 192
    v_xad_u32 v23, v19, s52, v2
    s_cmp_eq_u32 s3, 3
    s_cselect_b32 s52, 0x37f, -1
    v_and_b32 v29, s52, v26
    s_lshl_b32 s52, s3, 11
    s_add_u32 s80, s75, s52
    s_lshl_b32 s52, s76, 15
    s_add_u32 s72, s80, s52
    s_add_u32 s73, s80, 163840
    s_waitcnt vmcnt(8)
    v_lshlrev_b32 v60, 16, v60
    v_mul_f32 v2, 0xbfb8aa3b, v60
    v_exp_f32 v2, v2
    s_nop 0
    v_add_f32 v2, 1.0, v2
    v_rcp_f32 v2, v2
    s_nop 0
    v_mul_f32 v2, v2, v60
    v_cvt_pk_bf16_f32 v2, v2, v2
    ds_write_b16 v44, v2
    s_waitcnt lgkmcnt(0)
    s_add_u32 s6, s6, 0x9e3779b9
    v_mov_b32 v39, s6
    s_mul_i32 s97, s3, 3200
    s_add_u32 m0, s97, 147456
    s_mov_b32 exec_hi, 0x3ffff
    buffer_load_dwordx4 v55, s[16:19], s86 offen lds
    s_add_u32 m0, m0, 800
    s_add_u32 s86, s86, s89
    buffer_load_dwordx4 v55, s[16:19], s86 offen lds
    s_add_u32 m0, m0, 800
    s_add_u32 s86, s86, s89
    buffer_load_dwordx4 v55, s[16:19], s86 offen lds
    s_add_u32 m0, m0, 800
    s_add_u32 s86, s86, s89
    buffer_load_dwordx4 v55, s[16:19], s86 offen lds
    s_mov_b32 exec_hi, -1
    s_waitcnt vmcnt(7)
    s_barrier
    ds_read_b128 v[112:115], v41 offset:0
    ds_read_b64_tr_b16 v[132:133], v42 offset:0
    ds_read_b64_tr_b16 v[134:135], v42 offset:512
    ds_read_b128 v[116:119], v41 offset:64
    ds_read_b64_tr_b16 v[136:137], v42 offset:4096
    ds_read_b64_tr_b16 v[138:139], v42 offset:4608
    ds_read_b128 v[120:123], v41 offset:128
    ds_read_b64_tr_b16 v[140:141], v42 offset:8192
    ds_read_b64_tr_b16 v[142:143], v42 offset:8704
    ds_read_b128 v[124:127], v41 offset:192
    ds_read_b64_tr_b16 v[144:145], v42 offset:12288
    ds_read_b64_tr_b16 v[146:147], v42 offset:12800
    ds_read_b128 v[128:131], v41 offset:256
    ds_read_b64_tr_b16 v[148:149], v42 offset:16384
    ds_read_b64_tr_b16 v[150:151], v42 offset:16896
    s_waitcnt lgkmcnt(12)
    v_mfma_f32_16x16x32_bf16 v[152:155], v[112:115], v[132:135], 0
    s_waitcnt lgkmcnt(9)
    v_mfma_f32_16x16x32_bf16 v[152:155], v[116:119], v[136:139], v[152:155]
    s_waitcnt lgkmcnt(6)
    v_mfma_f32_16x16x32_bf16 v[152:155], v[120:123], v[140:143], v[152:155]
    s_waitcnt lgkmcnt(3)
    v_mfma_f32_16x16x32_bf16 v[152:155], v[124:127], v[144:147], v[152:155]
    s_waitcnt lgkmcnt(0)
    v_mfma_f32_16x16x32_bf16 v[152:155], v[128:131], v[148:151], v[152:155]
    s_mov_b64 exec, 0xffff
    s_nop 6
    v_mov_b32 v153, s6
    buffer_store_dwordx2 v[152:153], v43, s[24:27], s83 offen sc0 sc1
    s_mov_b64 exec, -1
    s_add_u32 m0, s49, 77824
    s_add_u32 s7, s79, s77
    buffer_load_dwordx4 v236, s[8:11], s7 offen offset:0 lds
    buffer_load_dwordx4 v237, s[8:11], s7 offen offset:1024 lds
    buffer_load_dwordx4 v238, s[8:11], s7 offen offset:2048 lds
    buffer_load_dwordx4 v239, s[8:11], s7 offen offset:3072 lds
    s_add_u32 m0, m0, 4096
    s_add_u32 s7, s7, 20480
    buffer_load_dwordx4 v236, s[8:11], s7 offen offset:0 lds
    buffer_load_dwordx4 v237, s[8:11], s7 offen offset:1024 lds
    buffer_load_dwordx4 v238, s[8:11], s7 offen offset:2048 lds
    buffer_load_dwordx4 v239, s[8:11], s7 offen offset:3072 lds
    s_add_u32 m0, s78, 73728
    s_nop 0
    buffer_load_dwordx4 v240, s[8:11], s77 offen lds
    s_add_u32 s77, s77, 256
    s_cmp_eq_u32 s77, 1280
    s_cselect_b32 s77, 0, s77
    s_lshl_b32 s86, s95, 2
    s_add_u32 s86, s86, s3
    s_lshl_b32 s53, s95, 7
    s_lshl_b32 s52, s87, 12
    s_add_u32 s69, s52, 0xc0000
    s_add_u32 s68, s69, s53
    v_mul_u32_u24 v54, 0x30000, v15
    v_lshl_add_u32 v54, v14, 4, v54
    s_mul_i32 s52, s86, 1280
    s_mul_i32 s53, s87, 160
    s_add_u32 s52, s52, s53
    s_add_u32 s92, s52, 0x60000
    s_lshl_b32 s52, s5, 4
    s_add_u32 s52, s52, s4
    s_lshl_b32 s52, s52, 10
    s_add_u32 s74, s52, 0x380000
    v_lshrrev_b32 v4, 3, v0
    v_and_b32 v5, 7, v0
    s_mul_i32 s56, s94, 80
    v_add_u32 v6, s56, v4
    v_mul_u32_u24 v6, 3456, v6
    v_lshl_add_u32 v6, v5, 4, v6
    s_lshl_b32 s56, s95, 7
    s_mul_i32 s89, s95, 81920
    s_mul_i32 s55, s94, 160
    s_add_u32 s89, s89, s55
    s_cmp_ge_u32 s93, 216
    s_cselect_b32 s56, 0x7ff00000, s56
    s_cselect_b32 s89, 0, s89
    v_add_u32 v31, s56, v6
    v_mov_b32 v7, 0x7ff00000
    v_cmp_gt_u32 vcc, 16, v4
    s_mov_b32 s16, 110592
    s_mov_b32 s17, 221184
    v_cndmask_b32 v32, v7, v31, vcc
    s_waitcnt vmcnt(10)
    s_barrier
    ds_read_b64_tr_b16 v[76:77], v46 offset:9600
    ds_read_b64_tr_b16 v[78:79], v46 offset:11200
    ds_read_b64_tr_b16 v[64:65], v45 offset:0
    ds_read_b64_tr_b16 v[66:67], v45 offset:320
    ds_read_b64_tr_b16 v[68:69], v45 offset:32
    ds_read_b64_tr_b16 v[70:71], v45 offset:352
    ds_read_b64_tr_b16 v[72:73], v45 offset:64
    ds_read_b64_tr_b16 v[74:75], v45 offset:384
    s_waitcnt lgkmcnt(6)
    buffer_store_dwordx4 v[76:79], v48, s[24:27], s81 offen sc0 sc1
    buffer_load_dwordx2 v[104:105], v49, s[24:27], s70 offen offset:0 sc1
    buffer_load_dwordx2 v[106:107], v49, s[24:27], s70 offen offset:512 sc1
    buffer_load_dwordx2 v[108:109], v49, s[24:27], s70 offen offset:1024 sc1
    buffer_load_dwordx2 v[110:111], v49, s[24:27], s70 offen offset:1536 sc1
    s_waitcnt lgkmcnt(5)
    v_lshlrev_b32 v80, 16, v64
    v_and_b32 v81, s84, v64
    v_lshlrev_b32 v82, 16, v65
    v_and_b32 v83, s84, v65
    s_waitcnt lgkmcnt(4)
    v_lshlrev_b32 v84, 16, v66
    v_and_b32 v85, s84, v66
    v_lshlrev_b32 v86, 16, v67
    v_and_b32 v87, s84, v67
    s_waitcnt lgkmcnt(3)
    v_lshlrev_b32 v88, 16, v68
    v_and_b32 v89, s84, v68
    v_lshlrev_b32 v90, 16, v69
    v_and_b32 v91, s84, v69
    s_waitcnt lgkmcnt(2)
    v_lshlrev_b32 v92, 16, v70
    v_and_b32 v93, s84, v70
    v_lshlrev_b32 v94, 16, v71
    v_and_b32 v95, s84, v71
    s_waitcnt lgkmcnt(1)
    v_lshlrev_b32 v96, 16, v72
    v_and_b32 v97, s84, v72
    v_lshlrev_b32 v98, 16, v73
    v_and_b32 v99, s84, v73
    s_waitcnt lgkmcnt(0)
    v_lshlrev_b32 v100, 16, v74
    v_and_b32 v101, s84, v74
    v_lshlrev_b32 v102, 16, v75
    v_and_b32 v103, s84, v75
    s_barrier
    s_waitcnt vmcnt(3)
    v_cmp_ne_u32 vcc, s6, v105
    s_waitcnt vmcnt(2)
    v_cmp_ne_u32 s[98:99], s6, v107
    s_nop 0
    s_or_b64 vcc, vcc, s[98:99]
    s_waitcnt vmcnt(1)
    v_cmp_ne_u32 s[98:99], s6, v109
    s_nop 0
    s_or_b64 vcc, vcc, s[98:99]
    s_waitcnt vmcnt(0)
    v_cmp_ne_u32 s[98:99], s6, v111
    s_nop 0
    s_or_b64 vcc, vcc, s[98:99]
    s_nop 4
    s_cbranch_vccz L_done_2
    s_mov_b32 s90, 0
L_poll_1:
    s_nop 1
    buffer_load_dwordx2 v[104:105], v49, s[24:27], s70 offen offset:0 sc1
    buffer_load_dwordx2 v[106:107], v49, s[24:27], s70 offen offset:512 sc1
    buffer_load_dwordx2 v[108:109], v49, s[24:27], s70 offen offset:1024 sc1
    buffer_load_dwordx2 v[110:111], v49, s[24:27], s70 offen offset:1536 sc1
    s_waitcnt vmcnt(0)
    v_cmp_ne_u32 vcc, s6, v105
    v_cmp_ne_u32 s[98:99], s6, v107
    s_nop 0
    s_or_b64 vcc, vcc, s[98:99]
    v_cmp_ne_u32 s[98:99], s6, v109
    s_nop 0
    s_or_b64 vcc, vcc, s[98:99]
    v_cmp_ne_u32 s[98:99], s6, v111
    s_nop 0
    s_or_b64 vcc, vcc, s[98:99]
    s_nop 4
    s_cbranch_vccz L_done_2
    s_add_u32 s90, s90, 1
    s_cmp_lt_u32 s90, 40000
    s_cbranch_scc1 L_poll_1
L_done_2:
    s_nop 1
    v_add_f32 v104, v104, v106
    v_add_f32 v108, v108, v110
    v_add_f32 v104, v104, v108
    v_cvt_pk_bf16_f32 v104, 0, v104
    v_add_f32 v104, v104, v50
    v_cvt_pk_bf16_f32 v104, 0, v104
    s_nop 1
    v_mul_f32_dpp v112, v104, v80 row_newbcast:0 row_mask:0xf bank_mask:0xf
    v_mul_f32_dpp v113, v104, v81 row_newbcast:1 row_mask:0xf bank_mask:0xf
    v_mul_f32_dpp v114, v104, v82 row_newbcast:2 row_mask:0xf bank_mask:0xf
    v_mul_f32_dpp v115, v104, v83 row_newbcast:3 row_mask:0xf bank_mask:0xf
    v_mul_f32_dpp v116, v104, v84 row_newbcast:4 row_mask:0xf bank_mask:0xf
    v_mul_f32_dpp v117, v104, v85 row_newbcast:5 row_mask:0xf bank_mask:0xf
    v_mul_f32_dpp v118, v104, v86 row_newbcast:6 row_mask:0xf bank_mask:0xf
    v_mul_f32_dpp v119, v104, v87 row_newbcast:7 row_mask:0xf bank_mask:0xf
    v_cvt_pk_bf16_f32 v64, v112, v113
    v_cvt_pk_bf16_f32 v65, v114, v115
    v_cvt_pk_bf16_f32 v66, v116, v117
    v_cvt_pk_bf16_f32 v67, v118, v119
    s_mov_b64 exec, s[12:13]
    buffer_store_dwordx4 v[64:67], v47, s[24:27], s75 offen offset:0 sc0 sc1
    s_mov_b64 exec, -1
    v_mul_f32_dpp v120, v104, v88 row_newbcast:0 row_mask:0xf bank_mask:0xf
    v_mul_f32_dpp v121, v104, v89 row_newbcast:1 row_mask:0xf bank_mask:0xf
    v_mul_f32_dpp v122, v104, v90 row_newbcast:2 row_mask:0xf bank_mask:0xf
    v_mul_f32_dpp v123, v104, v91 row_newbcast:3 row_mask:0xf bank_mask:0xf
    v_mul_f32_dpp v124, v104, v92 row_newbcast:4 row_mask:0xf bank_mask:0xf
    v_mul_f32_dpp v125, v104, v93 row_newbcast:5 row_mask:0xf bank_mask:0xf
    v_mul_f32_dpp v126, v104, v94 row_newbcast:6 row_mask:0xf bank_mask:0xf
    v_mul_f32_dpp v127, v104, v95 row_newbcast:7 row_mask:0xf bank_mask:0xf
    v_cvt_pk_bf16_f32 v68, v120, v121
    v_cvt_pk_bf16_f32 v69, v122, v123
    v_cvt_pk_bf16_f32 v70, v124, v125
    v_cvt_pk_bf16_f32 v71, v126, v127
    s_mov_b64 exec, s[12:13]
    buffer_store_dwordx4 v[68:71], v47, s[24:27], s75 offen offset:1024 sc0 sc1
    s_mov_b64 exec, -1
    v_mul_f32_dpp v128, v104, v96 row_newbcast:0 row_mask:0xf bank_mask:0xf
    v_mul_f32_dpp v129, v104, v97 row_newbcast:1 row_mask:0xf bank_mask:0xf
    v_mul_f32_dpp v130, v104, v98 row_newbcast:2 row_mask:0xf bank_mask:0xf
    v_mul_f32_dpp v131, v104, v99 row_newbcast:3 row_mask:0xf bank_mask:0xf
    v_mul_f32_dpp v132, v104, v100 row_newbcast:4 row_mask:0xf bank_mask:0xf
    v_mul_f32_dpp v133, v104, v101 row_newbcast:5 row_mask:0xf bank_mask:0xf
    v_mul_f32_dpp v134, v104, v102 row_newbcast:6 row_mask:0xf bank_mask:0xf
    v_mul_f32_dpp v135, v104, v103 row_newbcast:7 row_mask:0xf bank_mask:0xf
    v_cvt_pk_bf16_f32 v72, v128, v129
    v_cvt_pk_bf16_f32 v73, v130, v131
    v_cvt_pk_bf16_f32 v74, v132, v133
    v_cvt_pk_bf16_f32 v75, v134, v135
    s_mov_b64 exec, s[14:15]
    buffer_store_dwordx4 v[72:75], v47, s[24:27], s75 offen offset:2048 sc0 sc1
    s_mov_b64 exec, -1
    s_add_u32 m0, s49, 4096
    s_add_u32 s7, s79, s77
    buffer_load_dwordx4 v236, s[8:11], s7 offen offset:0 lds
    buffer_load_dwordx4 v237, s[8:11], s7 offen offset:1024 lds
    buffer_load_dwordx4 v238, s[8:11], s7 offen offset:2048 lds
    buffer_load_dwordx4 v239, s[8:11], s7 offen offset:3072 lds
    s_add_u32 m0, m0, 4096
    s_add_u32 s7, s7, 20480
    buffer_load_dwordx4 v236, s[8:11], s7 offen offset:0 lds
    buffer_load_dwordx4 v237, s[8:11], s7 offen offset:1024 lds
    buffer_load_dwordx4 v238, s[8:11], s7 offen offset:2048 lds
    buffer_load_dwordx4 v239, s[8:11], s7 offen offset:3072 lds
    s_add_u32 m0, s78, 0
    s_nop 0
    buffer_load_dwordx4 v240, s[8:11], s77 offen lds
    s_add_u32 s77, s77, 256
    s_cmp_eq_u32 s77, 1280
    s_cselect_b32 s77, 0, s77
    s_mov_b32 s52, 0x3f803f80
    v_dot2_f32_bf16 v172, v64, s52, 0
    v_dot2_f32_bf16 v174, v68, s52, 0
    v_dot2_f32_bf16 v176, v72, s52, 0
    v_mul_f32_dpp v173, v104, v80 row_newbcast:8 row_mask:0xf bank_mask:0xf
    v_mul_f32_dpp v175, v104, v88 row_newbcast:8 row_mask:0xf bank_mask:0xf
    v_mul_f32_dpp v177, v104, v96 row_newbcast:8 row_mask:0xf bank_mask:0xf
    v_fmac_f32_dpp v173, v104, v81 row_newbcast:9 row_mask:0xf bank_mask:0xf
    v_fmac_f32_dpp v175, v104, v89 row_newbcast:9 row_mask:0xf bank_mask:0xf
    v_fmac_f32_dpp v177, v104, v97 row_newbcast:9 row_mask:0xf bank_mask:0xf
    v_dot2_f32_bf16 v172, v65, s52, v172
    v_dot2_f32_bf16 v174, v69, s52, v174
    v_dot2_f32_bf16 v176, v73, s52, v176
    v_fmac_f32_dpp v173, v104, v82 row_newbcast:10 row_mask:0xf bank_mask:0xf
    v_fmac_f32_dpp v175, v104, v90 row_newbcast:10 row_mask:0xf bank_mask:0xf
    v_fmac_f32_dpp v177, v104, v98 row_newbcast:10 row_mask:0xf bank_mask:0xf
    v_fmac_f32_dpp v173, v104, v83 row_newbcast:11 row_mask:0xf bank_mask:0xf
    v_fmac_f32_dpp v175, v104, v91 row_newbcast:11 row_mask:0xf bank_mask:0xf
    v_fmac_f32_dpp v177, v104, v99 row_newbcast:11 row_mask:0xf bank_mask:0xf
    v_dot2_f32_bf16 v172, v66, s52, v172
    v_dot2_f32_bf16 v174, v70, s52, v174
    v_dot2_f32_bf16 v176, v74, s52, v176
    v_fmac_f32_dpp v173, v104, v84 row_newbcast:12 row_mask:0xf bank_mask:0xf
    v_fmac_f32_dpp v175, v104, v92 row_newbcast:12 row_mask:0xf bank_mask:0xf
    v_fmac_f32_dpp v177, v104, v100 row_newbcast:12 row_mask:0xf bank_mask:0xf
    v_fmac_f32_dpp v173, v104, v85 row_newbcast:13 row_mask:0xf bank_mask:0xf
    v_fmac_f32_dpp v175, v104, v93 row_newbcast:13 row_mask:0xf bank_mask:0xf
    v_fmac_f32_dpp v177, v104, v101 row_newbcast:13 row_mask:0xf bank_mask:0xf
    v_dot2_f32_bf16 v172, v67, s52, v172
    v_dot2_f32_bf16 v174, v71, s52, v174
    v_dot2_f32_bf16 v176, v75, s52, v176
    v_fmac_f32_dpp v173, v104, v86 row_newbcast:14 row_mask:0xf bank_mask:0xf
    v_fmac_f32_dpp v175, v104, v94 row_newbcast:14 row_mask:0xf bank_mask:0xf
    v_fmac_f32_dpp v177, v104, v102 row_newbcast:14 row_mask:0xf bank_mask:0xf
    v_fmac_f32_dpp v173, v104, v87 row_newbcast:15 row_mask:0xf bank_mask:0xf
    v_fmac_f32_dpp v175, v104, v95 row_newbcast:15 row_mask:0xf bank_mask:0xf
    v_fmac_f32_dpp v177, v104, v103 row_newbcast:15 row_mask:0xf bank_mask:0xf
    s_mov_b64 exec, s[12:13]
    ds_write_b64 v51, v[172:173] offset:0
    ds_write_b64 v51, v[174:175] offset:128
    s_mov_b64 exec, s[14:15]
    ds_write_b64 v51, v[176:177] offset:256
    s_mov_b64 exec, -1
    s_mov_b32 s52, 0x3f803f80
    v_dot2_f32_bf16 v170, v160, s52, 0
    v_dot2_f32_bf16 v171, v160, v160, 0
    v_dot2_f32_bf16 v170, v161, s52, v170
    v_dot2_f32_bf16 v171, v161, v161, v171
    v_dot2_f32_bf16 v170, v162, s52, v170
    v_dot2_f32_bf16 v171, v162, v162, v171
    v_dot2_f32_bf16 v170, v163, s52, v170
    v_dot2_f32_bf16 v171, v163, v163, v171
    v_dot2_f32_bf16 v170, v164, s52, v170
    v_dot2_f32_bf16 v171, v164, v164, v171
    v_dot2_f32_bf16 v170, v165, s52, v170
    v_dot2_f32_bf16 v171, v165, v165, v171
    v_dot2_f32_bf16 v170, v166, s52, v170
    v_dot2_f32_bf16 v171, v166, v166, v171
    v_dot2_f32_bf16 v170, v167, s52, v170
    v_dot2_f32_bf16 v171, v167, v167, v171
    v_dot2_f32_bf16 v170, v168, s52, v170
    v_dot2_f32_bf16 v171, v168, v168, v171
    v_dot2_f32_bf16 v170, v169, s52, v170
    v_dot2_f32_bf16 v171, v169, v169, v171
    s_nop 1
    v_add_f32_dpp v170, v170, v170 quad_perm:[1,0,3,2] row_mask:0xf bank_mask:0xf
    v_add_f32_dpp v171, v171, v171 quad_perm:[1,0,3,2] row_mask:0xf bank_mask:0xf
    s_nop 0
    v_add_f32_dpp v170, v170, v170 quad_perm:[2,3,0,1] row_mask:0xf bank_mask:0xf
    v_add_f32_dpp v171, v171, v171 quad_perm:[2,3,0,1] row_mask:0xf bank_mask:0xf
    s_nop 0
    v_add_f32_dpp v170, v170, v170 row_ror:4 row_mask:0xf bank_mask:0xf
    v_add_f32_dpp v171, v171, v171 row_ror:4 row_mask:0xf bank_mask:0xf
    s_nop 0
    v_add_f32_dpp v170, v170, v170 row_ror:8 row_mask:0xf bank_mask:0xf
    v_add_f32_dpp v171, v171, v171 row_ror:8 row_mask:0xf bank_mask:0xf
    v_mov_b32 v160, v170
    v_mov_b32 v161, v171
    s_nop 0
    v_permlane16_swap_b32 v170, v160
    v_permlane16_swap_b32 v171, v161
    v_add_f32 v170, v170, v160
    v_add_f32 v171, v171, v161
    v_mul_f32 v36, 0xbacccccd, v170
    v_mov_b32 v38, 0x3727c5ac
    v_fmac_f32 v38, 0x3acccccd, v171
    v_fma_f32 v38, -v36, v36, v38
    v_max_f32 v38, 0x3727c5ac, v38
    v_rsq_f32 v38, v38
    s_getreg_b32 s88, hwreg(HW_REG_XCC_ID, 0, 4)
    v_mul_f32 v36, v36, v38
    v_mov_b32 v37, s88
    s_mov_b32 exec_lo, 1
    s_mov_b32 exec_hi, 1
    buffer_store_dwordx4 v[36:39], v62, s[24:27], s65 offen sc0 sc1
    s_mov_b64 exec, -1
    s_waitcnt vmcnt(10)
    s_waitcnt lgkmcnt(0)
    s_barrier
    s_cmp_lg_u32 s3, 0
    s_cbranch_scc1 L_skip_3
    s_mov_b64 exec, 1
    buffer_store_dword v39, off, s[24:27], s50 sc0 sc1
    s_mov_b64 exec, -1
L_skip_3:
    s_nop 1
    s_cmp_lg_u32 s3, 1
    s_cbranch_scc1 L_skip_4
    v_lshlrev_b32 v3, 8, v15
    v_lshl_add_u32 v3, v14, 3, v3
    v_add_u32 v3, 147456, v3
    ds_read_b64 v[112:113], v3 offset:0
    ds_read_b64 v[114:115], v3 offset:128
    ds_read_b64 v[116:117], v3 offset:1024
    ds_read_b64 v[118:119], v3 offset:1152
    ds_read_b64 v[120:121], v3 offset:2048
    ds_read_b64 v[122:123], v3 offset:2176
    ds_read_b64 v[124:125], v3 offset:3072
    ds_read_b64 v[126:127], v3 offset:3200
    ds_read_b64 v[128:129], v3 offset:4096
    ds_read_b64 v[130:131], v3 offset:4224
    s_waitcnt lgkmcnt(7)
    v_pk_add_f32 v[112:113], v[112:113], v[116:117]
    s_waitcnt lgkmcnt(6)
    v_pk_add_f32 v[114:115], v[114:115], v[118:119]
    s_waitcnt lgkmcnt(3)
    v_pk_add_f32 v[120:121], v[120:121], v[124:125]
    s_waitcnt lgkmcnt(2)
    v_pk_add_f32 v[122:123], v[122:123], v[126:127]
    s_waitcnt lgkmcnt(1)
    v_pk_add_f32 v[112:113], v[112:113], v[128:129]
    s_waitcnt lgkmcnt(0)
    v_pk_add_f32 v[114:115], v[114:115], v[130:131]
    v_pk_add_f32 v[112:113], v[112:113], v[120:121]
    v_pk_add_f32 v[114:115], v[114:115], v[122:123]
    buffer_store_dwordx4 v[112:115], v26, s[24:27], s74 offen sc0 sc1
L_skip_4:
    s_nop 1
    s_add_u32 m0, s49, 40960
    s_add_u32 s7, s79, s77
    buffer_load_dwordx4 v236, s[8:11], s7 offen offset:0 lds
    buffer_load_dwordx4 v237, s[8:11], s7 offen offset:1024 lds
    buffer_load_dwordx4 v238, s[8:11], s7 offen offset:2048 lds
    buffer_load_dwordx4 v239, s[8:11], s7 offen offset:3072 lds
    s_add_u32 m0, m0, 4096
    s_add_u32 s7, s7, 20480
    buffer_load_dwordx4 v236, s[8:11], s7 offen offset:0 lds
    buffer_load_dwordx4 v237, s[8:11], s7 offen offset:1024 lds
    buffer_load_dwordx4 v238, s[8:11], s7 offen offset:2048 lds
    buffer_load_dwordx4 v239, s[8:11], s7 offen offset:3072 lds
    s_add_u32 m0, s78, 36864
    s_nop 0
    buffer_load_dwordx4 v240, s[8:11], s77 offen lds
    s_add_u32 s77, s77, 256
    s_cmp_eq_u32 s77, 1280
    s_cselect_b32 s77, 0, s77
    s_add_u32 m0, s49, 114688
    s_add_u32 s7, s79, s77
    buffer_load_dwordx4 v236, s[8:11], s7 offen offset:0 lds
    buffer_load_dwordx4 v237, s[8:11], s7 offen offset:1024 lds
    buffer_load_dwordx4 v238, s[8:11], s7 offen offset:2048 lds
    buffer_load_dwordx4 v239, s[8:11], s7 offen offset:3072 lds
    s_add_u32 m0, m0, 4096
    s_add_u32 s7, s7, 20480
    buffer_load_dwordx4 v236, s[8:11], s7 offen offset:0 lds
    buffer_load_dwordx4 v237, s[8:11], s7 offen offset:1024 lds
    buffer_load_dwordx4 v238, s[8:11], s7 offen offset:2048 lds
    buffer_load_dwordx4 v239, s[8:11], s7 offen offset:3072 lds
    s_add_u32 m0, s78, 110592
    s_nop 0
    buffer_load_dwordx4 v240, s[8:11], s77 offen lds
    s_add_u32 s77, s77, 256
    s_cmp_eq_u32 s77, 1280
    s_cselect_b32 s77, 0, s77
    s_min_u32 s52, s3, 2
    s_lshl_b32 s67, s52, 10
    s_lshl_b32 s52, s52, 6
    s_add_u32 s52, s52, s48
    s_sub_u32 s52, s52, 16
    v_add_u32 v2, s52, v1
    v_max_i32 v2, 0, v2
    v_lshlrev_b32 v12, 4, v2
    v_lshlrev_b32 v13, 7, v11
    s_mov_b32 s52, 160512
    v_lshl_add_u32 v28, v14, 4, s52
    s_lshl_b32 s66, s5, 14
    s_lshl_b32 s53, s3, 8
    s_add_u32 s66, s66, s53
    s_add_u32 s66, s66, 0x380000
    v_lshlrev_b32 v33, 12, v15
    v_lshl_add_u32 v33, v14, 4, v33
    s_mul_i32 s63, s3, 9216
    s_add_u32 s64, s60, s63
    s_lshl_b32 s52, s4, 3
    s_lshl_b32 s53, s3, 1
    s_add_u32 s52, s52, s53
    s_mul_i32 s52, s52, 20480
    s_add_u32 s91, s52, 0x100000
    s_lshl_b32 s53, s5, 10
    v_lshl_add_u32 v24, v1, 4, s53
    v_mul_u32_u24 v25, 20480, v10
    v_lshl_add_u32 v25, v14, 4, v25
    v_and_b32 v2, 1, v15
    v_lshl_add_u32 v25, v2, 3, v25
    s_lshl_b32 s53, s5, 8
    s_add_u32 s53, s53, 16384
    v_add_u32 v25, s53, v25
    s_lshr_b32 s54, s86, 1
    s_lshl_b32 s54, s54, 5
    s_and_b32 s55, s86, 1
    s_add_u32 s54, s54, s55
    v_lshl_add_u32 v35, v14, 1, s54
    v_mul_u32_u24 v30, 1280, v35
    v_lshl_add_u32 v30, v15, 3, v30
    s_mul_i32 s55, s87, 160
    v_add_u32 v30, s55, v30
    s_mul_i32 s71, s54, 1280
    s_add_u32 s71, s71, s55
    s_mul_i32 s53, s3, 640
    s_lshr_b32 s54, s55, 1
    s_add_u32 s53, s53, s54
    s_add_u32 s53, s53, 1280
    v_min_u32 v4, 39, v1
    v_lshl_add_u32 v5, v4, 1, s53
    v_lshrrev_b32 v3, 6, v5
    v_and_b32 v5, 63, v5
    v_lshlrev_b32 v5, 3, v5
    v_lshl_add_u32 v27, v3, 11, v5
    v_lshl_add_u32 v10, v4, 2, s55
    s_mul_i32 s58, s3, 3072
    s_add_u32 s58, s58, 149760
    s_lshl_b32 s59, s4, 2
    s_add_u32 s59, s59, s3
    s_lshl_b32 s59, s59, 4
    s_add_u32 s59, s59, s5
    s_lshl_b32 s59, s59, 7
    s_add_u32 s59, s59, 0x3e0000
    s_lshr_b32 s57, s86, 1
    s_lshl_b32 s57, s57, 11
    s_add_u32 s57, s57, 0x3e0000
    s_add_u32 m0, s67, 160512
    s_nop 0
    buffer_load_dwordx4 v12, s[24:27], s65 offen sc1 lds
    s_mov_b64 exec, 0xffff
    buffer_load_dword v61, v52, s[24:27], s51 offen sc1
    s_mov_b64 exec, -1
    s_cmp_lg_u32 s3, 1
    s_cbranch_scc1 L_skip_5
    s_waitcnt vmcnt(20)
    s_mov_b64 exec, 1
    buffer_store_dword v39, off, s[24:27], s68 sc0 sc1
    s_mov_b64 exec, -1
L_skip_5:
    s_nop 1
    ds_read_b128 a[40:43], v20 offset:0
    ds_read_b128 a[44:47], v20 offset:4096
    ds_read_b128 a[48:51], v20 offset:8192
    ds_read_b128 a[52:55], v20 offset:12288
    ds_read_b128 a[56:59], v20 offset:16384
    ds_read_b128 a[60:63], v20 offset:20480
    ds_read_b128 a[64:67], v20 offset:24576
    ds_read_b128 a[68:71], v20 offset:28672
    ds_read_b128 a[72:75], v20 offset:32768
    v_and_b32 v2, 7, v1
    s_lshl_b32 s52, s5, 10
    v_lshl_add_u32 v2, v2, 7, s52
    v_and_b32 v3, 1, v1
    s_lshl_b32 s52, s5, 8
    s_add_u32 s52, s52, 16384
    v_cmp_gt_u32 vcc, 16, v1
    v_lshl_add_u32 v3, v3, 7, s52
    v_bfe_u32 v4, v1, 3, 1
    v_cndmask_b32 v2, v3, v2, vcc
    v_mul_u32_u24 v4, 20480, v4
    v_add3_u32 v34, v2, v4, s91
    v_writelane_b32 v34, s59, 32
    s_lshl_b32 s52, s86, 3
    s_add_u32 s52, s52, s87
    s_lshl_b32 s52, s52, 8
    s_add_u32 s52, s52, 0x10000
    v_writelane_b32 v34, s52, 33
    s_add_u32 s52, s52, 128
    v_writelane_b32 v34, s52, 34
    s_lshl_b32 s52, s93, 2
    s_add_u32 s52, s52, s3
    s_lshl_b32 s52, s52, 8
    s_add_u32 s52, s52, 0x680000
    v_writelane_b32 v34, s52, 35
    s_add_u32 s52, s52, 128
    v_writelane_b32 v34, s52, 36
    s_lshl_b32 s52, s93, 7
    s_add_u32 s52, s52, 0xc8000
    v_writelane_b32 v34, s52, 37
    s_lshl_b32 s53, s95, 7
    s_add_u32 s52, s53, 0x50000
    v_writelane_b32 v34, s52, 38
    s_mul_i32 s52, s94, 20480
    s_add_u32 s52, s52, s53
    s_add_u32 s52, s52, 0x6c4000
    v_writelane_b32 v34, s52, 39
    s_lshl_b32 s53, s3, 12
    s_add_u32 s52, s52, s53
    s_sub_u32 s52, s52, 16384
    v_writelane_b32 v34, s52, 40
    s_waitcnt vmcnt(0)
    v_cmp_ne_u32 vcc, s6, v61
    s_nop 0
    s_and_b64 vcc, vcc, 0xffff
    s_cbranch_vccz L_done_7
    s_mov_b32 s90, 0
L_poll_6:
    s_nop 1
    s_add_u32 m0, s67, 160512
    s_nop 0
    buffer_load_dwordx4 v12, s[24:27], s65 offen sc1 lds
    s_mov_b64 exec, 0xffff
    buffer_load_dword v61, v52, s[24:27], s51 offen sc1
    s_mov_b64 exec, -1
    s_waitcnt vmcnt(0)
    v_cmp_ne_u32 vcc, s6, v61
    s_nop 0
    s_and_b64 vcc, vcc, 0xffff
    s_cbranch_vccz L_done_7
    s_add_u32 s90, s90, 1
    s_cmp_lt_u32 s90, 40000
    s_cbranch_scc1 L_poll_6
L_done_7:
    s_nop 1
    buffer_load_dwordx4 a[96:99], v26, s[24:27], s72 offen sc1
    buffer_load_dwordx4 a[100:103], v29, s[24:27], s72 offen offset:1024 sc1
    s_barrier
    s_add_u32 s72, s72, 8192
    buffer_load_dwordx4 a[104:107], v26, s[24:27], s72 offen sc1
    buffer_load_dwordx4 a[108:111], v29, s[24:27], s72 offen offset:1024 sc1
    s_add_u32 s72, s72, 8192
    buffer_load_dwordx4 a[112:115], v26, s[24:27], s72 offen sc1
    buffer_load_dwordx4 a[116:119], v29, s[24:27], s72 offen offset:1024 sc1
    s_add_u32 s72, s72, 8192
    buffer_load_dwordx4 a[120:123], v26, s[24:27], s72 offen sc1
    buffer_load_dwordx4 a[124:127], v29, s[24:27], s72 offen offset:1024 sc1
    s_add_u32 s72, s72, 8192
    s_cmp_eq_u32 s72, s73
    s_cselect_b32 s72, s80, s72
    buffer_load_dwordx4 a[128:131], v26, s[24:27], s72 offen sc1
    buffer_load_dwordx4 a[132:135], v29, s[24:27], s72 offen offset:1024 sc1
    s_waitcnt vmcnt(9) lgkmcnt(8)
    v_mfma_f32_16x16x32_bf16 v[40:43], a[96:99], a[40:43], 0
    ds_read_b128 v[184:187], v28 offset:0
    s_add_u32 s72, s72, 8192
    s_waitcnt vmcnt(8)
    v_mfma_f32_16x16x32_bf16 v[44:47], a[100:103], a[40:43], 0
    ds_read_b128 a[40:43], v21 offset:0
    s_lshl_b32 s54, s3, 5
    s_waitcnt lgkmcnt(9)
    v_mfma_f32_16x16x32_bf16 v[48:51], a[96:99], a[44:47], 0
    buffer_load_dwordx4 a[136:139], v26, s[24:27], s72 offen sc1
    v_mfma_f32_16x16x32_bf16 v[52:55], a[100:103], a[44:47], 0
    ds_read_b128 a[44:47], v21 offset:4096
    s_add_u32 s54, s54, 16
    s_waitcnt lgkmcnt(9)
    v_mfma_f32_16x16x32_bf16 v[56:59], a[96:99], a[48:51], 0
    s_waitcnt lgkmcnt(6)
    v_lshlrev_b32 v2, 2, v15
    v_sub_u32 v2, v2, v14
    v_mfma_f32_16x16x32_bf16 v[60:63], a[100:103], a[48:51], 0
    ds_read_b128 a[48:51], v21 offset:8192
    v_mfma_f32_16x16x32_bf16 v[64:67], a[96:99], a[52:55], 0
    ds_read_b128 v[188:191], v28 offset:256
    v_mov_b32 v4, 0xff7fffff
    v_mfma_f32_16x16x32_bf16 v[68:71], a[100:103], a[52:55], 0
    ds_read_b128 a[52:55], v21 offset:12288
    v_mfma_f32_16x16x32_bf16 v[72:75], a[96:99], a[56:59], 0
    buffer_load_dwordx4 a[140:143], v29, s[24:27], s72 offen offset:1024 sc1
    v_mfma_f32_16x16x32_bf16 v[76:79], a[100:103], a[56:59], 0
    ds_read_b128 a[56:59], v21 offset:16384
    v_mfma_f32_16x16x32_bf16 v[80:83], a[96:99], a[60:63], 0
    s_waitcnt lgkmcnt(7)
    s_or_b32 s55, s4, s3
    s_cmp_eq_u32 s55, 0
    s_cselect_b32 s55, 100, 0
    v_mfma_f32_16x16x32_bf16 v[84:87], a[100:103], a[60:63], 0
    ds_read_b128 a[60:63], v21 offset:20480
    v_subrev_u32 v3, s55, v2
    v_mfma_f32_16x16x32_bf16 v[88:91], a[96:99], a[64:67], 0
    v_cmp_le_i32 vcc, 9, v3
    v_mfma_f32_16x16x32_bf16 v[92:95], a[100:103], a[64:67], 0
    ds_read_b128 a[64:67], v21 offset:24576
    v_mfma_f32_16x16x32_bf16 v[96:99], a[96:99], a[68:71], 0
    ds_read_b128 v[192:195], v28 offset:512
    v_add_u32 v5, 7, v2
    v_mfma_f32_16x16x32_bf16 v[100:103], a[100:103], a[68:71], 0
    ds_read_b128 a[68:71], v21 offset:28672
    v_cmp_gt_u32 s[98:99], 8, v5
    v_mfma_f32_16x16x32_bf16 v[104:107], a[96:99], a[72:75], 0
    s_waitcnt vmcnt(8) lgkmcnt(7)
    v_cndmask_b32 v6, v4, 0, vcc
    s_mov_b32 s55, 0x05040100
    v_mfma_f32_16x16x32_bf16 v[108:111], a[100:103], a[72:75], 0
    ds_read_b128 a[72:75], v21 offset:32768
    v_mfma_f32_16x16x32_bf16 v[40:43], a[104:107], a[40:43], v[40:43]
    ds_read_b128 v[196:199], v28 offset:768
    s_add_u32 s72, s72, 8192
    v_mfma_f32_16x16x32_bf16 v[44:47], a[108:111], a[40:43], v[44:47]
    ds_read_b128 a[40:43], v22 offset:0
    v_cndmask_b32 v248, v4, 0, s[98:99]
    v_mfma_f32_16x16x32_bf16 v[48:51], a[104:107], a[44:47], v[48:51]
    buffer_load_dwordx4 a[144:147], v26, s[24:27], s72 offen sc1
    v_mfma_f32_16x16x32_bf16 v[52:55], a[108:111], a[44:47], v[52:55]
    ds_read_b128 a[44:47], v22 offset:4096
    v_cmp_le_i32 vcc, 8, v3
    v_mfma_f32_16x16x32_bf16 v[56:59], a[104:107], a[48:51], v[56:59]
    buffer_load_dwordx4 a[148:151], v29, s[24:27], s72 offen offset:1024 sc1
    v_mfma_f32_16x16x32_bf16 v[60:63], a[108:111], a[48:51], v[60:63]
    ds_read_b128 a[48:51], v22 offset:8192
    s_waitcnt lgkmcnt(8)
    v_mfma_f32_16x16x32_bf16 v[64:67], a[104:107], a[52:55], v[64:67]
    v_add_u32 v5, 8, v2
    v_cmp_gt_u32 s[98:99], 8, v5
    v_mfma_f32_16x16x32_bf16 v[68:71], a[108:111], a[52:55], v[68:71]
    ds_read_b128 a[52:55], v22 offset:12288
    v_mfma_f32_16x16x32_bf16 v[72:75], a[104:107], a[56:59], v[72:75]
    buffer_load_dword v253, v13, s[24:27], s69 offen sc1
    v_mfma_f32_16x16x32_bf16 v[76:79], a[108:111], a[56:59], v[76:79]
    ds_read_b128 a[56:59], v22 offset:16384
    v_mfma_f32_16x16x32_bf16 v[80:83], a[104:107], a[60:63], v[80:83]
    s_waitcnt lgkmcnt(6)
    v_mfma_f32_16x16x32_bf16 v[84:87], a[108:111], a[60:63], v[84:87]
    ds_read_b128 a[60:63], v22 offset:20480
    v_mfma_f32_16x16x32_bf16 v[88:91], a[104:107], a[64:67], v[88:91]
    buffer_load_dwordx4 v[168:171], v33, s[24:27], s66 offen offset:0 sc1
    v_mfma_f32_16x16x32_bf16 v[92:95], a[108:111], a[64:67], v[92:95]
    ds_read_b128 a[64:67], v22 offset:24576
    v_mfma_f32_16x16x32_bf16 v[96:99], a[104:107], a[68:71], v[96:99]
    ds_read_b128 v[200:203], v28 offset:1024
    v_cndmask_b32 v7, v4, 0, vcc
    v_mfma_f32_16x16x32_bf16 v[100:103], a[108:111], a[68:71], v[100:103]
    ds_read_b128 a[68:71], v22 offset:28672
    s_mov_b32 s55, 0x05040100
    v_mfma_f32_16x16x32_bf16 v[104:107], a[104:107], a[72:75], v[104:107]
    s_waitcnt vmcnt(10) lgkmcnt(6)
    v_cndmask_b32 v249, v4, 0, s[98:99]
    v_cmp_le_i32 vcc, 7, v3
    v_mfma_f32_16x16x32_bf16 v[108:111], a[108:111], a[72:75], v[108:111]
    ds_read_b128 a[72:75], v22 offset:32768
    v_mfma_f32_16x16x32_bf16 v[40:43], a[112:115], a[40:43], v[40:43]
    s_add_u32 s72, s72, 8192
    v_add_u32 v20, 0xfffee000, v20
    v_add_u32 v21, 0xfffee000, v21
    v_mfma_f32_16x16x32_bf16 v[44:47], a[116:119], a[40:43], v[44:47]
    ds_read_b128 a[40:43], v23 offset:0
    v_add_u32 v22, 0xfffee000, v22
    v_mfma_f32_16x16x32_bf16 v[48:51], a[112:115], a[44:47], v[48:51]
    buffer_load_dwordx4 a[152:155], v26, s[24:27], s72 offen sc1
    v_mfma_f32_16x16x32_bf16 v[52:55], a[116:119], a[44:47], v[52:55]
    ds_read_b128 a[44:47], v23 offset:4096
    v_mfma_f32_16x16x32_bf16 v[56:59], a[112:115], a[48:51], v[56:59]
    buffer_load_dwordx4 a[156:159], v29, s[24:27], s72 offen offset:1024 sc1
    v_mfma_f32_16x16x32_bf16 v[60:63], a[116:119], a[48:51], v[60:63]
    ds_read_b128 a[48:51], v23 offset:8192
    s_waitcnt lgkmcnt(7)
    v_mfma_f32_16x16x32_bf16 v[64:67], a[112:115], a[52:55], v[64:67]
    ds_read_b128 v[204:207], v28 offset:1280
    v_add_u32 v5, 9, v2
    v_mfma_f32_16x16x32_bf16 v[68:71], a[116:119], a[52:55], v[68:71]
    ds_read_b128 a[52:55], v23 offset:12288
    v_cmp_gt_u32 s[98:99], 8, v5
    v_mfma_f32_16x16x32_bf16 v[72:75], a[112:115], a[56:59], v[72:75]
    buffer_load_dwordx4 v[172:175], v33, s[24:27], s66 offen offset:1024 sc1
    v_mfma_f32_16x16x32_bf16 v[76:79], a[116:119], a[56:59], v[76:79]
    ds_read_b128 a[56:59], v23 offset:16384
    v_cndmask_b32 v8, v4, 0, vcc
    v_mfma_f32_16x16x32_bf16 v[80:83], a[112:115], a[60:63], v[80:83]
    s_waitcnt lgkmcnt(6)
    s_mov_b32 s55, 0x05040100
    v_mfma_f32_16x16x32_bf16 v[84:87], a[116:119], a[60:63], v[84:87]
    ds_read_b128 a[60:63], v23 offset:20480
    v_mfma_f32_16x16x32_bf16 v[88:91], a[112:115], a[64:67], v[88:91]
    buffer_load_dwordx4 v[176:179], v33, s[24:27], s66 offen offset:2048 sc1
    v_mfma_f32_16x16x32_bf16 v[92:95], a[116:119], a[64:67], v[92:95]
    ds_read_b128 a[64:67], v23 offset:24576
    v_mfma_f32_16x16x32_bf16 v[96:99], a[112:115], a[68:71], v[96:99]
    ds_read_b128 v[208:211], v28 offset:1536
    v_cndmask_b32 v250, v4, 0, s[98:99]
    v_mfma_f32_16x16x32_bf16 v[100:103], a[116:119], a[68:71], v[100:103]
    ds_read_b128 a[68:71], v23 offset:28672
    v_cmp_le_i32 vcc, 6, v3
    v_mfma_f32_16x16x32_bf16 v[104:107], a[112:115], a[72:75], v[104:107]
    s_waitcnt vmcnt(12) lgkmcnt(7)
    v_add_u32 v5, 10, v2
    v_cmp_gt_u32 s[98:99], 8, v5
    v_mfma_f32_16x16x32_bf16 v[108:111], a[116:119], a[72:75], v[108:111]
    ds_read_b128 a[72:75], v23 offset:32768
    v_mfma_f32_16x16x32_bf16 v[40:43], a[120:123], a[40:43], v[40:43]
    s_add_u32 s72, s72, 8192
    s_cmp_eq_u32 s72, s73
    s_cselect_b32 s72, s80, s72
    v_mfma_f32_16x16x32_bf16 v[44:47], a[124:127], a[40:43], v[44:47]
    ds_read_b128 a[40:43], v20 offset:0
    v_add_u32 v23, 0xfffee000, v23
    v_mfma_f32_16x16x32_bf16 v[48:51], a[120:123], a[44:47], v[48:51]
    buffer_load_dwordx4 a[160:163], v26, s[24:27], s72 offen sc1
    v_mfma_f32_16x16x32_bf16 v[52:55], a[124:127], a[44:47], v[52:55]
    ds_read_b128 a[44:47], v20 offset:4096
    v_mfma_f32_16x16x32_bf16 v[56:59], a[120:123], a[48:51], v[56:59]
    s_waitcnt lgkmcnt(6)
    v_mfma_f32_16x16x32_bf16 v[60:63], a[124:127], a[48:51], v[60:63]
    ds_read_b128 a[48:51], v20 offset:8192
    v_mfma_f32_16x16x32_bf16 v[64:67], a[120:123], a[52:55], v[64:67]
    buffer_load_dwordx4 a[164:167], v29, s[24:27], s72 offen offset:1024 sc1
    v_mfma_f32_16x16x32_bf16 v[68:71], a[124:127], a[52:55], v[68:71]
    ds_read_b128 a[52:55], v20 offset:12288
    v_mfma_f32_16x16x32_bf16 v[72:75], a[120:123], a[56:59], v[72:75]
    ds_read_b128 v[212:215], v28 offset:1792
    v_cndmask_b32 v9, v4, 0, vcc
    v_mfma_f32_16x16x32_bf16 v[76:79], a[124:127], a[56:59], v[76:79]
    ds_read_b128 a[56:59], v20 offset:16384
    s_mov_b32 s55, 0x05040100
    v_mfma_f32_16x16x32_bf16 v[80:83], a[120:123], a[60:63], v[80:83]
    s_waitcnt lgkmcnt(6)
    v_cndmask_b32 v251, v4, 0, s[98:99]
    v_perm_b32 v19, v7, v6, s55
    v_mfma_f32_16x16x32_bf16 v[84:87], a[124:127], a[60:63], v[84:87]
    ds_read_b128 a[60:63], v20 offset:20480
    v_mfma_f32_16x16x32_bf16 v[88:91], a[120:123], a[64:67], v[88:91]
    buffer_load_dwordx4 v[180:183], v33, s[24:27], s66 offen offset:3072 sc1
    v_mfma_f32_16x16x32_bf16 v[92:95], a[124:127], a[64:67], v[92:95]
    ds_read_b128 a[64:67], v20 offset:24576
    v_mfma_f32_16x16x32_bf16 v[96:99], a[120:123], a[68:71], v[96:99]
    ds_read_b128 v[216:219], v28 offset:2048
    v_perm_b32 v36, v9, v8, s55
    v_mfma_f32_16x16x32_bf16 v[100:103], a[124:127], a[68:71], v[100:103]
    ds_read_b128 a[68:71], v20 offset:28672
    v_perm_b32 v37, v249, v248, s55
    v_mfma_f32_16x16x32_bf16 v[104:107], a[120:123], a[72:75], v[104:107]
    s_waitcnt vmcnt(13) lgkmcnt(7)
    v_perm_b32 v254, v251, v250, s55
    s_mov_b32 s55, 110592
    v_mfma_f32_16x16x32_bf16 v[108:111], a[124:127], a[72:75], v[108:111]
    ds_read_b128 a[72:75], v20 offset:32768
    v_lshl_add_u32 v2, v14, 1, s54
    v_mfma_f32_16x16x32_bf16 v[40:43], a[128:131], a[40:43], v[40:43]
    s_add_u32 s72, s72, 8192
    v_subrev_u32 v3, 32, v2
    v_mul_u32_u24 v2, 272, v2
    v_mfma_f32_16x16x32_bf16 v[44:47], a[132:135], a[40:43], v[44:47]
    ds_read_b128 a[40:43], v21 offset:0
    v_max_i32 v3, 0, v3
    v_mfma_f32_16x16x32_bf16 v[48:51], a[128:131], a[44:47], v[48:51]
    buffer_load_dwordx4 a[168:171], v26, s[24:27], s72 offen sc1
    v_mfma_f32_16x16x32_bf16 v[52:55], a[132:135], a[44:47], v[52:55]
    ds_read_b128 a[44:47], v21 offset:4096
    v_mul_u32_u24 v3, 272, v3
    v_mfma_f32_16x16x32_bf16 v[56:59], a[128:131], a[48:51], v[56:59]
    buffer_load_dwordx4 a[172:175], v29, s[24:27], s72 offen offset:1024 sc1
    v_mfma_f32_16x16x32_bf16 v[60:63], a[132:135], a[48:51], v[60:63]
    ds_read_b128 a[48:51], v21 offset:8192
    s_waitcnt lgkmcnt(7)
    v_mfma_f32_16x16x32_bf16 v[64:67], a[128:131], a[52:55], v[64:67]
    s_add_u32 s72, s72, 8192
    v_lshl_add_u32 v4, v15, 4, s55
    v_add_u32 v241, v4, v2
    v_mfma_f32_16x16x32_bf16 v[68:71], a[132:135], a[52:55], v[68:71]
    ds_read_b128 a[52:55], v21 offset:12288
    v_add_u32 v242, v4, v3
    v_mfma_f32_16x16x32_bf16 v[72:75], a[128:131], a[56:59], v[72:75]
    buffer_load_dwordx4 a[176:179], v26, s[24:27], s72 offen sc1
    v_mfma_f32_16x16x32_bf16 v[76:79], a[132:135], a[56:59], v[76:79]
    ds_read_b128 a[56:59], v21 offset:16384
    v_lshrrev_b32 v5, 2, v1
    v_mfma_f32_16x16x32_bf16 v[80:83], a[128:131], a[60:63], v[80:83]
    s_waitcnt lgkmcnt(5)
    v_lshl_add_u32 v2, v5, 1, s54
    v_subrev_u32 v3, 32, v2
    v_mfma_f32_16x16x32_bf16 v[84:87], a[132:135], a[60:63], v[84:87]
    ds_read_b128 a[60:63], v21 offset:20480
    v_mul_u32_u24 v2, 272, v2
    v_mfma_f32_16x16x32_bf16 v[88:91], a[128:131], a[64:67], v[88:91]
    buffer_load_dwordx4 a[180:183], v29, s[24:27], s72 offen offset:1024 sc1
    v_mfma_f32_16x16x32_bf16 v[92:95], a[132:135], a[64:67], v[92:95]
    ds_read_b128 a[64:67], v21 offset:24576
    v_max_i32 v3, 0, v3
    v_mfma_f32_16x16x32_bf16 v[96:99], a[128:131], a[68:71], v[96:99]
    v_mul_u32_u24 v3, 272, v3
    v_and_b32 v4, 3, v1
    v_mfma_f32_16x16x32_bf16 v[100:103], a[132:135], a[68:71], v[100:103]
    ds_read_b128 a[68:71], v21 offset:28672
    v_lshl_add_u32 v4, v4, 3, s55
    v_mfma_f32_16x16x32_bf16 v[104:107], a[128:131], a[72:75], v[104:107]
    s_waitcnt vmcnt(15) lgkmcnt(5)
    v_add_u32 v243, v4, v2
    v_add_u32 v244, v4, v3
    v_mfma_f32_16x16x32_bf16 v[108:111], a[132:135], a[72:75], v[108:111]
    ds_read_b128 a[72:75], v21 offset:32768
    v_and_b32 v4, 1, v1
    v_mfma_f32_16x16x32_bf16 v[40:43], a[136:139], a[40:43], v[40:43]
    s_add_u32 s72, s72, 8192
    v_mul_u32_u24 v4, 40, v4
    v_add3_u32 v245, v4, v2, s55
    v_mfma_f32_16x16x32_bf16 v[44:47], a[140:143], a[40:43], v[44:47]
    ds_read_b128 a[40:43], v22 offset:0
    v_add3_u32 v246, v4, v3, s55
    v_mfma_f32_16x16x32_bf16 v[48:51], a[136:139], a[44:47], v[48:51]
    buffer_load_dwordx4 a[184:187], v26, s[24:27], s72 offen sc1
    v_mfma_f32_16x16x32_bf16 v[52:55], a[140:143], a[44:47], v[52:55]
    ds_read_b128 a[44:47], v22 offset:4096
    s_mov_b32 s50, -1
    v_mfma_f32_16x16x32_bf16 v[56:59], a[136:139], a[48:51], v[56:59]
    s_waitcnt lgkmcnt(5)
    s_mov_b32 s51, 0xffff
    s_mov_b32 s12, -1
    v_mfma_f32_16x16x32_bf16 v[60:63], a[140:143], a[48:51], v[60:63]
    ds_read_b128 a[48:51], v22 offset:8192
    s_mov_b32 s13, 0
    v_mfma_f32_16x16x32_bf16 v[64:67], a[136:139], a[52:55], v[64:67]
    s_mov_b32 s74, 0xffff0000
    s_mov_b32 s75, 0xffff
    v_lshlrev_b32 v247, 7, v14
    v_mfma_f32_16x16x32_bf16 v[68:71], a[140:143], a[52:55], v[68:71]
    ds_read_b128 a[52:55], v22 offset:12288
    v_mul_u32_u24 v38, 272, v14
    v_mfma_f32_16x16x32_bf16 v[72:75], a[136:139], a[56:59], v[72:75]
    buffer_load_dwordx4 a[188:191], v29, s[24:27], s72 offen offset:1024 sc1
    v_mfma_f32_16x16x32_bf16 v[76:79], a[140:143], a[56:59], v[76:79]
    ds_read_b128 a[56:59], v22 offset:16384
    s_lshl_b32 s55, s3, 6
    v_mfma_f32_16x16x32_bf16 v[80:83], a[136:139], a[60:63], v[80:83]
    s_waitcnt lgkmcnt(5)
    s_add_u32 s55, s55, 110592
    v_lshl_add_u32 v38, v15, 3, v38
    v_mfma_f32_16x16x32_bf16 v[84:87], a[140:143], a[60:63], v[84:87]
    ds_read_b128 a[60:63], v22 offset:20480
    v_add_u32 v38, s55, v38
    v_mfma_f32_16x16x32_bf16 v[88:91], a[136:139], a[64:67], v[88:91]
    v_add_u32 v2, 0, v1
    v_mul_u32_u24 v3, 205, v2
    v_mfma_f32_16x16x32_bf16 v[92:95], a[140:143], a[64:67], v[92:95]
    ds_read_b128 a[64:67], v22 offset:24576
    v_lshrrev_b32 v3, 11, v3
    v_mfma_f32_16x16x32_bf16 v[96:99], a[136:139], a[68:71], v[96:99]
    v_mul_u32_u24 v3, 2400, v3
    v_lshl_add_u32 v16, v2, 4, v3
    v_mfma_f32_16x16x32_bf16 v[100:103], a[140:143], a[68:71], v[100:103]
    ds_read_b128 a[68:71], v22 offset:28672
    v_add_u32 v2, 64, v1
    v_mfma_f32_16x16x32_bf16 v[104:107], a[136:139], a[72:75], v[104:107]
    s_waitcnt vmcnt(15) lgkmcnt(5)
    v_mul_u32_u24 v3, 205, v2
    v_lshrrev_b32 v3, 11, v3
    v_mfma_f32_16x16x32_bf16 v[108:111], a[140:143], a[72:75], v[108:111]
    ds_read_b128 a[72:75], v22 offset:32768
    v_mul_u32_u24 v3, 2400, v3
    v_mfma_f32_16x16x32_bf16 v[40:43], a[144:147], a[40:43], v[40:43]
    s_add_u32 s72, s72, 8192
    s_cmp_eq_u32 s72, s73
    s_cselect_b32 s72, s80, s72
    v_mfma_f32_16x16x32_bf16 v[44:47], a[148:151], a[40:43], v[44:47]
    ds_read_b128 a[40:43], v23 offset:0
    v_add_u32 v20, 0x9000, v20
    v_mfma_f32_16x16x32_bf16 v[48:51], a[144:147], a[44:47], v[48:51]
    buffer_load_dwordx4 a[192:195], v26, s[24:27], s72 offen sc1
    v_mfma_f32_16x16x32_bf16 v[52:55], a[148:151], a[44:47], v[52:55]
    ds_read_b128 a[44:47], v23 offset:4096
    v_add_u32 v21, 0x9000, v21
    v_mfma_f32_16x16x32_bf16 v[56:59], a[144:147], a[48:51], v[56:59]
    buffer_load_dwordx4 a[196:199], v29, s[24:27], s72 offen offset:1024 sc1
    v_mfma_f32_16x16x32_bf16 v[60:63], a[148:151], a[48:51], v[60:63]
    ds_read_b128 a[48:51], v23 offset:8192
    s_waitcnt lgkmcnt(6)
    v_mfma_f32_16x16x32_bf16 v[64:67], a[144:147], a[52:55], v[64:67]
    s_add_u32 s72, s72, 8192
    v_add_u32 v22, 0x9000, v22
    v_lshl_add_u32 v17, v2, 4, v3
    v_mfma_f32_16x16x32_bf16 v[68:71], a[148:151], a[52:55], v[68:71]
    ds_read_b128 a[52:55], v23 offset:12288
    v_add_u32 v2, 128, v1
    v_mfma_f32_16x16x32_bf16 v[72:75], a[144:147], a[56:59], v[72:75]
    buffer_load_dwordx4 a[200:203], v26, s[24:27], s72 offen sc1
    v_mfma_f32_16x16x32_bf16 v[76:79], a[148:151], a[56:59], v[76:79]
    ds_read_b128 a[56:59], v23 offset:16384
    v_min_u32 v2, 159, v2
    v_mfma_f32_16x16x32_bf16 v[80:83], a[144:147], a[60:63], v[80:83]
    s_waitcnt lgkmcnt(5)
    v_mul_u32_u24 v3, 205, v2
    v_lshrrev_b32 v3, 11, v3
    v_mfma_f32_16x16x32_bf16 v[84:87], a[148:151], a[60:63], v[84:87]
    ds_read_b128 a[60:63], v23 offset:20480
    v_mul_u32_u24 v3, 2400, v3
    v_mfma_f32_16x16x32_bf16 v[88:91], a[144:147], a[64:67], v[88:91]
    buffer_load_dwordx4 a[204:207], v29, s[24:27], s72 offen offset:1024 sc1
    v_mfma_f32_16x16x32_bf16 v[92:95], a[148:151], a[64:67], v[92:95]
    ds_read_b128 a[64:67], v23 offset:24576
    v_lshl_add_u32 v18, v2, 4, v3
    v_mfma_f32_16x16x32_bf16 v[96:99], a[144:147], a[68:71], v[96:99]
    v_xor_b32 v2, s6, v187
    v_bitop3_b32 v2, v2, v191, s6 bitop3:0xf6
    v_mfma_f32_16x16x32_bf16 v[100:103], a[148:151], a[68:71], v[100:103]
    ds_read_b128 a[68:71], v23 offset:28672
    v_bitop3_b32 v2, v2, v195, s6 bitop3:0xf6
    v_mfma_f32_16x16x32_bf16 v[104:107], a[144:147], a[72:75], v[104:107]
    s_waitcnt vmcnt(15) lgkmcnt(5)
    v_bitop3_b32 v2, v2, v199, s6 bitop3:0xf6
    v_bitop3_b32 v2, v2, v203, s6 bitop3:0xf6
    v_mfma_f32_16x16x32_bf16 v[108:111], a[148:151], a[72:75], v[108:111]
    ds_read_b128 a[72:75], v23 offset:32768
    v_bitop3_b32 v2, v2, v207, s6 bitop3:0xf6
    v_mfma_f32_16x16x32_bf16 v[40:43], a[152:155], a[40:43], v[40:43]
    s_add_u32 s72, s72, 8192
    v_add_u32 v23, 0x9000, v23
    v_bitop3_b32 v2, v2, v211, s6 bitop3:0xf6
    v_mfma_f32_16x16x32_bf16 v[44:47], a[156:159], a[40:43], v[44:47]
    ds_read_b128 a[40:43], v20 offset:0
    v_bitop3_b32 v2, v2, v215, s6 bitop3:0xf6
    v_mfma_f32_16x16x32_bf16 v[48:51], a[152:155], a[44:47], v[48:51]
    buffer_load_dwordx4 a[208:211], v26, s[24:27], s72 offen sc1
    v_mfma_f32_16x16x32_bf16 v[52:55], a[156:159], a[44:47], v[52:55]
    ds_read_b128 a[44:47], v20 offset:4096
    v_bitop3_b32 v2, v2, v219, s6 bitop3:0xf6
    v_mfma_f32_16x16x32_bf16 v[56:59], a[152:155], a[48:51], v[56:59]
    s_waitcnt lgkmcnt(5)
    v_bitop3_b32 v2, v2, v253, s6 bitop3:0xf6
    v_cmp_ne_u32 vcc, 0, v2
    v_mfma_f32_16x16x32_bf16 v[60:63], a[156:159], a[48:51], v[60:63]
    ds_read_b128 a[48:51], v20 offset:8192
    s_lshl_b32 s52, s3, 8
    v_mfma_f32_16x16x32_bf16 v[64:67], a[152:155], a[52:55], v[64:67]
    s_add_u32 s52, s52, 150016
    v_lshl_add_u32 v12, v14, 4, s52
    v_lshl_add_u32 v5, v15, 6, s52
    v_mfma_f32_16x16x32_bf16 v[68:71], a[156:159], a[52:55], v[68:71]
    ds_read_b128 a[52:55], v20 offset:12288
    s_cbranch_vccz L_sm_8
    v_add_u32 v2, s48, v14
    v_lshlrev_b32 v3, 4, v2
    v_subrev_u32 v2, 16, v2
    v_max_i32 v2, 0, v2
    v_lshlrev_b32 v4, 4, v2
    s_mov_b32 s90, 0
L_poll_9:
    s_nop 1
    buffer_load_dword v253, v13, s[24:27], s69 offen sc1
    buffer_load_dwordx4 v[168:171], v33, s[24:27], s66 offen offset:0 sc1
    s_waitcnt vmcnt(17)
    buffer_load_dwordx4 v[172:175], v33, s[24:27], s66 offen offset:1024 sc1
    s_waitcnt vmcnt(17)
    buffer_load_dwordx4 v[176:179], v33, s[24:27], s66 offen offset:2048 sc1
    s_waitcnt vmcnt(15)
    buffer_load_dwordx4 v[180:183], v33, s[24:27], s66 offen offset:3072 sc1
    buffer_load_dwordx4 v[184:187], v4, s[24:27], s65 offen sc1
    buffer_load_dwordx4 v[188:191], v3, s[24:27], s65 offen offset:0 sc1
    buffer_load_dwordx4 v[192:195], v3, s[24:27], s65 offen offset:256 sc1
    buffer_load_dwordx4 v[196:199], v3, s[24:27], s65 offen offset:512 sc1
    buffer_load_dwordx4 v[200:203], v3, s[24:27], s65 offen offset:768 sc1
    buffer_load_dwordx4 v[204:207], v3, s[24:27], s65 offen offset:1024 sc1
    buffer_load_dwordx4 v[208:211], v3, s[24:27], s65 offen offset:1280 sc1
    buffer_load_dwordx4 v[212:215], v3, s[24:27], s65 offen offset:1536 sc1
    buffer_load_dwordx4 v[216:219], v3, s[24:27], s65 offen offset:1792 sc1
    s_waitcnt vmcnt(0)
    v_xor_b32 v2, s6, v187
    v_bitop3_b32 v2, v2, v191, s6 bitop3:0xf6
    v_bitop3_b32 v2, v2, v195, s6 bitop3:0xf6
    v_bitop3_b32 v2, v2, v199, s6 bitop3:0xf6
    v_bitop3_b32 v2, v2, v203, s6 bitop3:0xf6
    v_bitop3_b32 v2, v2, v207, s6 bitop3:0xf6
    v_bitop3_b32 v2, v2, v211, s6 bitop3:0xf6
    v_bitop3_b32 v2, v2, v215, s6 bitop3:0xf6
    v_bitop3_b32 v2, v2, v219, s6 bitop3:0xf6
    v_bitop3_b32 v2, v2, v253, s6 bitop3:0xf6
    v_cmp_ne_u32 vcc, 0, v2
    s_nop 4
    s_cbranch_vccz L_done_10
    s_add_u32 s90, s90, 1
    s_cmp_lt_u32 s90, 40000
    s_cbranch_scc1 L_poll_9
L_done_10:
    s_nop 1
L_sm_8:
    v_mfma_f32_16x16x32_bf16 v[72:75], a[152:155], a[56:59], v[72:75]
    buffer_load_dwordx4 a[212:215], v29, s[24:27], s72 offen offset:1024 sc1
    v_mfma_f32_16x16x32_bf16 v[76:79], a[156:159], a[56:59], v[76:79]
    ds_read_b128 a[56:59], v20 offset:16384
    s_waitcnt vmcnt(16)
    v_add_f32 v168, v168, v172
    v_mfma_f32_16x16x32_bf16 v[80:83], a[152:155], a[60:63], v[80:83]
    s_waitcnt lgkmcnt(5)
    v_add_f32 v169, v169, v173
    v_add_f32 v170, v170, v174
    v_mfma_f32_16x16x32_bf16 v[84:87], a[156:159], a[60:63], v[84:87]
    ds_read_b128 a[60:63], v20 offset:20480
    v_add_f32 v171, v171, v175
    v_mfma_f32_16x16x32_bf16 v[88:91], a[152:155], a[64:67], v[88:91]
    s_waitcnt vmcnt(12)
    v_add_f32 v176, v176, v180
    v_add_f32 v177, v177, v181
    v_mfma_f32_16x16x32_bf16 v[92:95], a[156:159], a[64:67], v[92:95]
    ds_read_b128 a[64:67], v20 offset:24576
    v_add_f32 v178, v178, v182
    v_mfma_f32_16x16x32_bf16 v[96:99], a[152:155], a[68:71], v[96:99]
    v_add_f32 v179, v179, v183
    v_add_f32 v168, v168, v176
    v_mfma_f32_16x16x32_bf16 v[100:103], a[156:159], a[68:71], v[100:103]
    ds_read_b128 a[68:71], v20 offset:28672
    v_add_f32 v169, v169, v177
    v_mfma_f32_16x16x32_bf16 v[104:107], a[152:155], a[72:75], v[104:107]
    s_waitcnt lgkmcnt(5)
    v_add_f32 v170, v170, v178
    v_add_f32 v171, v171, v179
    v_mfma_f32_16x16x32_bf16 v[108:111], a[156:159], a[72:75], v[108:111]
    ds_read_b128 a[72:75], v20 offset:32768
    v_lshl_add_u32 v12, v15, 2, v12
    s_barrier
    v_mfma_f32_16x16x32_bf16 v[40:43], a[160:163], a[40:43], v[40:43]
    s_add_u32 s72, s72, 8192
    v_xor_b32 v3, s88, v189
    v_mfma_f32_16x16x32_bf16 v[44:47], a[164:167], a[40:43], v[44:47]
    ds_read_b128 a[40:43], v21 offset:0
    v_mfma_f32_16x16x32_bf16 v[48:51], a[160:163], a[44:47], v[48:51]
    buffer_load_dwordx4 a[216:219], v26, s[24:27], s72 offen sc1
    v_mfma_f32_16x16x32_bf16 v[52:55], a[164:167], a[44:47], v[52:55]
    ds_read_b128 a[44:47], v21 offset:4096
    v_mfma_f32_16x16x32_bf16 v[56:59], a[160:163], a[48:51], v[56:59]
    buffer_load_dwordx4 a[220:223], v29, s[24:27], s72 offen offset:1024 sc1
    v_mfma_f32_16x16x32_bf16 v[60:63], a[164:167], a[48:51], v[60:63]
    ds_read_b128 a[48:51], v21 offset:8192
    s_waitcnt lgkmcnt(6)
    v_mfma_f32_16x16x32_bf16 v[64:67], a[160:163], a[52:55], v[64:67]
    s_add_u32 m0, s49, 77824
    s_add_u32 s7, s79, s77
    v_mfma_f32_16x16x32_bf16 v[68:71], a[164:167], a[52:55], v[68:71]
    ds_read_b128 a[52:55], v21 offset:12288
    v_mfma_f32_16x16x32_bf16 v[72:75], a[160:163], a[56:59], v[72:75]
    buffer_load_dwordx4 v236, s[8:11], s7 offen offset:0 lds
    v_mfma_f32_16x16x32_bf16 v[76:79], a[164:167], a[56:59], v[76:79]
    ds_read_b128 a[56:59], v21 offset:16384
    v_mfma_f32_16x16x32_bf16 v[80:83], a[160:163], a[60:63], v[80:83]
    s_waitcnt lgkmcnt(5)
    v_permlane32_swap_b32 v168, v170
    v_mfma_f32_16x16x32_bf16 v[84:87], a[164:167], a[60:63], v[84:87]
    ds_read_b128 a[60:63], v21 offset:20480
    v_bitop3_b32 v3, v3, v193, s88 bitop3:0xf6
    v_mfma_f32_16x16x32_bf16 v[88:91], a[160:163], a[64:67], v[88:91]
    buffer_load_dwordx4 v237, s[8:11], s7 offen offset:1024 lds
    v_mfma_f32_16x16x32_bf16 v[92:95], a[164:167], a[64:67], v[92:95]
    ds_read_b128 a[64:67], v21 offset:24576
    v_mfma_f32_16x16x32_bf16 v[96:99], a[160:163], a[68:71], v[96:99]
    v_permlane32_swap_b32 v169, v171
    v_mfma_f32_16x16x32_bf16 v[100:103], a[164:167], a[68:71], v[100:103]
    ds_read_b128 a[68:71], v21 offset:28672
    v_add_f32 v168, v168, v170
    v_mfma_f32_16x16x32_bf16 v[104:107], a[160:163], a[72:75], v[104:107]
    s_waitcnt vmcnt(14) lgkmcnt(5)
    v_add_f32 v169, v169, v171
    v_bitop3_b32 v3, v3, v197, s88 bitop3:0xf6
    v_mfma_f32_16x16x32_bf16 v[108:111], a[164:167], a[72:75], v[108:111]
    ds_read_b128 a[72:75], v21 offset:32768
    v_bitop3_b32 v3, v3, v201, s88 bitop3:0xf6
    v_mfma_f32_16x16x32_bf16 v[40:43], a[168:171], a[40:43], v[40:43]
    s_add_u32 s72, s72, 8192
    s_cmp_eq_u32 s72, s73
    s_cselect_b32 s72, s80, s72
    v_mfma_f32_16x16x32_bf16 v[44:47], a[172:175], a[40:43], v[44:47]
    ds_read_b128 a[40:43], v22 offset:0
    v_mfma_f32_16x16x32_bf16 v[48:51], a[168:171], a[44:47], v[48:51]
    buffer_load_dwordx4 a[224:227], v26, s[24:27], s72 offen sc1
    v_mfma_f32_16x16x32_bf16 v[52:55], a[172:175], a[44:47], v[52:55]
    ds_read_b128 a[44:47], v22 offset:4096
    v_mfma_f32_16x16x32_bf16 v[56:59], a[168:171], a[48:51], v[56:59]
    buffer_load_dwordx4 a[228:231], v29, s[24:27], s72 offen offset:1024 sc1
    v_mfma_f32_16x16x32_bf16 v[60:63], a[172:175], a[48:51], v[60:63]
    ds_read_b128 a[48:51], v22 offset:8192
    s_waitcnt lgkmcnt(6)
    v_mfma_f32_16x16x32_bf16 v[64:67], a[168:171], a[52:55], v[64:67]
    v_permlane16_swap_b32 v168, v169
    v_mfma_f32_16x16x32_bf16 v[68:71], a[172:175], a[52:55], v[68:71]
    ds_read_b128 a[52:55], v22 offset:12288
    v_add_f32 v168, v168, v169
    v_mfma_f32_16x16x32_bf16 v[72:75], a[168:171], a[56:59], v[72:75]
    buffer_load_dwordx4 v238, s[8:11], s7 offen offset:2048 lds
    v_mfma_f32_16x16x32_bf16 v[76:79], a[172:175], a[56:59], v[76:79]
    ds_read_b128 a[56:59], v22 offset:16384
    v_mfma_f32_16x16x32_bf16 v[80:83], a[168:171], a[60:63], v[80:83]
    s_waitcnt lgkmcnt(5)
    v_mfma_f32_16x16x32_bf16 v[84:87], a[172:175], a[60:63], v[84:87]
    ds_read_b128 a[60:63], v22 offset:20480
    v_mfma_f32_16x16x32_bf16 v[88:91], a[168:171], a[64:67], v[88:91]
    buffer_load_dwordx4 v239, s[8:11], s7 offen offset:3072 lds
    v_mfma_f32_16x16x32_bf16 v[92:95], a[172:175], a[64:67], v[92:95]
    ds_read_b128 a[64:67], v22 offset:24576
    v_mfma_f32_16x16x32_bf16 v[96:99], a[168:171], a[68:71], v[96:99]
    ds_write_b32 v12, v168
    v_mfma_f32_16x16x32_bf16 v[100:103], a[172:175], a[68:71], v[100:103]
    ds_read_b128 a[68:71], v22 offset:28672
    v_bitop3_b32 v3, v3, v205, s88 bitop3:0xf6
    v_mfma_f32_16x16x32_bf16 v[104:107], a[168:171], a[72:75], v[104:107]
    s_waitcnt vmcnt(16) lgkmcnt(6)
    v_mfma_f32_16x16x32_bf16 v[108:111], a[172:175], a[72:75], v[108:111]
    ds_read_b128 a[72:75], v22 offset:32768
    v_mfma_f32_16x16x32_bf16 v[40:43], a[176:179], a[40:43], v[40:43]
    s_add_u32 s72, s72, 8192
    v_add_u32 v20, 0x12000, v20
    v_add_u32 v21, 0x12000, v21
    v_mfma_f32_16x16x32_bf16 v[44:47], a[180:183], a[40:43], v[44:47]
    ds_read_b128 a[40:43], v23 offset:0
    v_add_u32 v22, 0x12000, v22
    v_mfma_f32_16x16x32_bf16 v[48:51], a[176:179], a[44:47], v[48:51]
    buffer_load_dwordx4 a[232:235], v26, s[24:27], s72 offen sc1
    v_mfma_f32_16x16x32_bf16 v[52:55], a[180:183], a[44:47], v[52:55]
    ds_read_b128 a[44:47], v23 offset:4096
    v_mfma_f32_16x16x32_bf16 v[56:59], a[176:179], a[48:51], v[56:59]
    buffer_load_dwordx4 a[236:239], v29, s[24:27], s72 offen offset:1024 sc1
    v_mfma_f32_16x16x32_bf16 v[60:63], a[180:183], a[48:51], v[60:63]
    ds_read_b128 a[48:51], v23 offset:8192
    s_waitcnt lgkmcnt(7)
    v_mfma_f32_16x16x32_bf16 v[64:67], a[176:179], a[52:55], v[64:67]
    ds_read_b128 v[220:223], v5 offset:0
    s_add_u32 m0, m0, 4096
    v_mfma_f32_16x16x32_bf16 v[68:71], a[180:183], a[52:55], v[68:71]
    ds_read_b128 a[52:55], v23 offset:12288
    s_add_u32 s7, s7, 20480
    v_mfma_f32_16x16x32_bf16 v[72:75], a[176:179], a[56:59], v[72:75]
    buffer_load_dwordx4 v236, s[8:11], s7 offen offset:0 lds
    v_mfma_f32_16x16x32_bf16 v[76:79], a[180:183], a[56:59], v[76:79]
    ds_read_b128 a[56:59], v23 offset:16384
    v_bitop3_b32 v3, v3, v209, s88 bitop3:0xf6
    v_mfma_f32_16x16x32_bf16 v[80:83], a[176:179], a[60:63], v[80:83]
    s_waitcnt lgkmcnt(6)
    v_mfma_f32_16x16x32_bf16 v[84:87], a[180:183], a[60:63], v[84:87]
    ds_read_b128 a[60:63], v23 offset:20480
    v_mfma_f32_16x16x32_bf16 v[88:91], a[176:179], a[64:67], v[88:91]
    buffer_load_dwordx4 v237, s[8:11], s7 offen offset:1024 lds
    v_mfma_f32_16x16x32_bf16 v[92:95], a[180:183], a[64:67], v[92:95]
    ds_read_b128 a[64:67], v23 offset:24576
    v_mfma_f32_16x16x32_bf16 v[96:99], a[176:179], a[68:71], v[96:99]
    ds_read_b128 v[224:227], v5 offset:16
    v_bitop3_b32 v3, v3, v213, s88 bitop3:0xf6
    v_mfma_f32_16x16x32_bf16 v[100:103], a[180:183], a[68:71], v[100:103]
    ds_read_b128 a[68:71], v23 offset:28672
    v_mfma_f32_16x16x32_bf16 v[104:107], a[176:179], a[72:75], v[104:107]
    s_waitcnt vmcnt(18) lgkmcnt(7)
    v_mfma_f32_16x16x32_bf16 v[108:111], a[180:183], a[72:75], v[108:111]
    ds_read_b128 a[72:75], v23 offset:32768
    v_mfma_f32_16x16x32_bf16 v[40:43], a[184:187], a[40:43], v[40:43]
    s_add_u32 s72, s72, 8192
    v_add_u32 v23, 0x12000, v23
    v_mfma_f32_16x16x32_bf16 v[44:47], a[188:191], a[40:43], v[44:47]
    ds_read_b128 a[40:43], v20 offset:0
    v_mfma_f32_16x16x32_bf16 v[48:51], a[184:187], a[44:47], v[48:51]
    buffer_load_dwordx4 a[240:243], v26, s[24:27], s72 offen sc1
    v_mfma_f32_16x16x32_bf16 v[52:55], a[188:191], a[44:47], v[52:55]
    ds_read_b128 a[44:47], v20 offset:4096
    v_mfma_f32_16x16x32_bf16 v[56:59], a[184:187], a[48:51], v[56:59]
    buffer_load_dwordx4 a[244:247], v29, s[24:27], s72 offen offset:1024 sc1
    v_mfma_f32_16x16x32_bf16 v[60:63], a[188:191], a[48:51], v[60:63]
    ds_read_b128 a[48:51], v20 offset:8192
    s_waitcnt lgkmcnt(7)
    v_mfma_f32_16x16x32_bf16 v[64:67], a[184:187], a[52:55], v[64:67]
    ds_read_b128 v[228:231], v5 offset:32
    v_bitop3_b32 v3, v3, v217, s88 bitop3:0xf6
    v_mfma_f32_16x16x32_bf16 v[68:71], a[188:191], a[52:55], v[68:71]
    ds_read_b128 a[52:55], v20 offset:12288
    v_mfma_f32_16x16x32_bf16 v[72:75], a[184:187], a[56:59], v[72:75]
    buffer_load_dwordx4 v238, s[8:11], s7 offen offset:2048 lds
    v_mfma_f32_16x16x32_bf16 v[76:79], a[188:191], a[56:59], v[76:79]
    ds_read_b128 a[56:59], v20 offset:16384
    v_mfma_f32_16x16x32_bf16 v[80:83], a[184:187], a[60:63], v[80:83]
    s_waitcnt lgkmcnt(6)
    v_mfma_f32_16x16x32_bf16 v[84:87], a[188:191], a[60:63], v[84:87]
    ds_read_b128 a[60:63], v20 offset:20480
    v_mfma_f32_16x16x32_bf16 v[88:91], a[184:187], a[64:67], v[88:91]
    buffer_load_dwordx4 v239, s[8:11], s7 offen offset:3072 lds
    v_mfma_f32_16x16x32_bf16 v[92:95], a[188:191], a[64:67], v[92:95]
    ds_read_b128 a[64:67], v20 offset:24576
    v_mfma_f32_16x16x32_bf16 v[96:99], a[184:187], a[68:71], v[96:99]
    ds_read_b128 v[232:235], v5 offset:48
    v_cmp_ne_u32 vcc, 0, v3
    v_mfma_f32_16x16x32_bf16 v[100:103], a[188:191], a[68:71], v[100:103]
    ds_read_b128 a[68:71], v20 offset:28672
    v_mfma_f32_16x16x32_bf16 v[104:107], a[184:187], a[72:75], v[104:107]
    s_waitcnt vmcnt(20) lgkmcnt(7)
    s_cmp_eq_u64 vcc, 0
    s_cselect_b32 s88, 1, 0
    v_mfma_f32_16x16x32_bf16 v[108:111], a[188:191], a[72:75], v[108:111]
    ds_read_b128 a[72:75], v20 offset:32768
    v_mul_u32_u24 v13, 0x30000, v15
    v_mfma_f32_16x16x32_bf16 v[40:43], a[192:195], a[40:43], v[40:43]
    s_add_u32 s72, s72, 8192
    v_lshl_add_u32 v13, v14, 4, v13
    v_accvgpr_write_b32 a80, -1
    v_mfma_f32_16x16x32_bf16 v[44:47], a[196:199], a[40:43], v[44:47]
    ds_read_b128 a[40:43], v21 offset:0
    v_accvgpr_write_b32 a81, -1
    v_mfma_f32_16x16x32_bf16 v[48:51], a[192:195], a[44:47], v[48:51]
    buffer_load_dwordx4 a[248:251], v26, s[24:27], s72 offen sc1
    v_mfma_f32_16x16x32_bf16 v[52:55], a[196:199], a[44:47], v[52:55]
    ds_read_b128 a[44:47], v21 offset:4096
    v_accvgpr_write_b32 a82, -1
    v_mfma_f32_16x16x32_bf16 v[56:59], a[192:195], a[48:51], v[56:59]
    buffer_load_dwordx4 a[252:255], v29, s[24:27], s72 offen offset:1024 sc1
    v_mfma_f32_16x16x32_bf16 v[60:63], a[196:199], a[48:51], v[60:63]
    ds_read_b128 a[48:51], v21 offset:8192
    s_waitcnt lgkmcnt(7)
    v_mfma_f32_16x16x32_bf16 v[64:67], a[192:195], a[52:55], v[64:67]
    s_add_u32 m0, s78, 73728
    v_accvgpr_write_b32 a83, -1
    v_fma_f32 v112, v184, v220, v221
    v_mfma_f32_16x16x32_bf16 v[68:71], a[196:199], a[52:55], v[68:71]
    ds_read_b128 a[52:55], v21 offset:12288
    v_fma_f32 v113, v184, v224, v225
    v_mfma_f32_16x16x32_bf16 v[72:75], a[192:195], a[56:59], v[72:75]
    buffer_load_dwordx4 v240, s[8:11], s77 offen lds
    v_mfma_f32_16x16x32_bf16 v[76:79], a[196:199], a[56:59], v[76:79]
    ds_read_b128 a[56:59], v21 offset:16384
    v_fma_f32 v114, v184, v228, v229
    v_mfma_f32_16x16x32_bf16 v[80:83], a[192:195], a[60:63], v[80:83]
    s_waitcnt lgkmcnt(5)
    s_add_u32 m0, s63, 0
    s_add_u32 s7, s64, 0
    v_mfma_f32_16x16x32_bf16 v[84:87], a[196:199], a[60:63], v[84:87]
    ds_read_b128 a[60:63], v21 offset:20480
    v_fma_f32 v115, v184, v232, v233
    v_mfma_f32_16x16x32_bf16 v[88:91], a[192:195], a[64:67], v[88:91]
    buffer_load_dwordx4 v26, s[24:27], s7 offen offset:0 sc1 lds
    v_mfma_f32_16x16x32_bf16 v[92:95], a[196:199], a[64:67], v[92:95]
    ds_read_b128 a[64:67], v21 offset:24576
    v_fma_f32 v116, v184, v222, v223
    v_mfma_f32_16x16x32_bf16 v[96:99], a[192:195], a[68:71], v[96:99]
    v_fma_f32 v117, v184, v226, v227
    v_fma_f32 v118, v184, v230, v231
    v_mfma_f32_16x16x32_bf16 v[100:103], a[196:199], a[68:71], v[100:103]
    ds_read_b128 a[68:71], v21 offset:28672
    v_fma_f32 v119, v184, v234, v235
    v_mfma_f32_16x16x32_bf16 v[104:107], a[192:195], a[72:75], v[104:107]
    s_waitcnt vmcnt(22) lgkmcnt(5)
    v_fma_f32 v120, v188, v220, v221
    v_fma_f32 v121, v188, v224, v225
    v_mfma_f32_16x16x32_bf16 v[108:111], a[196:199], a[72:75], v[108:111]
    ds_read_b128 a[72:75], v21 offset:32768
    v_fma_f32 v122, v188, v228, v229
    v_mfma_f32_16x16x32_bf16 v[40:43], a[200:203], a[40:43], v[40:43]
    buffer_load_dwordx4 v26, s[24:27], s7 offen offset:1024 sc1 lds
    v_mfma_f32_16x16x32_bf16 v[44:47], a[204:207], a[40:43], v[44:47]
    ds_read_b128 a[40:43], v22 offset:0
    v_fma_f32 v123, v188, v232, v233
    v_mfma_f32_16x16x32_bf16 v[48:51], a[200:203], a[44:47], v[48:51]
    v_fma_f32 v124, v188, v222, v223
    v_fma_f32 v125, v188, v226, v227
    v_mfma_f32_16x16x32_bf16 v[52:55], a[204:207], a[44:47], v[52:55]
    ds_read_b128 a[44:47], v22 offset:4096
    v_fma_f32 v126, v188, v230, v231
    v_mfma_f32_16x16x32_bf16 v[56:59], a[200:203], a[48:51], v[56:59]
    s_waitcnt lgkmcnt(5)
    v_fma_f32 v127, v188, v234, v235
    v_fma_f32 v128, v192, v220, v221
    v_mfma_f32_16x16x32_bf16 v[60:63], a[204:207], a[48:51], v[60:63]
    ds_read_b128 a[48:51], v22 offset:8192
    v_fma_f32 v129, v192, v224, v225
    v_mfma_f32_16x16x32_bf16 v[64:67], a[200:203], a[52:55], v[64:67]
    buffer_load_dwordx4 v26, s[24:27], s7 offen offset:2048 sc1 lds
    v_mfma_f32_16x16x32_bf16 v[68:71], a[204:207], a[52:55], v[68:71]
    ds_read_b128 a[52:55], v22 offset:12288
    v_fma_f32 v130, v192, v228, v229
    v_mfma_f32_16x16x32_bf16 v[72:75], a[200:203], a[56:59], v[72:75]
    v_fma_f32 v131, v192, v232, v233
    v_fma_f32 v132, v192, v222, v223
    v_mfma_f32_16x16x32_bf16 v[76:79], a[204:207], a[56:59], v[76:79]
    ds_read_b128 a[56:59], v22 offset:16384
    v_fma_f32 v133, v192, v226, v227
    v_mfma_f32_16x16x32_bf16 v[80:83], a[200:203], a[60:63], v[80:83]
    s_waitcnt lgkmcnt(5)
    v_fma_f32 v134, v192, v230, v231
    v_fma_f32 v135, v192, v234, v235
    v_mfma_f32_16x16x32_bf16 v[84:87], a[204:207], a[60:63], v[84:87]
    ds_read_b128 a[60:63], v22 offset:20480
    v_fma_f32 v136, v196, v220, v221
    v_mfma_f32_16x16x32_bf16 v[88:91], a[200:203], a[64:67], v[88:91]
    buffer_load_dwordx4 v26, s[24:27], s7 offen offset:3072 sc1 lds
    v_mfma_f32_16x16x32_bf16 v[92:95], a[204:207], a[64:67], v[92:95]
    ds_read_b128 a[64:67], v22 offset:24576
    v_fma_f32 v137, v196, v224, v225
    v_mfma_f32_16x16x32_bf16 v[96:99], a[200:203], a[68:71], v[96:99]
    v_fma_f32 v138, v196, v228, v229
    v_fma_f32 v139, v196, v232, v233
    v_mfma_f32_16x16x32_bf16 v[100:103], a[204:207], a[68:71], v[100:103]
    ds_read_b128 a[68:71], v22 offset:28672
    v_fma_f32 v140, v196, v222, v223
    v_mfma_f32_16x16x32_bf16 v[104:107], a[200:203], a[72:75], v[104:107]
    s_waitcnt vmcnt(23) lgkmcnt(5)
    v_fma_f32 v141, v196, v226, v227
    v_fma_f32 v142, v196, v230, v231
    v_mfma_f32_16x16x32_bf16 v[108:111], a[204:207], a[72:75], v[108:111]
    ds_read_b128 a[72:75], v22 offset:32768
    v_fma_f32 v143, v196, v234, v235
    v_mfma_f32_16x16x32_bf16 v[40:43], a[208:211], a[40:43], v[40:43]
    s_add_u32 m0, s63, 4096
    s_add_u32 s7, s64, 4096
    v_add_u32 v20, 0xffff7000, v20
    v_mfma_f32_16x16x32_bf16 v[44:47], a[212:215], a[40:43], v[44:47]
    ds_read_b128 a[40:43], v23 offset:0
    v_add_u32 v21, 0xffff7000, v21
    v_mfma_f32_16x16x32_bf16 v[48:51], a[208:211], a[44:47], v[48:51]
    buffer_load_dwordx4 v26, s[24:27], s7 offen offset:0 sc1 lds
    v_mfma_f32_16x16x32_bf16 v[52:55], a[212:215], a[44:47], v[52:55]
    ds_read_b128 a[44:47], v23 offset:4096
    v_add_u32 v22, 0xffff7000, v22
    v_mfma_f32_16x16x32_bf16 v[56:59], a[208:211], a[48:51], v[56:59]
    s_waitcnt lgkmcnt(5)
    v_fma_f32 v144, v200, v220, v221
    v_fma_f32 v145, v200, v224, v225
    v_mfma_f32_16x16x32_bf16 v[60:63], a[212:215], a[48:51], v[60:63]
    ds_read_b128 a[48:51], v23 offset:8192
    v_fma_f32 v146, v200, v228, v229
    v_mfma_f32_16x16x32_bf16 v[64:67], a[208:211], a[52:55], v[64:67]
    buffer_load_dwordx4 v26, s[24:27], s7 offen offset:1024 sc1 lds
    v_mfma_f32_16x16x32_bf16 v[68:71], a[212:215], a[52:55], v[68:71]
    ds_read_b128 a[52:55], v23 offset:12288
    v_fma_f32 v147, v200, v232, v233
    v_mfma_f32_16x16x32_bf16 v[72:75], a[208:211], a[56:59], v[72:75]
    v_fma_f32 v148, v200, v222, v223
    v_fma_f32 v149, v200, v226, v227
    v_mfma_f32_16x16x32_bf16 v[76:79], a[212:215], a[56:59], v[76:79]
    ds_read_b128 a[56:59], v23 offset:16384
    v_fma_f32 v150, v200, v230, v231
    v_mfma_f32_16x16x32_bf16 v[80:83], a[208:211], a[60:63], v[80:83]
    s_waitcnt lgkmcnt(5)
    v_fma_f32 v151, v200, v234, v235
    v_fma_f32 v152, v204, v220, v221
    v_mfma_f32_16x16x32_bf16 v[84:87], a[212:215], a[60:63], v[84:87]
    ds_read_b128 a[60:63], v23 offset:20480
    v_fma_f32 v153, v204, v224, v225
    v_mfma_f32_16x16x32_bf16 v[88:91], a[208:211], a[64:67], v[88:91]
    buffer_load_dwordx4 v26, s[24:27], s7 offen offset:2048 sc1 lds
    v_mfma_f32_16x16x32_bf16 v[92:95], a[212:215], a[64:67], v[92:95]
    ds_read_b128 a[64:67], v23 offset:24576
    v_fma_f32 v154, v204, v228, v229
    v_mfma_f32_16x16x32_bf16 v[96:99], a[208:211], a[68:71], v[96:99]
    v_fma_f32 v155, v204, v232, v233
    v_fma_f32 v156, v204, v222, v223
    v_mfma_f32_16x16x32_bf16 v[100:103], a[212:215], a[68:71], v[100:103]
    ds_read_b128 a[68:71], v23 offset:28672
    v_fma_f32 v157, v204, v226, v227
    v_mfma_f32_16x16x32_bf16 v[104:107], a[208:211], a[72:75], v[104:107]
    s_waitcnt vmcnt(24) lgkmcnt(5)
    v_fma_f32 v158, v204, v230, v231
    v_fma_f32 v159, v204, v234, v235
    v_mfma_f32_16x16x32_bf16 v[108:111], a[212:215], a[72:75], v[108:111]
    ds_read_b128 a[72:75], v23 offset:32768
    v_fma_f32 v160, v208, v220, v221
    v_mfma_f32_16x16x32_bf16 v[40:43], a[216:219], a[40:43], v[40:43]
    buffer_load_dwordx4 v26, s[24:27], s7 offen offset:3072 sc1 lds
    v_mfma_f32_16x16x32_bf16 v[44:47], a[220:223], a[40:43], v[44:47]
    v_add_u32 v23, 0xffff7000, v23
    v_fma_f32 v161, v208, v224, v225
    v_mfma_f32_16x16x32_bf16 v[48:51], a[216:219], a[44:47], v[48:51]
    s_add_u32 m0, s63, 8192
    v_fma_f32 v162, v208, v228, v229
    v_fma_f32 v163, v208, v232, v233
    v_mfma_f32_16x16x32_bf16 v[52:55], a[220:223], a[44:47], v[52:55]
    s_add_u32 s7, s64, 8192
    v_fma_f32 v164, v208, v222, v223
    v_fma_f32 v165, v208, v226, v227
    v_mfma_f32_16x16x32_bf16 v[56:59], a[216:219], a[48:51], v[56:59]
    s_waitcnt lgkmcnt(3)
    v_fma_f32 v166, v208, v230, v231
    v_fma_f32 v167, v208, v234, v235
    v_mfma_f32_16x16x32_bf16 v[60:63], a[220:223], a[48:51], v[60:63]
    v_fma_f32 v168, v212, v220, v221
    v_fma_f32 v169, v212, v224, v225
    v_mfma_f32_16x16x32_bf16 v[64:67], a[216:219], a[52:55], v[64:67]
    buffer_load_dwordx4 v26, s[24:27], s7 offen offset:0 sc1 lds
    v_mfma_f32_16x16x32_bf16 v[68:71], a[220:223], a[52:55], v[68:71]
    s_waitcnt vmcnt(9)
    s_waitcnt lgkmcnt(0)
    s_barrier
    ds_read_b128 a[40:43], v20 offset:0
    ds_read_b128 a[44:47], v21 offset:0
    ds_read_b128 a[48:51], v22 offset:0
    ds_read_b128 a[52:55], v23 offset:0
    v_mfma_f32_16x16x32_bf16 v[72:75], a[216:219], a[56:59], v[72:75]
    v_fma_f32 v170, v212, v228, v229
    v_fma_f32 v171, v212, v232, v233
    v_mfma_f32_16x16x32_bf16 v[76:79], a[220:223], a[56:59], v[76:79]
    ds_read_b128 a[56:59], v20 offset:4096
    v_fma_f32 v172, v212, v222, v223
    v_mfma_f32_16x16x32_bf16 v[80:83], a[216:219], a[60:63], v[80:83]
    v_fma_f32 v173, v212, v226, v227
    v_fma_f32 v174, v212, v230, v231
    v_mfma_f32_16x16x32_bf16 v[84:87], a[220:223], a[60:63], v[84:87]
    ds_read_b128 a[60:63], v21 offset:4096
    v_fma_f32 v175, v212, v234, v235
    v_mfma_f32_16x16x32_bf16 v[88:91], a[216:219], a[64:67], v[88:91]
    buffer_load_dword a36, v10, s[36:39], 0 offen
    v_mfma_f32_16x16x32_bf16 v[92:95], a[220:223], a[64:67], v[92:95]
    ds_read_b128 a[64:67], v22 offset:4096
    v_fma_f32 v176, v216, v220, v221
    v_mfma_f32_16x16x32_bf16 v[96:99], a[216:219], a[68:71], v[96:99]
    v_fma_f32 v177, v216, v224, v225
    v_fma_f32 v178, v216, v228, v229
    v_mfma_f32_16x16x32_bf16 v[100:103], a[220:223], a[68:71], v[100:103]
    ds_read_b128 a[68:71], v23 offset:4096
    v_fma_f32 v179, v216, v232, v233
    v_mfma_f32_16x16x32_bf16 v[104:107], a[216:219], a[72:75], v[104:107]
    s_waitcnt lgkmcnt(5)
    v_fma_f32 v180, v216, v222, v223
    v_fma_f32 v181, v216, v226, v227
    v_mfma_f32_16x16x32_bf16 v[108:111], a[220:223], a[72:75], v[108:111]
    ds_read_b128 a[72:75], v20 offset:8192
    v_fma_f32 v182, v216, v230, v231
    v_mfma_f32_16x16x32_bf16 v[40:43], a[224:227], a[40:43], v[40:43]
    s_mov_b64 exec, 0x03ff03ff
    buffer_store_dwordx4 a[80:83], v13, s[24:27], s92 offen sc0 sc1
    s_mov_b64 exec, -1
    v_mfma_f32_16x16x32_bf16 v[44:47], a[228:231], a[40:43], v[44:47]
    ds_read_b128 a[40:43], v21 offset:8192
    v_fma_f32 v183, v216, v234, v235
    v_mfma_f32_16x16x32_bf16 v[40:43], a[232:235], a[44:47], v[40:43]
    v_mfma_f32_16x16x32_bf16 v[44:47], a[236:239], a[44:47], v[44:47]
    ds_read_b128 a[44:47], v22 offset:8192
    v_mfma_f32_16x16x32_bf16 v[40:43], a[240:243], a[48:51], v[40:43]
    s_waitcnt lgkmcnt(5)
    v_mfma_f32_16x16x32_bf16 v[44:47], a[244:247], a[48:51], v[44:47]
    ds_read_b128 a[48:51], v23 offset:8192
    v_mfma_f32_16x16x32_bf16 v[40:43], a[248:251], a[52:55], v[40:43]
    v_mfma_f32_16x16x32_bf16 v[44:47], a[252:255], a[52:55], v[44:47]
    ds_read_b128 a[52:55], v20 offset:12288
    v_mfma_f32_16x16x32_bf16 v[48:51], a[224:227], a[56:59], v[48:51]
    v_mfma_f32_16x16x32_bf16 v[52:55], a[228:231], a[56:59], v[52:55]
    ds_read_b128 a[56:59], v21 offset:12288
    v_mfma_f32_16x16x32_bf16 v[48:51], a[232:235], a[60:63], v[48:51]
    s_waitcnt lgkmcnt(5)
    s_nop 0
    v_fma_f32 v40, v40, v186, v112
    v_fma_f32 v41, v41, v186, v113
    v_fma_f32 v42, v42, v186, v114
    v_mfma_f32_16x16x32_bf16 v[52:55], a[236:239], a[60:63], v[52:55]
    ds_read_b128 a[60:63], v22 offset:12288
    v_fma_f32 v43, v43, v186, v115
    v_mfma_f32_16x16x32_bf16 v[48:51], a[240:243], a[64:67], v[48:51]
    v_fma_f32 v44, v44, v186, v116
    v_fma_f32 v45, v45, v186, v117
    v_mfma_f32_16x16x32_bf16 v[52:55], a[244:247], a[64:67], v[52:55]
    ds_read_b128 a[64:67], v23 offset:12288
    v_fma_f32 v46, v46, v186, v118
    v_mfma_f32_16x16x32_bf16 v[48:51], a[248:251], a[68:71], v[48:51]
    v_fma_f32 v47, v47, v186, v119
    v_cvt_pk_bf16_f32 v40, v40, v41
    v_mfma_f32_16x16x32_bf16 v[52:55], a[252:255], a[68:71], v[52:55]
    ds_read_b128 a[68:71], v20 offset:16384
    v_cvt_pk_bf16_f32 v41, v42, v43
    v_mfma_f32_16x16x32_bf16 v[56:59], a[224:227], a[72:75], v[56:59]
    s_waitcnt lgkmcnt(5)
    v_cvt_pk_bf16_f32 v42, v44, v45
    v_cvt_pk_bf16_f32 v43, v46, v47
    v_mfma_f32_16x16x32_bf16 v[60:63], a[228:231], a[72:75], v[60:63]
    ds_read_b128 a[72:75], v21 offset:16384
    v_mfma_f32_16x16x32_bf16 v[56:59], a[232:235], a[40:43], v[56:59]
    s_mov_b32 exec_hi, 0x1ff
    buffer_load_dword a76, v34, s[24:27], 0 offen
    s_mov_b64 exec, -1
    v_fma_f32 v48, v48, v190, v120
    v_mfma_f32_16x16x32_bf16 v[60:63], a[236:239], a[40:43], v[60:63]
    ds_read_b128 a[40:43], v22 offset:16384
    v_fma_f32 v49, v49, v190, v121
    v_fma_f32 v50, v50, v190, v122
    v_mfma_f32_16x16x32_bf16 v[56:59], a[240:243], a[44:47], v[56:59]
    ds_write_b64 v38, v[40:41] offset:0
    v_fma_f32 v51, v51, v190, v123
    v_mfma_f32_16x16x32_bf16 v[60:63], a[244:247], a[44:47], v[60:63]
    ds_read_b128 a[44:47], v23 offset:16384
    v_fma_f32 v52, v52, v190, v124
    v_mfma_f32_16x16x32_bf16 v[56:59], a[248:251], a[48:51], v[56:59]
    ds_write_b64 v38, v[42:43] offset:32
    v_mfma_f32_16x16x32_bf16 v[60:63], a[252:255], a[48:51], v[60:63]
    ds_read_b128 a[48:51], v20 offset:20480
    s_waitcnt lgkmcnt(8)
    v_mfma_f32_16x16x32_bf16 v[64:67], a[224:227], a[52:55], v[64:67]
    v_fma_f32 v53, v53, v190, v125
    v_fma_f32 v54, v54, v190, v126
    v_mfma_f32_16x16x32_bf16 v[68:71], a[228:231], a[52:55], v[68:71]
    ds_read_b128 a[52:55], v21 offset:20480
    v_fma_f32 v55, v55, v190, v127
    v_mfma_f32_16x16x32_bf16 v[64:67], a[232:235], a[56:59], v[64:67]
    v_cvt_pk_bf16_f32 v48, v48, v49
    v_cvt_pk_bf16_f32 v49, v50, v51
    v_cvt_pk_bf16_f32 v50, v52, v53
    v_mfma_f32_16x16x32_bf16 v[68:71], a[236:239], a[56:59], v[68:71]
    ds_read_b128 a[56:59], v22 offset:20480
    v_cvt_pk_bf16_f32 v51, v54, v55
    v_mfma_f32_16x16x32_bf16 v[64:67], a[240:243], a[60:63], v[64:67]
    ds_write_b64 v38, v[48:49] offset:4352
    v_fma_f32 v56, v56, v194, v128
    v_mfma_f32_16x16x32_bf16 v[68:71], a[244:247], a[60:63], v[68:71]
    ds_read_b128 a[60:63], v23 offset:20480
    s_waitcnt lgkmcnt(9)
    v_fma_f32 v57, v57, v194, v129
    v_mfma_f32_16x16x32_bf16 v[64:67], a[248:251], a[64:67], v[64:67]
    ds_write_b64 v38, v[50:51] offset:4384
    v_fma_f32 v58, v58, v194, v130
    v_mfma_f32_16x16x32_bf16 v[68:71], a[252:255], a[64:67], v[68:71]
    ds_read_b128 a[64:67], v20 offset:24576
    v_fma_f32 v59, v59, v194, v131
    v_mfma_f32_16x16x32_bf16 v[72:75], a[224:227], a[68:71], v[72:75]
    v_fma_f32 v60, v60, v194, v132
    v_fma_f32 v61, v61, v194, v133
    v_mfma_f32_16x16x32_bf16 v[76:79], a[228:231], a[68:71], v[76:79]
    ds_read_b128 a[68:71], v21 offset:24576
    v_fma_f32 v62, v62, v194, v134
    v_mfma_f32_16x16x32_bf16 v[72:75], a[232:235], a[72:75], v[72:75]
    s_waitcnt lgkmcnt(7)
    v_fma_f32 v63, v63, v194, v135
    v_cvt_pk_bf16_f32 v56, v56, v57
    v_cvt_pk_bf16_f32 v57, v58, v59
    v_mfma_f32_16x16x32_bf16 v[76:79], a[236:239], a[72:75], v[76:79]
    ds_read_b128 a[72:75], v22 offset:24576
    v_cvt_pk_bf16_f32 v58, v60, v61
    v_cvt_pk_bf16_f32 v59, v62, v63
    v_mfma_f32_16x16x32_bf16 v[72:75], a[240:243], a[40:43], v[72:75]
    ds_write_b64 v38, v[56:57] offset:8704
    v_fma_f32 v64, v64, v198, v136
    v_mfma_f32_16x16x32_bf16 v[76:79], a[244:247], a[40:43], v[76:79]
    ds_read_b128 a[40:43], v23 offset:24576
    s_add_u32 m0, s63, 36864
    v_fma_f32 v65, v65, v198, v137
    v_mfma_f32_16x16x32_bf16 v[72:75], a[248:251], a[44:47], v[72:75]
    ds_write_b64 v38, v[58:59] offset:8736
    v_fma_f32 v66, v66, v198, v138
    v_mfma_f32_16x16x32_bf16 v[76:79], a[252:255], a[44:47], v[76:79]
    ds_read_b128 a[44:47], v20 offset:28672
    s_add_u32 s7, s64, 36864
    v_fma_f32 v67, v67, v198, v139
    v_mfma_f32_16x16x32_bf16 v[80:83], a[224:227], a[48:51], v[80:83]
    buffer_load_dwordx4 v26, s[24:27], s7 offen offset:0 sc1 lds
    v_mfma_f32_16x16x32_bf16 v[84:87], a[228:231], a[48:51], v[84:87]
    ds_read_b128 a[48:51], v21 offset:28672
    s_waitcnt lgkmcnt(9)
    v_mfma_f32_16x16x32_bf16 v[80:83], a[232:235], a[52:55], v[80:83]
    v_fma_f32 v68, v68, v198, v140
    v_fma_f32 v69, v69, v198, v141
    v_fma_f32 v70, v70, v198, v142
    v_mfma_f32_16x16x32_bf16 v[84:87], a[236:239], a[52:55], v[84:87]
    ds_read_b128 a[52:55], v22 offset:28672
    v_fma_f32 v71, v71, v198, v143
    v_cvt_pk_bf16_f32 v64, v64, v65
    v_mfma_f32_16x16x32_bf16 v[80:83], a[240:243], a[56:59], v[80:83]
    v_cvt_pk_bf16_f32 v65, v66, v67
    v_cvt_pk_bf16_f32 v66, v68, v69
    v_cvt_pk_bf16_f32 v67, v70, v71
    v_mfma_f32_16x16x32_bf16 v[84:87], a[244:247], a[56:59], v[84:87]
    ds_read_b128 a[56:59], v23 offset:28672
    v_fma_f32 v72, v72, v202, v144
    v_fma_f32 v73, v73, v202, v145
    v_mfma_f32_16x16x32_bf16 v[80:83], a[248:251], a[60:63], v[80:83]
    ds_write_b64 v38, v[64:65] offset:13056
    v_fma_f32 v74, v74, v202, v146
    v_mfma_f32_16x16x32_bf16 v[84:87], a[252:255], a[60:63], v[84:87]
    ds_read_b128 a[60:63], v20 offset:32768
    s_waitcnt lgkmcnt(9)
    v_fma_f32 v75, v75, v202, v147
    v_mfma_f32_16x16x32_bf16 v[88:91], a[224:227], a[64:67], v[88:91]
    ds_write_b64 v38, v[66:67] offset:13088
    v_mfma_f32_16x16x32_bf16 v[92:95], a[228:231], a[64:67], v[92:95]
    ds_read_b128 a[64:67], v21 offset:32768
    v_fma_f32 v76, v76, v202, v148
    v_mfma_f32_16x16x32_bf16 v[88:91], a[232:235], a[68:71], v[88:91]
    v_fma_f32 v77, v77, v202, v149
    v_fma_f32 v78, v78, v202, v150
    v_fma_f32 v79, v79, v202, v151
    v_mfma_f32_16x16x32_bf16 v[92:95], a[236:239], a[68:71], v[92:95]
    ds_read_b128 a[68:71], v22 offset:32768
    v_cvt_pk_bf16_f32 v72, v72, v73
    v_cvt_pk_bf16_f32 v73, v74, v75
    v_mfma_f32_16x16x32_bf16 v[88:91], a[240:243], a[72:75], v[88:91]
    s_waitcnt lgkmcnt(7)
    v_cvt_pk_bf16_f32 v74, v76, v77
    v_cvt_pk_bf16_f32 v75, v78, v79
    v_mfma_f32_16x16x32_bf16 v[92:95], a[244:247], a[72:75], v[92:95]
    ds_read_b128 a[72:75], v23 offset:32768
    v_fma_f32 v80, v80, v206, v152
    v_fma_f32 v81, v81, v206, v153
    v_mfma_f32_16x16x32_bf16 v[88:91], a[248:251], a[40:43], v[88:91]
    buffer_load_dwordx4 v26, s[24:27], s7 offen offset:1024 sc1 lds
    v_fma_f32 v82, v82, v206, v154
    v_mfma_f32_16x16x32_bf16 v[92:95], a[252:255], a[40:43], v[92:95]
    ds_write_b64 v38, v[72:73] offset:17408
    v_fma_f32 v83, v83, v206, v155
    v_mfma_f32_16x16x32_bf16 v[96:99], a[224:227], a[44:47], v[96:99]
    ds_write_b64 v38, v[74:75] offset:17440
    v_mfma_f32_16x16x32_bf16 v[100:103], a[228:231], a[44:47], v[100:103]
    v_fma_f32 v84, v84, v206, v156
    v_fma_f32 v85, v85, v206, v157
    v_mfma_f32_16x16x32_bf16 v[96:99], a[232:235], a[48:51], v[96:99]
    s_waitcnt lgkmcnt(6)
    v_fma_f32 v86, v86, v206, v158
    v_fma_f32 v87, v87, v206, v159
    v_cvt_pk_bf16_f32 v80, v80, v81
    v_mfma_f32_16x16x32_bf16 v[100:103], a[236:239], a[48:51], v[100:103]
    v_cvt_pk_bf16_f32 v81, v82, v83
    v_cvt_pk_bf16_f32 v82, v84, v85
    v_cvt_pk_bf16_f32 v83, v86, v87
    v_mfma_f32_16x16x32_bf16 v[96:99], a[240:243], a[52:55], v[96:99]
    ds_write_b64 v38, v[80:81] offset:21760
    v_fma_f32 v88, v88, v210, v160
    v_mfma_f32_16x16x32_bf16 v[100:103], a[244:247], a[52:55], v[100:103]
    ds_write_b64 v38, v[82:83] offset:21792
    v_fma_f32 v89, v89, v210, v161
    v_mfma_f32_16x16x32_bf16 v[96:99], a[248:251], a[56:59], v[96:99]
    v_fma_f32 v90, v90, v210, v162
    v_fma_f32 v91, v91, v210, v163
    v_mfma_f32_16x16x32_bf16 v[100:103], a[252:255], a[56:59], v[100:103]
    v_fma_f32 v92, v92, v210, v164
    v_fma_f32 v93, v93, v210, v165
    v_mfma_f32_16x16x32_bf16 v[104:107], a[224:227], a[60:63], v[104:107]
    s_waitcnt lgkmcnt(4)
    v_fma_f32 v94, v94, v210, v166
    v_fma_f32 v95, v95, v210, v167
    v_mfma_f32_16x16x32_bf16 v[108:111], a[228:231], a[60:63], v[108:111]
    v_cvt_pk_bf16_f32 v88, v88, v89
    v_cvt_pk_bf16_f32 v89, v90, v91
    v_mfma_f32_16x16x32_bf16 v[104:107], a[232:235], a[64:67], v[104:107]
    v_cvt_pk_bf16_f32 v90, v92, v93
    v_cvt_pk_bf16_f32 v91, v94, v95
    v_mfma_f32_16x16x32_bf16 v[108:111], a[236:239], a[64:67], v[108:111]
    ds_write_b64 v38, v[88:89] offset:26112
    v_fma_f32 v96, v96, v214, v168
    v_mfma_f32_16x16x32_bf16 v[104:107], a[240:243], a[68:71], v[104:107]
    ds_write_b64 v38, v[90:91] offset:26144
    v_fma_f32 v97, v97, v214, v169
    v_mfma_f32_16x16x32_bf16 v[108:111], a[244:247], a[68:71], v[108:111]
    v_fma_f32 v98, v98, v214, v170
    v_fma_f32 v99, v99, v214, v171
    v_mfma_f32_16x16x32_bf16 v[104:107], a[248:251], a[72:75], v[104:107]
    v_fma_f32 v100, v100, v214, v172
    v_fma_f32 v101, v101, v214, v173
    v_mfma_f32_16x16x32_bf16 v[108:111], a[252:255], a[72:75], v[108:111]
    v_fma_f32 v102, v102, v214, v174
    v_fma_f32 v103, v103, v214, v175
    v_cvt_pk_bf16_f32 v96, v96, v97
    v_cvt_pk_bf16_f32 v97, v98, v99
    v_cvt_pk_bf16_f32 v98, v100, v101
    v_cvt_pk_bf16_f32 v99, v102, v103
    ds_write_b64 v38, v[96:97] offset:30464
    ds_write_b64 v38, v[98:99] offset:30496
    v_pk_fma_f32 v[104:105], v[104:105], v[218:219], v[176:177] op_sel_hi:[1,0,1]
    v_pk_fma_f32 v[106:107], v[106:107], v[218:219], v[178:179] op_sel_hi:[1,0,1]
    v_pk_fma_f32 v[108:109], v[108:109], v[218:219], v[180:181] op_sel_hi:[1,0,1]
    v_pk_fma_f32 v[110:111], v[110:111], v[218:219], v[182:183] op_sel_hi:[1,0,1]
    v_cvt_pk_bf16_f32 v104, v104, v105
    v_cvt_pk_bf16_f32 v105, v106, v107
    v_cvt_pk_bf16_f32 v106, v108, v109
    v_cvt_pk_bf16_f32 v107, v110, v111
    ds_write_b64 v38, v[104:105] offset:34816
    ds_write_b64 v38, v[106:107] offset:34848
    buffer_load_dwordx4 v26, s[24:27], s7 offen offset:2048 sc1 lds
    s_waitcnt lgkmcnt(0)
    s_barrier
    ds_read_b128 v[40:43], v241 offset:0
    ds_read_b128 v[56:59], v242 offset:80
    ds_read_b128 v[72:75], v241 offset:80
    ds_read_b128 v[44:47], v241 offset:32
    ds_read_b128 v[60:63], v242 offset:112
    ds_read_b128 v[76:79], v241 offset:112
    ds_read_b128 v[48:51], v241 offset:272
    ds_read_b128 v[64:67], v242 offset:352
    ds_read_b128 v[80:83], v241 offset:352
    ds_read_b128 v[52:55], v241 offset:304
    ds_read_b128 v[68:71], v242 offset:384
    ds_read_b128 v[84:87], v241 offset:384
    buffer_load_dwordx4 v26, s[24:27], s7 offen offset:3072 sc1 lds
    s_add_u32 m0, s63, 40960
    s_add_u32 s7, s64, 40960
    buffer_load_dwordx4 v26, s[24:27], s7 offen offset:0 sc1 lds
    v_mov_b32 v184, 0x3f803f80
    v_mov_b32 v185, 0x3f803f80
    v_mov_b32 v186, 0x3f803f80
    v_mov_b32 v187, 0x3f803f80
    s_waitcnt lgkmcnt(11)
    v_cndmask_b32 v40, 0, v40, s[50:51]
    v_cndmask_b32 v41, 0, v41, s[50:51]
    v_cndmask_b32 v42, 0, v42, s[12:13]
    v_cndmask_b32 v43, 0, v43, s[12:13]
    s_waitcnt lgkmcnt(8)
    v_cndmask_b32 v44, 0, v44, s[74:75]
    v_cndmask_b32 v45, 0, v45, s[74:75]
    v_cndmask_b32 v46, 0, v46, s[50:51]
    v_cndmask_b32 v47, 0, v47, s[50:51]
    buffer_load_dwordx4 v26, s[24:27], s7 offen offset:1024 sc1 lds
    s_waitcnt lgkmcnt(5)
    v_cndmask_b32 v48, 0, v48, s[50:51]
    v_cndmask_b32 v49, 0, v49, s[50:51]
    v_cndmask_b32 v50, 0, v50, s[12:13]
    v_cndmask_b32 v51, 0, v51, s[12:13]
    s_waitcnt lgkmcnt(2)
    v_cndmask_b32 v52, 0, v52, s[74:75]
    v_cndmask_b32 v53, 0, v53, s[74:75]
    v_cndmask_b32 v54, 0, v54, s[50:51]
    v_cndmask_b32 v55, 0, v55, s[50:51]
    v_mfma_f32_16x16x32_bf16 v[144:147], v[56:59], v[40:43], v[6:9]
    v_mfma_f32_16x16x32_bf16 v[160:163], v[72:75], v[40:43], v[248:251]
    v_mfma_f32_16x16x32_bf16 v[148:151], v[60:63], v[44:47], v[6:9]
    v_mfma_f32_16x16x32_bf16 v[164:167], v[76:79], v[44:47], v[248:251]
    buffer_load_dwordx4 v26, s[24:27], s7 offen offset:2048 sc1 lds
    v_mfma_f32_16x16x32_bf16 v[152:155], v[64:67], v[48:51], v[6:9]
    v_mfma_f32_16x16x32_bf16 v[168:171], v[80:83], v[48:51], v[248:251]
    s_waitcnt lgkmcnt(1)
    v_mfma_f32_16x16x32_bf16 v[156:159], v[68:71], v[52:55], v[6:9]
    s_waitcnt lgkmcnt(0)
    v_mfma_f32_16x16x32_bf16 v[172:175], v[84:87], v[52:55], v[248:251]
    ds_read_b64_tr_b16 v[88:89], v244 offset:160
    ds_read_b64_tr_b16 v[90:91], v243 offset:160
    ds_read_b64_tr_b16 v[92:93], v244 offset:200
    ds_read_b64_tr_b16 v[94:95], v243 offset:200
    ds_read_b64_tr_b16 v[104:105], v246 offset:192
    ds_read_b64_tr_b16 v[106:107], v245 offset:192
    ds_read_b64_tr_b16 v[96:97], v244 offset:432
    ds_read_b64_tr_b16 v[98:99], v243 offset:432
    buffer_load_dwordx4 v26, s[24:27], s7 offen offset:3072 sc1 lds
    ds_read_b64_tr_b16 v[100:101], v244 offset:472
    ds_read_b64_tr_b16 v[102:103], v243 offset:472
    ds_read_b64_tr_b16 v[108:109], v246 offset:464
    ds_read_b64_tr_b16 v[110:111], v245 offset:464
    v_mul_u32_u24 v4, 1280, v15
    v_lshl_add_u32 v4, v14, 4, v4
    v_add_u32 v6, 61440, v4
    v_max_f32 v144, v144, v160
    v_max_f32 v145, v145, v161
    v_max_f32 v146, v146, v162
    v_max_f32 v147, v147, v163
    v_max_f32 v148, v148, v164
    s_add_u32 m0, s63, 45056
    s_add_u32 s7, s64, 45056
    buffer_load_dwordx4 v26, s[24:27], s7 offen offset:0 sc1 lds
    v_max_f32 v149, v149, v165
    v_max_f32 v150, v150, v166
    v_max_f32 v151, v151, v167
    v_max_f32 v152, v152, v168
    v_max_f32 v153, v153, v169
    v_max_f32 v154, v154, v170
    v_max_f32 v155, v155, v171
    v_max_f32 v156, v156, v172
    v_max_f32 v157, v157, v173
    v_max_f32 v158, v158, v174
    v_max_f32 v159, v159, v175
    v_max3_f32 v176, v144, v145, v146
    s_mul_i32 s63, s3, 7168
    s_add_u32 s64, s60, s63
    s_add_u32 m0, s63, 73728
    s_add_u32 s7, s64, 73728
    buffer_load_dwordx4 v26, s[24:27], s7 offen offset:0 sc1 lds
    v_max3_f32 v177, v148, v149, v150
    v_max3_f32 v178, v152, v153, v154
    v_max3_f32 v179, v156, v157, v158
    v_max_f32 v176, v176, v147
    v_max_f32 v177, v177, v151
    v_max_f32 v178, v178, v155
    v_max_f32 v179, v179, v159
    v_mov_b32 v180, v176
    v_mov_b32 v181, v177
    v_mov_b32 v182, v178
    v_mov_b32 v183, v179
    v_permlane16_swap_b32 v176, v180
    buffer_load_dwordx4 v26, s[24:27], s7 offen offset:1024 sc1 lds
    v_permlane16_swap_b32 v177, v181
    v_permlane16_swap_b32 v178, v182
    v_permlane16_swap_b32 v179, v183
    v_max_f32 v176, v176, v180
    v_max_f32 v177, v177, v181
    v_max_f32 v178, v178, v182
    v_max_f32 v179, v179, v183
    v_mov_b32 v180, v176
    v_mov_b32 v181, v177
    v_mov_b32 v182, v178
    v_mov_b32 v183, v179
    v_permlane32_swap_b32 v176, v180
    buffer_load_dwordx4 v26, s[24:27], s7 offen offset:2048 sc1 lds
    v_permlane32_swap_b32 v177, v181
    v_permlane32_swap_b32 v178, v182
    v_permlane32_swap_b32 v179, v183
    v_max_f32 v176, v176, v180
    v_max_f32 v177, v177, v181
    v_max_f32 v178, v178, v182
    v_max_f32 v179, v179, v183
    s_mov_b32 s55, 0x3ea52b5c
    v_mul_f32 v176, s55, v176
    v_mul_f32 v177, s55, v177
    v_mul_f32 v178, s55, v178
    v_mul_f32 v179, s55, v179
    buffer_load_dwordx4 v26, s[24:27], s7 offen offset:3072 sc1 lds
    v_fma_f32 v144, v144, s55, -v176
    v_fma_f32 v145, v145, s55, -v176
    v_fma_f32 v146, v146, s55, -v176
    v_fma_f32 v147, v147, s55, -v176
    v_fma_f32 v148, v148, s55, -v177
    v_fma_f32 v149, v149, s55, -v177
    v_fma_f32 v150, v150, s55, -v177
    v_fma_f32 v151, v151, s55, -v177
    v_fma_f32 v152, v152, s55, -v178
    v_fma_f32 v153, v153, s55, -v178
    v_fma_f32 v154, v154, s55, -v178
    v_fma_f32 v155, v155, s55, -v178
    s_add_u32 m0, s63, 77824
    s_add_u32 s7, s64, 77824
    buffer_load_dwordx4 v26, s[24:27], s7 offen offset:0 sc1 lds
    v_fma_f32 v156, v156, s55, -v179
    v_fma_f32 v157, v157, s55, -v179
    v_fma_f32 v158, v158, s55, -v179
    v_fma_f32 v159, v159, s55, -v179
    v_exp_f32 v144, v144
    v_exp_f32 v145, v145
    v_exp_f32 v146, v146
    v_exp_f32 v147, v147
    v_exp_f32 v148, v148
    v_exp_f32 v149, v149
    v_exp_f32 v150, v150
    v_exp_f32 v151, v151
    buffer_load_dwordx4 v26, s[24:27], s7 offen offset:1024 sc1 lds
    v_exp_f32 v152, v152
    v_exp_f32 v153, v153
    v_exp_f32 v154, v154
    v_exp_f32 v155, v155
    v_exp_f32 v156, v156
    v_exp_f32 v157, v157
    v_exp_f32 v158, v158
    v_exp_f32 v159, v159
    v_cvt_pk_bf16_f32 v144, v144, v145
    v_cvt_pk_bf16_f32 v145, v146, v147
    v_cvt_pk_bf16_f32 v148, v148, v149
    v_cvt_pk_bf16_f32 v149, v150, v151
    buffer_load_dwordx4 v26, s[24:27], s7 offen offset:2048 sc1 lds
    v_cvt_pk_bf16_f32 v152, v152, v153
    v_cvt_pk_bf16_f32 v153, v154, v155
    v_cvt_pk_bf16_f32 v156, v156, v157
    v_cvt_pk_bf16_f32 v157, v158, v159
    v_bfi_b32 v160, v19, 0, v144
    v_bfi_b32 v161, v36, 0, v145
    v_bfi_b32 v162, v37, 0, v144
    v_bfi_b32 v163, v254, 0, v145
    v_bfi_b32 v164, v19, 0, v148
    v_bfi_b32 v165, v36, 0, v149
    v_bfi_b32 v166, v37, 0, v148
    v_bfi_b32 v167, v254, 0, v149
    v_bfi_b32 v168, v19, 0, v152
    v_bfi_b32 v169, v36, 0, v153
    v_bfi_b32 v170, v37, 0, v152
    v_bfi_b32 v171, v254, 0, v153
    v_bfi_b32 v172, v19, 0, v156
    v_bfi_b32 v173, v36, 0, v157
    v_bfi_b32 v174, v37, 0, v156
    v_bfi_b32 v175, v254, 0, v157
    v_mfma_f32_16x16x32_bf16 v[72:75], v[184:187], v[160:163], 0
    v_mfma_f32_16x16x32_bf16 v[76:79], v[184:187], v[164:167], 0
    v_mfma_f32_16x16x32_bf16 v[80:83], v[184:187], v[168:171], 0
    v_mfma_f32_16x16x32_bf16 v[84:87], v[184:187], v[172:175], 0
    s_waitcnt lgkmcnt(10)
    v_mfma_f32_16x16x32_bf16 v[40:43], v[88:91], v[160:163], 0
    s_waitcnt lgkmcnt(8)
    v_mfma_f32_16x16x32_bf16 v[44:47], v[92:95], v[164:167], 0
    s_waitcnt lgkmcnt(4)
    v_mfma_f32_16x16x32_bf16 v[48:51], v[96:99], v[168:171], 0
    s_waitcnt lgkmcnt(2)
    v_mfma_f32_16x16x32_bf16 v[52:55], v[100:103], v[172:175], 0
    v_mfma_f32_16x16x32_bf16 v[56:59], v[104:107], v[160:163], 0
    v_mfma_f32_16x16x32_bf16 v[60:63], v[104:107], v[164:167], 0
    s_waitcnt lgkmcnt(0)
    v_mfma_f32_16x16x32_bf16 v[64:67], v[108:111], v[168:171], 0
    v_mfma_f32_16x16x32_bf16 v[68:71], v[108:111], v[172:175], 0
    v_rcp_f32 v72, v72
    v_rcp_f32 v76, v76
    v_rcp_f32 v80, v80
    v_rcp_f32 v84, v84
    v_pk_mul_f32 v[40:41], v[40:41], v[72:73] op_sel_hi:[1,0]
    v_pk_mul_f32 v[42:43], v[42:43], v[72:73] op_sel_hi:[1,0]
    v_pk_mul_f32 v[44:45], v[44:45], v[76:77] op_sel_hi:[1,0]
    v_pk_mul_f32 v[46:47], v[46:47], v[76:77] op_sel_hi:[1,0]
    v_pk_mul_f32 v[48:49], v[48:49], v[80:81] op_sel_hi:[1,0]
    v_pk_mul_f32 v[50:51], v[50:51], v[80:81] op_sel_hi:[1,0]
    v_pk_mul_f32 v[52:53], v[52:53], v[84:85] op_sel_hi:[1,0]
    v_pk_mul_f32 v[54:55], v[54:55], v[84:85] op_sel_hi:[1,0]
    v_cvt_pk_bf16_f32 v144, v40, v41
    v_cvt_pk_bf16_f32 v145, v42, v43
    v_cvt_pk_bf16_f32 v146, v44, v45
    v_cvt_pk_bf16_f32 v147, v46, v47
    v_cvt_pk_bf16_f32 v148, v48, v49
    v_cvt_pk_bf16_f32 v149, v50, v51
    v_cvt_pk_bf16_f32 v150, v52, v53
    v_cvt_pk_bf16_f32 v151, v54, v55
    s_add_u32 s55, s91, 20480
    s_cmp_eq_u32 s88, 0
    s_cbranch_scc1 L_gs_11
    buffer_store_dwordx4 v[144:147], v24, s[24:27], s91 offen
    buffer_store_dwordx4 v[148:151], v24, s[24:27], s55 offen
    s_branch L_ge_12
L_gs_11:
    buffer_store_dwordx4 v[144:147], v24, s[24:27], s91 offen sc0 sc1
    buffer_store_dwordx4 v[148:151], v24, s[24:27], s55 offen sc0 sc1
L_ge_12:
    s_nop 1
    v_cmp_eq_u32 vcc, 1, v15
    s_nop 1
    v_cndmask_b32 v56, v56, v60, vcc
    v_cndmask_b32 v57, v57, v61, vcc
    v_cndmask_b32 v58, v58, v62, vcc
    v_cndmask_b32 v59, v59, v63, vcc
    v_cndmask_b32 v72, v72, v76, vcc
    v_cmp_eq_u32 vcc, 2, v15
    s_nop 1
    v_cndmask_b32 v56, v56, v64, vcc
    v_cndmask_b32 v57, v57, v65, vcc
    v_cndmask_b32 v58, v58, v66, vcc
    v_cndmask_b32 v59, v59, v67, vcc
    v_cndmask_b32 v72, v72, v80, vcc
    v_cmp_eq_u32 vcc, 3, v15
    s_nop 1
    v_cndmask_b32 v56, v56, v68, vcc
    v_cndmask_b32 v57, v57, v69, vcc
    v_cndmask_b32 v58, v58, v70, vcc
    v_cndmask_b32 v59, v59, v71, vcc
    v_cndmask_b32 v72, v72, v84, vcc
    v_pk_mul_f32 v[56:57], v[56:57], v[72:73] op_sel_hi:[1,0]
    v_pk_mul_f32 v[58:59], v[58:59], v[72:73] op_sel_hi:[1,0]
    v_cvt_pk_bf16_f32 v152, v56, v57
    v_cvt_pk_bf16_f32 v153, v58, v59
    s_cmp_eq_u32 s88, 0
    s_cbranch_scc1 L_gs_13
    buffer_store_dwordx2 v[152:153], v25, s[24:27], s91 offen
    s_branch L_ge_14
L_gs_13:
    buffer_store_dwordx2 v[152:153], v25, s[24:27], s91 offen sc0 sc1
L_ge_14:
    s_nop 1
    v_mul_u32_u24 v7, 160, v14
    v_lshl_add_u32 v7, v15, 3, v7
    v_add_u32 v7, s58, v7
    v_mov_b32 v33, v7
    v_add_u32 v34, s58, v26
    s_waitcnt vmcnt(0)
    s_mov_b64 exec, 1
    s_cmp_eq_u32 s88, 0
    s_cbranch_scc1 L_gs_15
    buffer_store_dword v39, off, s[24:27], s59
    s_branch L_ge_16
L_gs_15:
    buffer_store_dword v39, off, s[24:27], s59 sc0 sc1
L_ge_16:
    s_nop 1
    s_mov_b64 exec, -1
    buffer_load_dword v9, v247, s[24:27], s57 offen sc1
    buffer_load_dwordx4 v[64:67], v27, s[24:27], s70 offen offset:0 sc1
    buffer_load_dwordx4 v[68:71], v27, s[24:27], s70 offen offset:512 sc1
    buffer_load_dwordx4 v[72:75], v27, s[24:27], s70 offen offset:1024 sc1
    buffer_load_dwordx4 v[76:79], v27, s[24:27], s70 offen offset:1536 sc1
    s_add_u32 m0, s58, 0
    s_nop 0
    buffer_load_dwordx4 v16, s[8:11], s71 offen lds
    s_add_u32 m0, s58, 1024
    s_nop 0
    buffer_load_dwordx4 v17, s[8:11], s71 offen lds
    s_add_u32 m0, s58, 2048
    s_nop 0
    buffer_load_dwordx4 v18, s[8:11], s71 offen lds
    s_barrier
    s_mul_i32 s52, s86, 20480
    s_add_u32 s52, s52, 0x100000
    s_add_u32 s53, s52, 4096
    s_add_u32 s54, s52, 8192
    s_add_u32 s55, s52, 12288
    s_add_u32 s56, s52, 16384
    v_mov_b32 v2, v26
    v_lshlrev_b32 v3, 4, v15
    v_add_u32 v3, 102400, v3
    v_and_b32 v12, 7, v1
    v_lshlrev_b32 v12, 7, v12
    ds_read_b128 a[56:59], v4 offset:0
    ds_read_b128 a[60:63], v4 offset:256
    ds_read_b128 a[64:67], v4 offset:512
    ds_read_b128 a[68:71], v4 offset:768
    ds_read_b128 a[72:75], v4 offset:1024
    ds_read_b128 a[76:79], v4 offset:5120
    ds_read_b128 a[80:83], v4 offset:5376
    ds_read_b128 a[84:87], v4 offset:5632
    ds_read_b128 a[88:91], v4 offset:5888
    ds_read_b128 a[92:95], v4 offset:6144
    ds_read_b128 a[96:99], v4 offset:10240
    ds_read_b128 a[100:103], v4 offset:10496
    ds_read_b128 a[104:107], v4 offset:10752
    ds_read_b128 a[108:111], v4 offset:11008
    ds_read_b128 a[112:115], v4 offset:11264
    ds_read_b128 a[116:119], v4 offset:15360
    ds_read_b128 a[120:123], v4 offset:15616
    ds_read_b128 a[124:127], v4 offset:15872
    ds_read_b128 a[128:131], v4 offset:16128
    ds_read_b128 a[132:135], v4 offset:16384
    ds_read_b128 a[136:139], v4 offset:20480
    ds_read_b128 a[140:143], v4 offset:20736
    ds_read_b128 a[144:147], v4 offset:20992
    ds_read_b128 a[148:151], v4 offset:21248
    ds_read_b128 a[152:155], v4 offset:21504
    ds_read_b128 a[156:159], v4 offset:25600
    ds_read_b128 a[160:163], v4 offset:25856
    ds_read_b128 a[164:167], v4 offset:26112
    ds_read_b128 a[168:171], v4 offset:26368
    ds_read_b128 a[172:175], v4 offset:26624
    ds_read_b128 a[176:179], v4 offset:30720
    ds_read_b128 a[180:183], v4 offset:30976
    ds_read_b128 a[184:187], v4 offset:31232
    ds_read_b128 a[188:191], v4 offset:31488
    ds_read_b128 a[192:195], v4 offset:31744
    ds_read_b128 a[196:199], v4 offset:35840
    ds_read_b128 a[200:203], v4 offset:36096
    ds_read_b128 a[204:207], v4 offset:36352
    ds_read_b128 a[208:211], v4 offset:36608
    ds_read_b128 a[212:215], v4 offset:36864
    ds_read_b128 a[216:219], v4 offset:40960
    ds_read_b128 a[220:223], v4 offset:41216
    ds_read_b128 a[224:227], v4 offset:41472
    ds_read_b128 a[228:231], v4 offset:41728
    ds_read_b128 a[232:235], v4 offset:41984
    ds_read_b128 a[236:239], v4 offset:46080
    ds_read_b128 a[240:243], v4 offset:46336
    ds_read_b128 a[244:247], v4 offset:46592
    ds_read_b128 a[248:251], v4 offset:46848
    ds_read_b128 a[252:255], v4 offset:47104
    ds_read_b128 v[100:103], v4 offset:51200
    ds_read_b128 v[104:107], v4 offset:51456
    ds_read_b128 v[108:111], v4 offset:51712
    ds_read_b128 v[112:115], v4 offset:51968
    ds_read_b128 v[116:119], v4 offset:52224
    ds_read_b128 v[120:123], v4 offset:56320
    ds_read_b128 v[124:127], v4 offset:56576
    ds_read_b128 v[128:131], v4 offset:56832
    ds_read_b128 v[132:135], v4 offset:57088
    ds_read_b128 v[136:139], v4 offset:57344
    s_waitcnt vmcnt(7)
    v_cmp_ne_u32 vcc, s6, v9
    s_nop 4
    s_cbranch_vccz L_done_18
    s_mov_b32 s90, 0
L_poll_17:
    s_nop 1
    buffer_load_dword v9, v247, s[24:27], s57 offen sc1
    s_waitcnt vmcnt(0)
    v_cmp_ne_u32 vcc, s6, v9
    s_nop 4
    s_cbranch_vccz L_done_18
    s_add_u32 s90, s90, 1
    s_cmp_lt_u32 s90, 40000
    s_cbranch_scc1 L_poll_17
L_done_18:
    s_nop 1
    buffer_load_dwordx4 v[144:147], v2, s[24:27], s52 offen offset:0 sc1
    buffer_load_dwordx4 v[148:151], v2, s[24:27], s52 offen offset:1024 sc1
    buffer_load_dwordx4 v[152:155], v2, s[24:27], s52 offen offset:2048 sc1
    buffer_load_dwordx4 v[156:159], v2, s[24:27], s52 offen offset:3072 sc1
    buffer_load_dwordx4 v[160:163], v2, s[24:27], s53 offen offset:0 sc1
    buffer_load_dwordx4 v[164:167], v2, s[24:27], s53 offen offset:1024 sc1
    buffer_load_dwordx4 v[168:171], v2, s[24:27], s53 offen offset:2048 sc1
    buffer_load_dwordx4 v[172:175], v2, s[24:27], s53 offen offset:3072 sc1
    s_waitcnt vmcnt(14)
    v_cmp_ne_u32 vcc, s6, v65
    v_cmp_ne_u32 s[98:99], s6, v67
    s_nop 0
    s_or_b64 vcc, vcc, s[98:99]
    s_waitcnt vmcnt(13)
    v_cmp_ne_u32 s[98:99], s6, v69
    s_nop 0
    s_or_b64 vcc, vcc, s[98:99]
    v_cmp_ne_u32 s[98:99], s6, v71
    s_nop 0
    s_or_b64 vcc, vcc, s[98:99]
    s_waitcnt vmcnt(12)
    v_cmp_ne_u32 s[98:99], s6, v73
    s_nop 0
    s_or_b64 vcc, vcc, s[98:99]
    v_cmp_ne_u32 s[98:99], s6, v75
    s_nop 0
    s_or_b64 vcc, vcc, s[98:99]
    s_waitcnt vmcnt(11)
    v_cmp_ne_u32 s[98:99], s6, v77
    s_nop 0
    s_or_b64 vcc, vcc, s[98:99]
    v_cmp_ne_u32 s[98:99], s6, v79
    s_nop 0
    s_or_b64 vcc, vcc, s[98:99]
    s_nop 4
    s_cbranch_vccz L_done_20
    s_mov_b32 s90, 0
L_poll_19:
    s_nop 1
    buffer_load_dwordx4 v[64:67], v27, s[24:27], s70 offen offset:0 sc1
    buffer_load_dwordx4 v[68:71], v27, s[24:27], s70 offen offset:512 sc1
    buffer_load_dwordx4 v[72:75], v27, s[24:27], s70 offen offset:1024 sc1
    buffer_load_dwordx4 v[76:79], v27, s[24:27], s70 offen offset:1536 sc1
    s_waitcnt vmcnt(0)
    v_cmp_ne_u32 vcc, s6, v65
    v_cmp_ne_u32 s[98:99], s6, v67
    s_nop 0
    s_or_b64 vcc, vcc, s[98:99]
    v_cmp_ne_u32 s[98:99], s6, v69
    s_nop 0
    s_or_b64 vcc, vcc, s[98:99]
    v_cmp_ne_u32 s[98:99], s6, v71
    s_nop 0
    s_or_b64 vcc, vcc, s[98:99]
    v_cmp_ne_u32 s[98:99], s6, v73
    s_nop 0
    s_or_b64 vcc, vcc, s[98:99]
    v_cmp_ne_u32 s[98:99], s6, v75
    s_nop 0
    s_or_b64 vcc, vcc, s[98:99]
    v_cmp_ne_u32 s[98:99], s6, v77
    s_nop 0
    s_or_b64 vcc, vcc, s[98:99]
    v_cmp_ne_u32 s[98:99], s6, v79
    s_nop 0
    s_or_b64 vcc, vcc, s[98:99]
    s_nop 4
    s_cbranch_vccz L_done_20
    s_add_u32 s90, s90, 1
    s_cmp_lt_u32 s90, 40000
    s_cbranch_scc1 L_poll_19
L_done_20:
    s_nop 1
    s_waitcnt vmcnt(8)
    ds_read_b64 v[40:41], v7 offset:0
    ds_read_b64 v[42:43], v7 offset:32
    ds_read_b64 v[44:45], v7 offset:64
    ds_read_b64 v[46:47], v7 offset:96
    ds_read_b64 v[48:49], v7 offset:128
    v_accvgpr_read_b32 v52, a36
    v_add_f32 v64, v64, v68
    v_add_f32 v72, v72, v76
    v_add_f32 v66, v66, v70
    v_add_f32 v74, v74, v78
    s_cmp_eq_u32 s3, 2
    s_cselect_b32 s62, 1.0, 0
    s_movk_i32 s63, 1920
    s_cselect_b32 s63, 640, s63
    v_add_f32 v64, v64, v72
    v_add_f32 v66, v66, v74
    v_min_u32 v8, 39, v1
    v_cvt_pk_bf16_f32 v64, v64, v66
    s_mul_i32 s65, s3, 320
    v_lshlrev_b32 v66, 16, v64
    v_and_b32 v67, s84, v64
    s_add_u32 s65, s65, 102400
    v_add_f32 v66, s62, v66
    v_add_f32 v67, s62, v67
    v_lshl_add_u32 v8, v8, 3, s65
    v_cvt_pk_bf16_f32 v64, v66, v67
    v_lshlrev_b32 v68, 16, v52
    v_and_b32 v69, s84, v52
    v_lshlrev_b32 v66, 16, v64
    v_and_b32 v67, s84, v64
    v_add_u32 v7, s63, v8
    v_mul_f32 v68, v68, v66
    v_mul_f32 v69, v69, v67
    ds_write_b64 v8, v[66:67]
    v_cmp_gt_u32 vcc, 40, v1
    ds_write_b64 v7, v[68:69]
    v_add_f32 v50, v68, v69
    s_lshr_b32 s62, s86, 2
    v_cndmask_b32 v50, 0, v50, vcc
    s_waitcnt vmcnt(7) lgkmcnt(14)
    v_mfma_f32_16x16x32_bf16 v[244:247], a[56:59], v[144:147], 0
    buffer_load_dwordx4 v[176:179], v2, s[24:27], s54 offen offset:0 sc1
    buffer_load_dwordx4 v[180:183], v2, s[24:27], s54 offen offset:1024 sc1
    v_mfma_f32_16x16x32_bf16 v[248:251], a[60:63], v[144:147], 0
    s_lshl_b32 s62, s62, 10
    s_add_u32 s61, s62, 0xc8000
    v_mfma_f32_16x16x32_bf16 v[140:143], a[64:67], v[144:147], 0
    s_lshl_b32 s62, s87, 7
    s_add_u32 s62, s62, s61
    v_mfma_f32_16x16x32_bf16 v[20:23], a[68:71], v[144:147], 0
    s_lshl_b32 s63, s3, 3
    v_mfma_f32_16x16x32_bf16 v[36:39], a[72:75], v[144:147], 0
    s_waitcnt vmcnt(8)
    v_mfma_f32_16x16x32_bf16 v[244:247], a[76:79], v[148:151], v[244:247]
    buffer_load_dwordx4 v[184:187], v2, s[24:27], s54 offen offset:2048 sc1
    s_add_u32 s59, s62, s63
    v_mfma_f32_16x16x32_bf16 v[248:251], a[80:83], v[148:151], v[248:251]
    s_waitcnt lgkmcnt(6)
    v_lshlrev_b32 v80, 16, v40
    v_and_b32 v81, s84, v40
    v_mfma_f32_16x16x32_bf16 v[140:143], a[84:87], v[148:151], v[140:143]
    v_add_f32_dpp v50, v50, v50 quad_perm:[1,0,3,2] row_mask:0xf bank_mask:0xf
    v_lshlrev_b32 v82, 16, v41
    v_mfma_f32_16x16x32_bf16 v[20:23], a[88:91], v[148:151], v[20:23]
    v_mfma_f32_16x16x32_bf16 v[36:39], a[92:95], v[148:151], v[36:39]
    s_waitcnt vmcnt(8)
    v_mfma_f32_16x16x32_bf16 v[244:247], a[96:99], v[152:155], v[244:247]
    buffer_load_dwordx4 v[188:191], v2, s[24:27], s54 offen offset:3072 sc1
    buffer_load_dwordx4 v[192:195], v2, s[24:27], s55 offen offset:0 sc1
    v_mfma_f32_16x16x32_bf16 v[248:251], a[100:103], v[152:155], v[248:251]
    v_and_b32 v83, s84, v41
    v_add_f32_dpp v50, v50, v50 quad_perm:[2,3,0,1] row_mask:0xf bank_mask:0xf
    v_mfma_f32_16x16x32_bf16 v[140:143], a[104:107], v[152:155], v[140:143]
    s_waitcnt lgkmcnt(5)
    v_lshlrev_b32 v84, 16, v42
    v_and_b32 v85, s84, v42
    v_mfma_f32_16x16x32_bf16 v[20:23], a[108:111], v[152:155], v[20:23]
    v_add_f32_dpp v50, v50, v50 row_ror:4 row_mask:0xf bank_mask:0xf
    v_mfma_f32_16x16x32_bf16 v[36:39], a[112:115], v[152:155], v[36:39]
    s_waitcnt vmcnt(9)
    v_mfma_f32_16x16x32_bf16 v[244:247], a[116:119], v[156:159], v[244:247]
    buffer_load_dwordx4 v[196:199], v2, s[24:27], s55 offen offset:1024 sc1
    v_lshlrev_b32 v86, 16, v43
    v_mfma_f32_16x16x32_bf16 v[248:251], a[120:123], v[156:159], v[248:251]
    v_and_b32 v87, s84, v43
    v_add_f32_dpp v50, v50, v50 row_ror:8 row_mask:0xf bank_mask:0xf
    v_mfma_f32_16x16x32_bf16 v[140:143], a[124:127], v[156:159], v[140:143]
    v_mov_b32 v51, v50
    s_waitcnt lgkmcnt(4)
    v_lshlrev_b32 v88, 16, v44
    v_mfma_f32_16x16x32_bf16 v[20:23], a[128:131], v[156:159], v[20:23]
    v_mfma_f32_16x16x32_bf16 v[36:39], a[132:135], v[156:159], v[36:39]
    s_waitcnt vmcnt(9)
    v_mfma_f32_16x16x32_bf16 v[244:247], a[136:139], v[160:163], v[244:247]
    buffer_load_dwordx4 v[200:203], v2, s[24:27], s55 offen offset:2048 sc1
    buffer_load_dwordx4 v[204:207], v2, s[24:27], s55 offen offset:3072 sc1
    v_mfma_f32_16x16x32_bf16 v[248:251], a[140:143], v[160:163], v[248:251]
    ds_read_b128 a[56:59], v6 offset:0
    ds_read_b128 a[60:63], v6 offset:256
    v_mfma_f32_16x16x32_bf16 v[140:143], a[144:147], v[160:163], v[140:143]
    ds_read_b128 a[64:67], v6 offset:512
    ds_read_b128 a[68:71], v6 offset:768
    v_mfma_f32_16x16x32_bf16 v[20:23], a[148:151], v[160:163], v[20:23]
    ds_read_b128 a[72:75], v6 offset:1024
    v_mfma_f32_16x16x32_bf16 v[36:39], a[152:155], v[160:163], v[36:39]
    s_waitcnt lgkmcnt(0)
    s_barrier
    s_waitcnt vmcnt(10)
    v_mfma_f32_16x16x32_bf16 v[244:247], a[156:159], v[164:167], v[244:247]
    buffer_load_dwordx4 v[208:211], v2, s[24:27], s56 offen offset:0 sc1
    ds_read_b128 a[76:79], v6 offset:5120
    v_mfma_f32_16x16x32_bf16 v[248:251], a[160:163], v[164:167], v[248:251]
    ds_read_b128 a[80:83], v6 offset:5376
    ds_read_b128 a[84:87], v6 offset:5632
    v_mfma_f32_16x16x32_bf16 v[140:143], a[164:167], v[164:167], v[140:143]
    ds_read_b128 a[88:91], v6 offset:5888
    ds_read_b128 a[92:95], v6 offset:6144
    v_mfma_f32_16x16x32_bf16 v[20:23], a[168:171], v[164:167], v[20:23]
    v_mfma_f32_16x16x32_bf16 v[36:39], a[172:175], v[164:167], v[36:39]
    s_waitcnt vmcnt(10)
    v_mfma_f32_16x16x32_bf16 v[244:247], a[176:179], v[168:171], v[244:247]
    buffer_load_dwordx4 v[212:215], v2, s[24:27], s56 offen offset:1024 sc1
    buffer_load_dwordx4 v[216:219], v2, s[24:27], s56 offen offset:2048 sc1
    v_mfma_f32_16x16x32_bf16 v[248:251], a[180:183], v[168:171], v[248:251]
    ds_read_b128 a[96:99], v6 offset:10240
    ds_read_b128 a[100:103], v6 offset:10496
    v_mfma_f32_16x16x32_bf16 v[140:143], a[184:187], v[168:171], v[140:143]
    ds_read_b128 a[104:107], v6 offset:10752
    ds_read_b128 a[108:111], v6 offset:11008
    v_mfma_f32_16x16x32_bf16 v[20:23], a[188:191], v[168:171], v[20:23]
    ds_read_b128 a[112:115], v6 offset:11264
    v_mfma_f32_16x16x32_bf16 v[36:39], a[192:195], v[168:171], v[36:39]
    s_waitcnt vmcnt(11)
    v_mfma_f32_16x16x32_bf16 v[244:247], a[196:199], v[172:175], v[244:247]
    buffer_load_dwordx4 v[220:223], v2, s[24:27], s56 offen offset:3072 sc1
    ds_read_b128 a[116:119], v6 offset:15360
    v_mfma_f32_16x16x32_bf16 v[248:251], a[200:203], v[172:175], v[248:251]
    ds_read_b128 a[120:123], v6 offset:15616
    ds_read_b128 a[124:127], v6 offset:15872
    v_mfma_f32_16x16x32_bf16 v[140:143], a[204:207], v[172:175], v[140:143]
    ds_read_b128 a[128:131], v6 offset:16128
    ds_read_b128 a[132:135], v6 offset:16384
    v_mfma_f32_16x16x32_bf16 v[20:23], a[208:211], v[172:175], v[20:23]
    v_mfma_f32_16x16x32_bf16 v[36:39], a[212:215], v[172:175], v[36:39]
    s_waitcnt vmcnt(11)
    v_mfma_f32_16x16x32_bf16 v[244:247], a[216:219], v[176:179], v[244:247]
    ds_read_b128 a[136:139], v6 offset:20480
    v_mfma_f32_16x16x32_bf16 v[248:251], a[220:223], v[176:179], v[248:251]
    ds_read_b128 a[140:143], v6 offset:20736
    v_mfma_f32_16x16x32_bf16 v[140:143], a[224:227], v[176:179], v[140:143]
    ds_read_b128 a[144:147], v6 offset:20992
    v_mfma_f32_16x16x32_bf16 v[20:23], a[228:231], v[176:179], v[20:23]
    ds_read_b128 a[148:151], v6 offset:21248
    v_mfma_f32_16x16x32_bf16 v[36:39], a[232:235], v[176:179], v[36:39]
    ds_read_b128 a[152:155], v6 offset:21504
    s_waitcnt vmcnt(10)
    v_mfma_f32_16x16x32_bf16 v[244:247], a[236:239], v[180:183], v[244:247]
    ds_read_b128 a[156:159], v6 offset:25600
    v_mfma_f32_16x16x32_bf16 v[248:251], a[240:243], v[180:183], v[248:251]
    ds_read_b128 a[160:163], v6 offset:25856
    v_mfma_f32_16x16x32_bf16 v[140:143], a[244:247], v[180:183], v[140:143]
    ds_read_b128 a[164:167], v6 offset:26112
    v_mfma_f32_16x16x32_bf16 v[20:23], a[248:251], v[180:183], v[20:23]
    ds_read_b128 a[168:171], v6 offset:26368
    v_mfma_f32_16x16x32_bf16 v[36:39], a[252:255], v[180:183], v[36:39]
    ds_read_b128 a[172:175], v6 offset:26624
    s_waitcnt vmcnt(9)
    v_mfma_f32_16x16x32_bf16 v[244:247], v[100:103], v[184:187], v[244:247]
    ds_read_b128 a[176:179], v6 offset:30720
    ds_read_b128 a[180:183], v6 offset:30976
    v_mfma_f32_16x16x32_bf16 v[248:251], v[104:107], v[184:187], v[248:251]
    ds_read_b128 a[184:187], v6 offset:31232
    ds_read_b128 a[188:191], v6 offset:31488
    v_mfma_f32_16x16x32_bf16 v[140:143], v[108:111], v[184:187], v[140:143]
    ds_read_b128 a[192:195], v6 offset:31744
    buffer_load_dwordx4 a[0:3], v31, s[40:43], 0 offen
    v_mfma_f32_16x16x32_bf16 v[20:23], v[112:115], v[184:187], v[20:23]
    v_mfma_f32_16x16x32_bf16 v[36:39], v[116:119], v[184:187], v[36:39]
    s_waitcnt vmcnt(9)
    v_mfma_f32_16x16x32_bf16 v[244:247], v[120:123], v[188:191], v[244:247]
    ds_read_b128 a[196:199], v6 offset:35840
    ds_read_b128 a[200:203], v6 offset:36096
    v_mfma_f32_16x16x32_bf16 v[248:251], v[124:127], v[188:191], v[248:251]
    ds_read_b128 a[204:207], v6 offset:36352
    ds_read_b128 a[208:211], v6 offset:36608
    v_mfma_f32_16x16x32_bf16 v[140:143], v[128:131], v[188:191], v[140:143]
    ds_read_b128 a[212:215], v6 offset:36864
    buffer_load_dwordx4 a[4:7], v31, s[40:43], s16 offen
    v_mfma_f32_16x16x32_bf16 v[20:23], v[132:135], v[188:191], v[20:23]
    v_mfma_f32_16x16x32_bf16 v[36:39], v[136:139], v[188:191], v[36:39]
    s_waitcnt vmcnt(9)
    v_mfma_f32_16x16x32_bf16 v[244:247], a[56:59], v[192:195], v[244:247]
    buffer_load_dwordx4 a[8:11], v32, s[40:43], s17 offen
    v_and_b32 v89, s84, v44
    v_mfma_f32_16x16x32_bf16 v[248:251], a[60:63], v[192:195], v[248:251]
    v_permlane16_swap_b32 v50, v51
    v_add_f32 v50, v50, v51
    v_mfma_f32_16x16x32_bf16 v[140:143], a[64:67], v[192:195], v[140:143]
    v_mov_b32 v51, v50
    v_lshlrev_b32 v90, 16, v45
    v_mfma_f32_16x16x32_bf16 v[20:23], a[68:71], v[192:195], v[20:23]
    v_mfma_f32_16x16x32_bf16 v[36:39], a[72:75], v[192:195], v[36:39]
    s_waitcnt vmcnt(9) lgkmcnt(14)
    v_mfma_f32_16x16x32_bf16 v[244:247], a[76:79], v[196:199], v[244:247]
    buffer_load_dwordx4 a[12:15], v31, s[44:47], 0 offen
    v_and_b32 v91, s84, v45
    v_mfma_f32_16x16x32_bf16 v[248:251], a[80:83], v[196:199], v[248:251]
    v_permlane32_swap_b32 v50, v51
    v_add_f32 v50, v50, v51
    v_mfma_f32_16x16x32_bf16 v[140:143], a[84:87], v[196:199], v[140:143]
    v_mov_b32 v51, s6
    s_mov_b64 exec, 1
    s_cmp_eq_u32 s88, 0
    s_cbranch_scc1 L_gs_21
    buffer_store_dwordx2 v[50:51], off, s[24:27], s59 offset:8
    s_branch L_ge_22
L_gs_21:
    buffer_store_dwordx2 v[50:51], off, s[24:27], s59 offset:8 sc0 sc1
L_ge_22:
    s_nop 1
    s_mov_b64 exec, -1
    v_mfma_f32_16x16x32_bf16 v[20:23], a[88:91], v[196:199], v[20:23]
    v_mfma_f32_16x16x32_bf16 v[36:39], a[92:95], v[196:199], v[36:39]
    s_waitcnt vmcnt(10)
    v_mfma_f32_16x16x32_bf16 v[244:247], a[96:99], v[200:203], v[244:247]
    buffer_load_dwordx4 a[16:19], v31, s[44:47], s16 offen
    v_lshlrev_b32 v92, 16, v46
    v_mfma_f32_16x16x32_bf16 v[248:251], a[100:103], v[200:203], v[248:251]
    v_and_b32 v93, s84, v46
    v_lshlrev_b32 v94, 16, v47
    v_mfma_f32_16x16x32_bf16 v[140:143], a[104:107], v[200:203], v[140:143]
    v_and_b32 v95, s84, v47
    v_lshlrev_b32 v96, 16, v48
    v_mfma_f32_16x16x32_bf16 v[20:23], a[108:111], v[200:203], v[20:23]
    v_mfma_f32_16x16x32_bf16 v[36:39], a[112:115], v[200:203], v[36:39]
    s_waitcnt vmcnt(10)
    v_mfma_f32_16x16x32_bf16 v[244:247], a[116:119], v[204:207], v[244:247]
    buffer_load_dwordx4 a[20:23], v32, s[44:47], s17 offen
    v_mfma_f32_16x16x32_bf16 v[248:251], a[120:123], v[204:207], v[248:251]
    v_and_b32 v97, s84, v48
    v_mfma_f32_16x16x32_bf16 v[140:143], a[124:127], v[204:207], v[140:143]
    v_lshlrev_b32 v98, 16, v49
    v_mfma_f32_16x16x32_bf16 v[20:23], a[128:131], v[204:207], v[20:23]
    v_and_b32 v99, s84, v49
    v_mfma_f32_16x16x32_bf16 v[36:39], a[132:135], v[204:207], v[36:39]
    s_waitcnt vmcnt(10)
    v_mfma_f32_16x16x32_bf16 v[244:247], a[136:139], v[208:211], v[244:247]
    v_mfma_f32_16x16x32_bf16 v[248:251], a[140:143], v[208:211], v[248:251]
    v_mfma_f32_16x16x32_bf16 v[140:143], a[144:147], v[208:211], v[140:143]
    v_mfma_f32_16x16x32_bf16 v[20:23], a[148:151], v[208:211], v[20:23]
    v_mfma_f32_16x16x32_bf16 v[36:39], a[152:155], v[208:211], v[36:39]
    s_waitcnt vmcnt(9)
    v_mfma_f32_16x16x32_bf16 v[244:247], a[156:159], v[212:215], v[244:247]
    ds_read_b128 v[40:43], v3 offset:0
    s_waitcnt lgkmcnt(14)
    v_mfma_f32_16x16x32_bf16 v[248:251], a[160:163], v[212:215], v[248:251]
    ds_read_b128 v[44:47], v3 offset:64
    s_waitcnt lgkmcnt(14)
    v_mfma_f32_16x16x32_bf16 v[140:143], a[164:167], v[212:215], v[140:143]
    ds_read_b128 v[48:51], v3 offset:128
    s_waitcnt lgkmcnt(14)
    v_mfma_f32_16x16x32_bf16 v[20:23], a[168:171], v[212:215], v[20:23]
    ds_read_b128 v[52:55], v3 offset:192
    s_waitcnt lgkmcnt(14)
    v_mfma_f32_16x16x32_bf16 v[36:39], a[172:175], v[212:215], v[36:39]
    ds_read_b128 v[56:59], v3 offset:256
    s_waitcnt vmcnt(8) lgkmcnt(14)
    v_mfma_f32_16x16x32_bf16 v[244:247], a[176:179], v[216:219], v[244:247]
    ds_read_b128 v[224:227], v3 offset:1280
    s_waitcnt lgkmcnt(14)
    v_mfma_f32_16x16x32_bf16 v[248:251], a[180:183], v[216:219], v[248:251]
    ds_read_b128 v[228:231], v3 offset:1344
    s_waitcnt lgkmcnt(14)
    v_mfma_f32_16x16x32_bf16 v[140:143], a[184:187], v[216:219], v[140:143]
    ds_read_b128 v[232:235], v3 offset:1408
    s_waitcnt lgkmcnt(14)
    v_mfma_f32_16x16x32_bf16 v[20:23], a[188:191], v[216:219], v[20:23]
    ds_read_b128 v[236:239], v3 offset:1472
    s_waitcnt lgkmcnt(14)
    v_mfma_f32_16x16x32_bf16 v[36:39], a[192:195], v[216:219], v[36:39]
    ds_read_b128 v[240:243], v3 offset:1536
    s_waitcnt vmcnt(7) lgkmcnt(14)
    v_mfma_f32_16x16x32_bf16 v[244:247], a[196:199], v[220:223], v[244:247]
    s_waitcnt lgkmcnt(13)
    v_mfma_f32_16x16x32_bf16 v[248:251], a[200:203], v[220:223], v[248:251]
    s_waitcnt lgkmcnt(12)
    v_mfma_f32_16x16x32_bf16 v[140:143], a[204:207], v[220:223], v[140:143]
    s_waitcnt lgkmcnt(11)
    v_mfma_f32_16x16x32_bf16 v[20:23], a[208:211], v[220:223], v[20:23]
    s_waitcnt lgkmcnt(10)
    v_mfma_f32_16x16x32_bf16 v[36:39], a[212:215], v[220:223], v[36:39]
    s_lshl_b32 s52, s86, 11
    s_add_u32 s52, s52, 0x10000
    s_lshl_b32 s53, s87, 8
    s_add_u32 s53, s53, s52
    s_waitcnt lgkmcnt(9)
    v_pk_fma_f32 v[80:81], v[244:245], v[40:41], v[80:81]
    v_pk_fma_f32 v[82:83], v[246:247], v[42:43], v[82:83]
    s_waitcnt lgkmcnt(8)
    v_pk_fma_f32 v[84:85], v[248:249], v[44:45], v[84:85]
    v_pk_fma_f32 v[86:87], v[250:251], v[46:47], v[86:87]
    s_waitcnt lgkmcnt(7)
    v_pk_fma_f32 v[88:89], v[140:141], v[48:49], v[88:89]
    v_pk_fma_f32 v[90:91], v[142:143], v[50:51], v[90:91]
    s_waitcnt lgkmcnt(6)
    v_pk_fma_f32 v[92:93], v[20:21], v[52:53], v[92:93]
    v_pk_fma_f32 v[94:95], v[22:23], v[54:55], v[94:95]
    s_waitcnt lgkmcnt(5)
    v_pk_fma_f32 v[96:97], v[36:37], v[56:57], v[96:97]
    v_pk_fma_f32 v[98:99], v[38:39], v[58:59], v[98:99]
    v_cvt_pk_bf16_f32 v144, v80, v81
    v_cvt_pk_bf16_f32 v145, v82, v83
    v_cvt_pk_bf16_f32 v146, v84, v85
    v_cvt_pk_bf16_f32 v147, v86, v87
    v_cvt_pk_bf16_f32 v148, v88, v89
    v_cvt_pk_bf16_f32 v149, v90, v91
    v_cvt_pk_bf16_f32 v150, v92, v93
    v_cvt_pk_bf16_f32 v151, v94, v95
    v_cvt_pk_bf16_f32 v152, v96, v97
    v_cvt_pk_bf16_f32 v153, v98, v99
    v_lshlrev_b32 v80, 16, v144
    v_and_b32 v81, s84, v144
    v_lshlrev_b32 v82, 16, v145
    v_and_b32 v83, s84, v145
    v_lshlrev_b32 v84, 16, v146
    v_and_b32 v85, s84, v146
    v_lshlrev_b32 v86, 16, v147
    v_and_b32 v87, s84, v147
    v_lshlrev_b32 v88, 16, v148
    v_and_b32 v89, s84, v148
    v_lshlrev_b32 v90, 16, v149
    v_and_b32 v91, s84, v149
    v_lshlrev_b32 v92, 16, v150
    v_and_b32 v93, s84, v150
    v_lshlrev_b32 v94, 16, v151
    v_and_b32 v95, s84, v151
    v_lshlrev_b32 v96, 16, v152
    v_and_b32 v97, s84, v152
    v_lshlrev_b32 v98, 16, v153
    v_and_b32 v99, s84, v153
    v_pk_add_f32 v[156:157], v[80:81], v[82:83]
    v_pk_mul_f32 v[158:159], v[80:81], v[80:81]
    s_waitcnt lgkmcnt(4)
    v_pk_mul_f32 v[160:161], v[80:81], v[224:225]
    v_pk_fma_f32 v[158:159], v[82:83], v[82:83], v[158:159]
    v_pk_fma_f32 v[160:161], v[82:83], v[226:227], v[160:161]
    v_pk_add_f32 v[156:157], v[156:157], v[84:85]
    v_pk_fma_f32 v[158:159], v[84:85], v[84:85], v[158:159]
    s_waitcnt lgkmcnt(3)
    v_pk_fma_f32 v[160:161], v[84:85], v[228:229], v[160:161]
    v_pk_add_f32 v[156:157], v[156:157], v[86:87]
    v_pk_fma_f32 v[158:159], v[86:87], v[86:87], v[158:159]
    v_pk_fma_f32 v[160:161], v[86:87], v[230:231], v[160:161]
    v_pk_add_f32 v[156:157], v[156:157], v[88:89]
    v_pk_fma_f32 v[158:159], v[88:89], v[88:89], v[158:159]
    s_waitcnt lgkmcnt(2)
    v_pk_fma_f32 v[160:161], v[88:89], v[232:233], v[160:161]
    v_pk_add_f32 v[156:157], v[156:157], v[90:91]
    v_pk_fma_f32 v[158:159], v[90:91], v[90:91], v[158:159]
    v_pk_fma_f32 v[160:161], v[90:91], v[234:235], v[160:161]
    v_pk_add_f32 v[156:157], v[156:157], v[92:93]
    v_pk_fma_f32 v[158:159], v[92:93], v[92:93], v[158:159]
    s_waitcnt lgkmcnt(1)
    v_pk_fma_f32 v[160:161], v[92:93], v[236:237], v[160:161]
    v_pk_add_f32 v[156:157], v[156:157], v[94:95]
    v_pk_fma_f32 v[158:159], v[94:95], v[94:95], v[158:159]
    v_pk_fma_f32 v[160:161], v[94:95], v[238:239], v[160:161]
    v_pk_add_f32 v[156:157], v[156:157], v[96:97]
    v_pk_fma_f32 v[158:159], v[96:97], v[96:97], v[158:159]
    s_waitcnt lgkmcnt(0)
    v_pk_fma_f32 v[160:161], v[96:97], v[240:241], v[160:161]
    v_pk_add_f32 v[156:157], v[156:157], v[98:99]
    v_pk_fma_f32 v[158:159], v[98:99], v[98:99], v[158:159]
    v_pk_fma_f32 v[160:161], v[98:99], v[242:243], v[160:161]
    v_add_f32 v164, v156, v157
    v_add_f32 v165, v158, v159
    v_add_f32 v166, v160, v161
    v_mov_b32 v167, s6
    v_mov_b32 v168, v164
    v_mov_b32 v169, v165
    v_mov_b32 v170, v166
    v_permlane16_swap_b32 v164, v168
    v_permlane16_swap_b32 v165, v169
    v_permlane16_swap_b32 v166, v170
    v_add_f32 v164, v164, v168
    v_add_f32 v165, v165, v169
    v_add_f32 v166, v166, v170
    v_mov_b32 v168, v164
    v_mov_b32 v169, v165
    v_mov_b32 v170, v166
    v_permlane32_swap_b32 v164, v168
    v_permlane32_swap_b32 v165, v169
    v_permlane32_swap_b32 v166, v170
    v_add_f32 v164, v164, v168
    v_add_f32 v165, v165, v169
    v_add_f32 v166, v166, v170
    s_mov_b64 exec, 0xffff
    s_cmp_eq_u32 s88, 0
    s_cbranch_scc1 L_gs_23
    buffer_store_dwordx4 v[164:167], v2, s[24:27], s53 offen
    s_branch L_ge_24
L_gs_23:
    buffer_store_dwordx4 v[164:167], v2, s[24:27], s53 offen sc0 sc1
L_ge_24:
    s_nop 1
    s_mov_b64 exec, -1
    ds_read_b128 v[60:63], v3 offset:320
    ds_read_b128 v[64:67], v3 offset:384
    ds_read_b128 v[68:71], v3 offset:448
    ds_read_b128 v[72:75], v3 offset:512
    ds_read_b128 v[76:79], v3 offset:576
    ds_read_b128 v[100:103], v3 offset:640
    ds_read_b128 v[104:107], v3 offset:704
    ds_read_b128 v[108:111], v3 offset:768
    ds_read_b128 v[112:115], v3 offset:832
    ds_read_b128 v[116:119], v3 offset:896
    ds_read_b128 v[120:123], v3 offset:960
    ds_read_b128 v[124:127], v3 offset:1024
    ds_read_b128 v[128:131], v3 offset:1088
    ds_read_b128 v[132:135], v3 offset:1152
    ds_read_b128 v[136:139], v3 offset:1216
    v_lshlrev_b32 v20, 4, v0
    v_lshrrev_b32 v21, 2, v14
    v_lshl_add_u32 v21, v15, 3, v21
    v_and_b32 v22, 3, v1
    s_lshl_b32 s54, s3, 5
    v_lshl_add_u32 v22, v22, 3, s54
    v_lshl_add_u32 v23, v21, 7, v22
    v_mul_u32_u24 v21, 160, v21
    v_add_u32 v22, v21, v22
    v_subrev_u32 v21, s54, v22
    v_add_u32 v36, 0, v0
    v_mul_u32_u24 v32, 205, v36
    v_lshrrev_b32 v32, 11, v32
    v_mul_u32_u24 v32, 1120, v32
    v_lshl_add_u32 v36, v36, 4, v32
    v_add_u32 v37, 256, v0
    v_mul_u32_u24 v32, 205, v37
    v_lshrrev_b32 v32, 11, v32
    v_mul_u32_u24 v32, 1120, v32
    v_lshl_add_u32 v37, v37, 4, v32
    v_add_u32 v38, 512, v0
    v_min_u32 v38, 639, v38
    v_mul_u32_u24 v32, 205, v38
    v_lshrrev_b32 v32, 11, v32
    v_mul_u32_u24 v32, 1120, v32
    v_lshl_add_u32 v38, v38, 4, v32
    s_lshl_b32 s62, s3, 2
    s_add_u32 s62, s62, 108544
    v_mov_b32 v24, s62
    v_mov_b32 v25, 108544
    s_lshl_b32 s62, s86, 5
    s_add_u32 s62, s62, 0x50000
    v_mov_b32 v173, 0x3727c5ac
    s_movk_i32 s63, 0x7ff
    s_mov_b32 s90, 0
L_poll_25:
    s_nop 1
    buffer_load_dwordx4 v[16:19], v12, s[24:27], s61 offen offset:16 sc1
    buffer_load_dwordx4 v[164:167], v2, s[24:27], s52 offen sc1
    buffer_load_dwordx4 v[168:171], v2, s[24:27], s52 offen offset:1024 sc1
    s_waitcnt vmcnt(0)
    v_cmp_ne_u32 vcc, s6, v17
    v_cmp_ne_u32 s[98:99], s6, v19
    s_nop 0
    s_or_b64 vcc, vcc, s[98:99]
    v_cmp_ne_u32 s[98:99], s6, v167
    s_nop 0
    s_or_b64 vcc, vcc, s[98:99]
    v_cmp_ne_u32 s[98:99], s6, v171
    s_nop 0
    s_or_b64 vcc, vcc, s[98:99]
    s_nop 4
    s_cbranch_vccz L_done_26
    s_add_u32 s90, s90, 1
    s_cmp_lt_u32 s90, 40000
    s_cbranch_scc1 L_poll_25
L_done_26:
    s_nop 1
    v_add_f32_dpp v16, v16, v16 quad_perm:[1,0,3,2] row_mask:0xf bank_mask:0xf
    v_add_f32_dpp v18, v18, v18 quad_perm:[1,0,3,2] row_mask:0xf bank_mask:0xf
    s_nop 0
    v_add_f32_dpp v16, v16, v16 quad_perm:[2,3,0,1] row_mask:0xf bank_mask:0xf
    v_add_f32_dpp v18, v18, v18 quad_perm:[2,3,0,1] row_mask:0xf bank_mask:0xf
    s_nop 0
    v_add_f32_dpp v16, v16, v16 row_ror:4 row_mask:0xf bank_mask:0xf
    v_add_f32_dpp v18, v18, v18 row_ror:4 row_mask:0xf bank_mask:0xf
    buffer_load_dwordx4 a[24:27], v36, s[32:35], s89 offen
    buffer_load_dwordx4 a[28:31], v37, s[32:35], s89 offen
    buffer_load_dwordx4 a[32:35], v38, s[32:35], s89 offen
    v_add_f32 v164, v164, v168
    v_add_f32 v165, v165, v169
    v_add_f32 v166, v166, v170
    v_mov_b32 v168, v164
    v_mov_b32 v169, v165
    v_mov_b32 v170, v166
    v_permlane16_swap_b32 v164, v168
    v_permlane16_swap_b32 v165, v169
    v_permlane16_swap_b32 v166, v170
    v_add_f32 v164, v164, v168
    v_add_f32 v165, v165, v169
    v_add_f32 v166, v166, v170
    v_mov_b32 v168, v164
    v_mov_b32 v169, v165
    v_mov_b32 v170, v166
    v_permlane32_swap_b32 v164, v168
    v_permlane32_swap_b32 v165, v169
    v_permlane32_swap_b32 v166, v170
    v_add_f32 v164, v164, v168
    v_add_f32 v165, v165, v169
    v_add_f32 v166, v166, v170
    v_mul_f32 v168, 0x3acccccd, v164
    v_fmac_f32 v173, 0x3acccccd, v165
    v_fma_f32 v169, -v168, v168, v173
    v_max_f32 v169, 0x3727c5ac, v169
    v_rsq_f32 v170, v169
    v_fma_f32 v171, -v168, v18, v166
    v_fma_f32 v171, v171, v170, v16
    v_ashrrev_i32 v172, 31, v171
    v_or_b32 v172, 0x80000000, v172
    v_xor_b32 v172, v172, v171
    v_bfi_b32 v172, s63, v35, v172
    v_mov_b32 v174, v172
    s_nop 1
    v_max_u32_dpp v174, v174, v174 quad_perm:[1,0,3,2] row_mask:0xf bank_mask:0xf
    s_nop 1
    v_max_u32_dpp v174, v174, v174 quad_perm:[2,3,0,1] row_mask:0xf bank_mask:0xf
    s_nop 1
    v_max_u32_dpp v174, v174, v174 row_ror:4 row_mask:0xf bank_mask:0xf
    s_nop 1
    v_max_u32_dpp v174, v174, v174 row_ror:8 row_mask:0xf bank_mask:0xf
    s_cmp_lg_u32 s87, 0
    s_cbranch_scc1 L_skip_27
    ds_write_b32 v24, v174
    s_waitcnt lgkmcnt(0)
    s_barrier
    s_cmp_lg_u32 s3, 0
    s_cbranch_scc1 L_skip_28
    ds_read_b128 v[6:9], v25
    s_mov_b64 exec, 1
    s_waitcnt lgkmcnt(0)
    v_max3_u32 v6, v6, v7, v8
    v_mov_b32 v7, s6
    v_max_u32 v6, v6, v9
    buffer_store_dwordx2 v[6:7], off, s[24:27], s62 sc0 sc1
    s_mov_b64 exec, -1
L_skip_28:
    s_nop 1
L_skip_27:
    s_nop 1
    v_cmp_eq_u32 s[56:57], v172, v174
    v_mul_f32 v172, v168, v170
    v_sub_f32 v172, 0, v172
    v_pk_fma_f32 v[176:177], v[80:81], v[170:171], v[172:173] op_sel_hi:[1,0,0]
    v_pk_fma_f32 v[178:179], v[82:83], v[170:171], v[172:173] op_sel_hi:[1,0,0]
    v_pk_fma_f32 v[180:181], v[84:85], v[170:171], v[172:173] op_sel_hi:[1,0,0]
    v_pk_fma_f32 v[182:183], v[86:87], v[170:171], v[172:173] op_sel_hi:[1,0,0]
    v_pk_fma_f32 v[184:185], v[88:89], v[170:171], v[172:173] op_sel_hi:[1,0,0]
    v_pk_fma_f32 v[186:187], v[90:91], v[170:171], v[172:173] op_sel_hi:[1,0,0]
    v_pk_fma_f32 v[188:189], v[92:93], v[170:171], v[172:173] op_sel_hi:[1,0,0]
    v_pk_fma_f32 v[190:191], v[94:95], v[170:171], v[172:173] op_sel_hi:[1,0,0]
    v_pk_fma_f32 v[192:193], v[96:97], v[170:171], v[172:173] op_sel_hi:[1,0,0]
    v_pk_fma_f32 v[194:195], v[98:99], v[170:171], v[172:173] op_sel_hi:[1,0,0]
    s_waitcnt lgkmcnt(9)
    v_pk_fma_f32 v[176:177], v[176:177], v[100:101], v[60:61]
    v_pk_fma_f32 v[178:179], v[178:179], v[102:103], v[62:63]
    s_waitcnt lgkmcnt(8)
    v_pk_fma_f32 v[180:181], v[180:181], v[104:105], v[64:65]
    v_pk_fma_f32 v[182:183], v[182:183], v[106:107], v[66:67]
    s_waitcnt lgkmcnt(7)
    v_pk_fma_f32 v[184:185], v[184:185], v[108:109], v[68:69]
    v_pk_fma_f32 v[186:187], v[186:187], v[110:111], v[70:71]
    s_waitcnt lgkmcnt(6)
    v_pk_fma_f32 v[188:189], v[188:189], v[112:113], v[72:73]
    v_pk_fma_f32 v[190:191], v[190:191], v[114:115], v[74:75]
    s_waitcnt lgkmcnt(5)
    v_pk_fma_f32 v[192:193], v[192:193], v[116:117], v[76:77]
    v_pk_fma_f32 v[194:195], v[194:195], v[118:119], v[78:79]
    v_cvt_pk_bf16_f32 v196, v176, v177
    v_cvt_pk_bf16_f32 v197, v178, v179
    v_cvt_pk_bf16_f32 v198, v180, v181
    v_cvt_pk_bf16_f32 v199, v182, v183
    v_cvt_pk_bf16_f32 v200, v184, v185
    v_cvt_pk_bf16_f32 v201, v186, v187
    v_cvt_pk_bf16_f32 v202, v188, v189
    v_cvt_pk_bf16_f32 v203, v190, v191
    v_cvt_pk_bf16_f32 v204, v192, v193
    v_cvt_pk_bf16_f32 v205, v194, v195
    v_min_u32 v196, -2, v196
    v_min_u32 v197, -2, v197
    v_min_u32 v198, -2, v198
    v_min_u32 v199, -2, v199
    v_min_u32 v200, -2, v200
    v_min_u32 v201, -2, v201
    v_min_u32 v202, -2, v202
    v_min_u32 v203, -2, v203
    v_min_u32 v204, -2, v204
    v_min_u32 v205, -2, v205
    v_lshlrev_b32 v3, 3, v15
    s_mov_b64 exec, s[56:57]
    buffer_store_dwordx2 v[196:197], v3, s[24:27], s92 offen offset:0 sc0 sc1
    buffer_store_dwordx2 v[198:199], v3, s[24:27], s92 offen offset:32 sc0 sc1
    buffer_store_dwordx2 v[200:201], v3, s[24:27], s92 offen offset:64 sc0 sc1
    buffer_store_dwordx2 v[202:203], v3, s[24:27], s92 offen offset:96 sc0 sc1
    buffer_store_dwordx2 v[204:205], v3, s[24:27], s92 offen offset:128 sc0 sc1
    s_mov_b64 exec, -1
    v_min_u32 v144, -2, v144
    v_min_u32 v145, -2, v145
    v_min_u32 v146, -2, v146
    v_min_u32 v147, -2, v147
    v_min_u32 v148, -2, v148
    v_min_u32 v149, -2, v149
    v_min_u32 v150, -2, v150
    v_min_u32 v151, -2, v151
    v_min_u32 v152, -2, v152
    v_min_u32 v153, -2, v153
    s_add_u32 s54, s92, 0x30000
    s_mov_b64 exec, s[56:57]
    buffer_store_dwordx2 v[144:145], v3, s[24:27], s54 offen offset:0 sc0 sc1
    buffer_store_dwordx2 v[146:147], v3, s[24:27], s54 offen offset:32 sc0 sc1
    buffer_store_dwordx2 v[148:149], v3, s[24:27], s54 offen offset:64 sc0 sc1
    buffer_store_dwordx2 v[150:151], v3, s[24:27], s54 offen offset:96 sc0 sc1
    buffer_store_dwordx2 v[152:153], v3, s[24:27], s54 offen offset:128 sc0 sc1
    s_mov_b64 exec, -1
    s_mov_b32 s52, 0x50000
    v_lshlrev_b32 v4, 7, v11
    v_lshlrev_b32 v176, 16, v196
    v_and_b32 v177, s84, v196
    v_lshlrev_b32 v178, 16, v197
    v_and_b32 v179, s84, v197
    v_lshlrev_b32 v180, 16, v198
    v_and_b32 v181, s84, v198
    v_lshlrev_b32 v182, 16, v199
    v_and_b32 v183, s84, v199
    v_lshlrev_b32 v184, 16, v200
    v_and_b32 v185, s84, v200
    v_lshlrev_b32 v186, 16, v201
    v_and_b32 v187, s84, v201
    v_lshlrev_b32 v188, 16, v202
    v_and_b32 v189, s84, v202
    v_lshlrev_b32 v190, 16, v203
    v_and_b32 v191, s84, v203
    v_lshlrev_b32 v192, 16, v204
    v_and_b32 v193, s84, v204
    v_lshlrev_b32 v194, 16, v205
    v_and_b32 v195, s84, v205
    s_waitcnt lgkmcnt(4)
    v_pk_fma_f32 v[176:177], v[176:177], v[120:121], v[80:81]
    v_pk_fma_f32 v[178:179], v[178:179], v[122:123], v[82:83]
    s_waitcnt lgkmcnt(3)
    v_pk_fma_f32 v[180:181], v[180:181], v[124:125], v[84:85]
    v_pk_fma_f32 v[182:183], v[182:183], v[126:127], v[86:87]
    s_waitcnt lgkmcnt(2)
    v_pk_fma_f32 v[184:185], v[184:185], v[128:129], v[88:89]
    v_pk_fma_f32 v[186:187], v[186:187], v[130:131], v[90:91]
    s_waitcnt lgkmcnt(1)
    v_pk_fma_f32 v[188:189], v[188:189], v[132:133], v[92:93]
    v_pk_fma_f32 v[190:191], v[190:191], v[134:135], v[94:95]
    s_waitcnt lgkmcnt(0)
    v_pk_fma_f32 v[192:193], v[192:193], v[136:137], v[96:97]
    v_pk_fma_f32 v[194:195], v[194:195], v[138:139], v[98:99]
    v_cvt_pk_bf16_f32 v206, v176, v177
    v_cvt_pk_bf16_f32 v207, v178, v179
    v_cvt_pk_bf16_f32 v208, v180, v181
    v_cvt_pk_bf16_f32 v209, v182, v183
    v_cvt_pk_bf16_f32 v210, v184, v185
    v_cvt_pk_bf16_f32 v211, v186, v187
    v_cvt_pk_bf16_f32 v212, v188, v189
    v_cvt_pk_bf16_f32 v213, v190, v191
    v_cvt_pk_bf16_f32 v214, v192, v193
    v_cvt_pk_bf16_f32 v215, v194, v195
    v_lshlrev_b32 v5, 4, v15
    v_min_u32 v6, 16, v5
    s_mov_b32 s58, s94
    s_mov_b32 s59, s95
    s_mul_i32 s63, s58, 160
    s_add_u32 s63, s63, 0x60000
    s_lshl_b32 s64, s59, 13
    s_add_u32 s64, s64, 0x680000
    s_lshl_b32 s65, s58, 10
    s_lshl_b32 s66, s3, 8
    s_add_u32 s65, s65, s66
    s_add_u32 s65, s65, s64
    s_lshl_b32 s66, s3, 11
    s_add_u32 s64, s64, s66
    v_mov_b32 v58, s6
    v_mov_b32 v59, s6
    ds_write_b128 v20, a[0:3] offset:0
    ds_write_b128 v20, a[4:7] offset:4096
    ds_write_b128 v20, a[8:11] offset:8192
    ds_write_b128 v20, a[12:15] offset:12288
    ds_write_b128 v20, a[16:19] offset:16384
    ds_write_b128 v20, a[20:23] offset:20480
    s_waitcnt lgkmcnt(0)
    s_barrier
    ds_read_b64_tr_b16 a[56:57], v23 offset:0
    ds_read_b64_tr_b16 a[58:59], v23 offset:512
    ds_read_b64_tr_b16 a[60:61], v23 offset:4096
    ds_read_b64_tr_b16 a[62:63], v23 offset:4608
    ds_read_b64_tr_b16 a[64:65], v23 offset:8192
    ds_read_b64_tr_b16 a[66:67], v23 offset:8704
    ds_read_b64_tr_b16 a[68:69], v23 offset:12288
    ds_read_b64_tr_b16 a[70:71], v23 offset:12800
    ds_read_b64_tr_b16 a[72:73], v23 offset:16384
    ds_read_b64_tr_b16 a[74:75], v23 offset:16896
    ds_read_b64_tr_b16 a[76:77], v23 offset:20480
    ds_read_b64_tr_b16 a[78:79], v23 offset:20992
    s_mov_b32 s90, 0
L_poll_29:
    s_nop 1
    buffer_load_dwordx2 v[40:41], v4, s[24:27], s52 offen sc1
    s_waitcnt vmcnt(0)
    v_cmp_ne_u32 vcc, s6, v41
    s_nop 4
    s_cbranch_vccz L_done_30
    s_add_u32 s90, s90, 1
    s_cmp_lt_u32 s90, 40000
    s_cbranch_scc1 L_poll_29
L_done_30:
    s_nop 1
    v_max_u32_dpp v40, v40, v40 quad_perm:[1,0,3,2] row_mask:0xf bank_mask:0xf
    s_nop 1
    v_max_u32_dpp v40, v40, v40 quad_perm:[2,3,0,1] row_mask:0xf bank_mask:0xf
    s_nop 1
    v_max_u32_dpp v40, v40, v40 row_ror:4 row_mask:0xf bank_mask:0xf
    s_nop 1
    v_max_u32_dpp v40, v40, v40 row_ror:8 row_mask:0xf bank_mask:0xf
    v_mov_b32 v41, v40
    s_nop 1
    v_permlane16_swap_b32 v40, v41
    v_max_u32 v40, v40, v41
    s_nop 0
    v_readfirstlane_b32 s60, v40
    s_nop 0
    s_and_b32 s61, s60, 0x7ff
    s_lshr_b32 s62, s61, 5
    s_lshl_b32 s62, s62, 1
    s_and_b32 s55, s61, 1
    s_add_u32 s62, s62, s55
    s_mul_i32 s62, s62, 1280
    s_cmp_ge_u32 s93, 216
    s_cbranch_scc1 L_F_31
    s_add_u32 s63, s63, s62
    s_mov_b32 s90, 0
L_poll_33:
    s_nop 1
    buffer_load_dwordx4 v[44:47], v5, s[24:27], s63 offen sc1
    buffer_load_dwordx4 v[48:51], v5, s[24:27], s63 offen offset:64 sc1
    buffer_load_dwordx4 v[52:55], v6, s[24:27], s63 offen offset:128 sc1
    s_waitcnt vmcnt(0)
    v_max3_u32 v9, v44, v45, v46
    v_max3_u32 v9, v9, v47, v48
    v_max3_u32 v9, v9, v49, v50
    v_max3_u32 v9, v9, v51, v52
    v_max3_u32 v9, v9, v53, v54
    v_max_u32 v9, v9, v55
    v_cmp_eq_u32 vcc, -1, v9
    s_nop 4
    s_cbranch_vccz L_done_34
    s_add_u32 s90, s90, 1
    s_cmp_lt_u32 s90, 40000
    s_cbranch_scc1 L_poll_33
L_done_34:
    s_nop 1
    s_waitcnt lgkmcnt(10)
    v_mfma_f32_16x16x32_bf16 v[60:63], v[44:47], a[56:59], 0
    s_waitcnt lgkmcnt(4)
    v_mfma_f32_16x16x32_bf16 v[64:67], v[44:47], a[68:71], 0
    v_mfma_f32_16x16x32_bf16 v[60:63], v[48:51], a[60:63], v[60:63]
    s_waitcnt lgkmcnt(2)
    v_mfma_f32_16x16x32_bf16 v[64:67], v[48:51], a[72:75], v[64:67]
    v_mfma_f32_16x16x32_bf16 v[60:63], v[52:55], a[64:67], v[60:63]
    s_waitcnt lgkmcnt(0)
    v_mfma_f32_16x16x32_bf16 v[64:67], v[52:55], a[76:79], v[64:67]
    s_lshl_b32 s54, s3, 9
    s_add_u32 s54, s54, 109568
    v_lshl_add_u32 v7, v1, 3, s54
    v_lshlrev_b32 v8, 3, v1
    v_add_u32 v8, 109568, v8
    s_lshl_b32 s54, s3, 7
    s_add_u32 s54, s54, 111616
    v_mov_b32 v56, v60
    v_mov_b32 v57, v64
    s_mov_b64 exec, 0xffff
    s_cmp_eq_u32 s88, 0
    s_cbranch_scc1 L_gs_35
    buffer_store_dwordx4 v[56:59], v2, s[24:27], s65 offen
    s_branch L_ge_36
L_gs_35:
    buffer_store_dwordx4 v[56:59], v2, s[24:27], s65 offen sc0 sc1
L_ge_36:
    s_nop 1
    s_mov_b64 exec, -1
    ds_write_b128 v20, a[24:27] offset:24576
    ds_write_b128 v20, a[28:31] offset:28672
    ds_write_b128 v20, a[32:35] offset:32768
    s_waitcnt lgkmcnt(0)
    s_barrier
    ds_read_b64_tr_b16 a[80:81], v22 offset:24576
    ds_read_b64_tr_b16 a[82:83], v22 offset:25216
    ds_read_b64_tr_b16 a[84:85], v22 offset:29696
    ds_read_b64_tr_b16 a[86:87], v22 offset:30336
    ds_read_b64_tr_b16 a[88:89], v21 offset:24704
    ds_read_b64_tr_b16 a[90:91], v21 offset:25344
    ds_read_b64_tr_b16 a[92:93], v21 offset:29824
    ds_read_b64_tr_b16 a[94:95], v21 offset:30464
    v_lshl_add_u32 v12, v1, 1, s54
    v_add_u32 v13, s54, v5
    s_mul_i32 s66, s58, 20480
    s_lshl_b32 s67, s59, 7
    s_add_u32 s66, s66, s67
    s_add_u32 s66, s66, 0x6c0000
    s_lshl_b32 s67, s3, 12
    s_add_u32 s67, s67, s66
    s_add_u32 s66, s66, 16384
    v_lshlrev_b32 v3, 3, v14
    s_mov_b32 s90, 0
L_poll_37:
    s_nop 1
    buffer_load_dwordx4 v[44:47], v2, s[24:27], s64 offen sc1
    buffer_load_dwordx4 v[48:51], v2, s[24:27], s64 offen offset:1024 sc1
    s_waitcnt vmcnt(0)
    v_cmp_ne_u32 vcc, s6, v46
    v_cmp_ne_u32 s[98:99], s6, v50
    s_nop 0
    s_or_b64 vcc, vcc, s[98:99]
    s_nop 4
    s_cbranch_vccz L_done_38
    s_add_u32 s90, s90, 1
    s_cmp_lt_u32 s90, 40000
    s_cbranch_scc1 L_poll_37
L_done_38:
    s_nop 1
    v_pk_add_f32 v[44:45], v[44:45], v[48:49]
    ds_write_b64 v7, v[44:45]
    s_waitcnt lgkmcnt(0)
    s_barrier
    ds_read_b64 v[44:45], v8 offset:0
    ds_read_b64 v[46:47], v8 offset:512
    ds_read_b64 v[48:49], v8 offset:1024
    ds_read_b64 v[50:51], v8 offset:1536
    s_waitcnt lgkmcnt(2)
    v_pk_add_f32 v[44:45], v[44:45], v[46:47]
    s_waitcnt lgkmcnt(0)
    v_pk_add_f32 v[48:49], v[48:49], v[50:51]
    v_pk_add_f32 v[44:45], v[44:45], v[48:49]
    v_cvt_pk_bf16_f32 v44, v44, v45
    v_lshlrev_b32 v46, 16, v44
    v_and_b32 v47, s84, v44
    v_mul_f32 v48, 0xbfb8aa3b, v46
    v_exp_f32 v48, v48
    s_nop 0
    v_add_f32 v48, 1.0, v48
    v_rcp_f32 v48, v48
    s_nop 0
    v_mul_f32 v48, v48, v46
    v_cvt_pk_bf16_f32 v48, v48, v48
    v_lshlrev_b32 v48, 16, v48
    v_mul_f32 v48, v48, v47
    v_cvt_pk_bf16_f32 v48, v48, v48
    ds_write_b16 v12, v48
    ds_read_b128 v[44:47], v13
    ds_read_b128 v[48:51], v13 offset:64
    s_waitcnt lgkmcnt(1)
    v_mfma_f32_16x16x32_bf16 v[60:63], v[44:47], a[80:83], 0
    v_mfma_f32_16x16x32_bf16 v[64:67], v[44:47], a[88:91], 0
    s_waitcnt lgkmcnt(0)
    v_mfma_f32_16x16x32_bf16 v[60:63], v[48:51], a[84:87], v[60:63]
    v_mfma_f32_16x16x32_bf16 v[64:67], v[48:51], a[92:95], v[64:67]
    s_nop 6
    v_mov_b32 v61, s6
    v_mov_b32 v65, s6
    s_mov_b64 exec, 0xffff
    buffer_store_dwordx2 v[60:61], v3, s[24:27], s67 offen sc0 sc1
    s_cmp_lg_u32 s3, 0
    s_cbranch_scc1 L_skip_39
    buffer_store_dwordx2 v[64:65], v3, s[24:27], s66 offen sc0 sc1
    s_cmp_lg_u32 s93, 0
    s_cbranch_scc1 L_skip_40
    s_mov_b64 exec, 1
    buffer_store_dword v61, off, s[24:27], 0 sc0 sc1
L_skip_40:
    s_nop 1
L_skip_39:
    s_nop 1
    s_mov_b64 exec, -1
    v_cmp_ne_u32 vcc, s61, v35
    s_nop 0
    s_mov_b64 exec, vcc
    s_cbranch_execz L_no_41
    buffer_store_dwordx2 v[206:207], v30, s[28:31], 0 offen offset:0
    buffer_store_dwordx2 v[208:209], v30, s[28:31], 0 offen offset:32
    buffer_store_dwordx2 v[210:211], v30, s[28:31], 0 offen offset:64
    buffer_store_dwordx2 v[212:213], v30, s[28:31], 0 offen offset:96
    buffer_store_dwordx2 v[214:215], v30, s[28:31], 0 offen offset:128
L_no_41:
    s_mov_b64 exec, -1
    s_branch L_fin_32
L_F_31:
    s_nop 0
    v_cmp_ne_u32 vcc, s61, v35
    s_nop 0
    s_mov_b64 exec, vcc
    s_cbranch_execz L_no_42
    buffer_store_dwordx2 v[206:207], v30, s[28:31], 0 offen offset:0
    buffer_store_dwordx2 v[208:209], v30, s[28:31], 0 offen offset:32
    buffer_store_dwordx2 v[210:211], v30, s[28:31], 0 offen offset:64
    buffer_store_dwordx2 v[212:213], v30, s[28:31], 0 offen offset:96
    buffer_store_dwordx2 v[214:215], v30, s[28:31], 0 offen offset:128
L_no_42:
    s_mov_b64 exec, -1
    s_cmp_lg_u32 s3, 0
    s_cbranch_scc1 L_fin_32
    s_sub_u32 s58, s93, 216
    v_and_b32 v4, 7, v1
    s_lshl_b32 s54, s58, 5
    v_lshl_add_u32 v5, v4, 2, s54
    s_add_u32 s62, s62, 0x60000
    s_add_u32 s63, s62, 0x30000
    s_lshl_b32 s55, s58, 4
    s_add_u32 s55, s55, 3200
    v_lshl_add_u32 v6, v4, 1, s55
    v_lshrrev_b32 v7, 6, v6
    v_and_b32 v6, 63, v6
    v_lshlrev_b32 v6, 3, v6
    v_lshl_add_u32 v6, v7, 11, v6
    s_mov_b32 s90, 0
L_poll_43:
    s_nop 1
    buffer_load_dword v100, v5, s[24:27], s62 offen sc1
    buffer_load_dword v101, v5, s[24:27], s63 offen sc1
    buffer_load_dwordx4 v[104:107], v6, s[24:27], s70 offen offset:0 sc1
    buffer_load_dwordx4 v[108:111], v6, s[24:27], s70 offen offset:512 sc1
    buffer_load_dwordx4 v[112:115], v6, s[24:27], s70 offen offset:1024 sc1
    buffer_load_dwordx4 v[116:119], v6, s[24:27], s70 offen offset:1536 sc1
    s_waitcnt vmcnt(0)
    v_max_u32 v9, v100, v101
    v_cmp_eq_u32 vcc, -1, v9
    v_cmp_ne_u32 s[98:99], s6, v105
    s_nop 0
    s_or_b64 vcc, vcc, s[98:99]
    v_cmp_ne_u32 s[98:99], s6, v107
    s_nop 0
    s_or_b64 vcc, vcc, s[98:99]
    v_cmp_ne_u32 s[98:99], s6, v109
    s_nop 0
    s_or_b64 vcc, vcc, s[98:99]
    v_cmp_ne_u32 s[98:99], s6, v111
    s_nop 0
    s_or_b64 vcc, vcc, s[98:99]
    v_cmp_ne_u32 s[98:99], s6, v113
    s_nop 0
    s_or_b64 vcc, vcc, s[98:99]
    v_cmp_ne_u32 s[98:99], s6, v115
    s_nop 0
    s_or_b64 vcc, vcc, s[98:99]
    v_cmp_ne_u32 s[98:99], s6, v117
    s_nop 0
    s_or_b64 vcc, vcc, s[98:99]
    v_cmp_ne_u32 s[98:99], s6, v119
    s_nop 0
    s_or_b64 vcc, vcc, s[98:99]
    s_nop 4
    s_cbranch_vccz L_done_44
    s_add_u32 s90, s90, 1
    s_cmp_lt_u32 s90, 40000
    s_cbranch_scc1 L_poll_43
L_done_44:
    s_nop 1
    v_add_f32 v104, v104, v108
    v_add_f32 v112, v112, v116
    v_add_f32 v106, v106, v110
    v_add_f32 v114, v114, v118
    v_add_f32 v104, v104, v112
    v_add_f32 v106, v106, v114
    v_cvt_pk_bf16_f32 v102, v104, v106
    v_lshlrev_b32 v104, 16, v100
    v_and_b32 v105, s84, v100
    v_lshlrev_b32 v106, 16, v101
    v_and_b32 v107, s84, v101
    v_lshlrev_b32 v108, 16, v102
    v_and_b32 v109, s84, v102
    s_andn2_b32 s64, s60, 0x7ff
    s_ashr_i32 s65, s64, 31
    s_not_b32 s65, s65
    s_or_b32 s65, s65, 0x80000000
    s_xor_b32 s64, s64, s65
    v_mov_b32 v110, s64
    v_cvt_pk_bf16_f32 v110, v110, v110
    v_lshlrev_b32 v110, 16, v110
    v_mul_f32 v110, 0xbfb8aa3b, v110
    v_exp_f32 v110, v110
    s_nop 0
    v_add_f32 v110, 1.0, v110
    v_rcp_f32 v110, v110
    s_nop 0
    v_cvt_pk_bf16_f32 v110, v110, v110
    v_lshlrev_b32 v110, 16, v110
    s_lshl_b32 s55, s58, 12
    s_add_u32 s55, s55, 0x6c0000
    v_min_u32 v7, 368, v2
    v_cmp_gt_u32 s[56:57], 24, v1
    s_mul_i32 s61, s61, 1280
    s_mov_b32 s90, 0
L_poll_45:
    s_nop 1
    buffer_load_dwordx4 v[44:47], v2, s[24:27], s55 offen offset:0 sc1
    buffer_load_dwordx4 v[48:51], v2, s[24:27], s55 offen offset:1024 sc1
    buffer_load_dwordx4 v[52:55], v2, s[24:27], s55 offen offset:2048 sc1
    buffer_load_dwordx4 v[56:59], v7, s[24:27], s55 offen offset:3072 sc1
    s_waitcnt vmcnt(0)
    v_cmp_ne_u32 vcc, s6, v45
    v_cmp_ne_u32 s[98:99], s6, v47
    s_nop 0
    s_or_b64 vcc, vcc, s[98:99]
    v_cmp_ne_u32 s[98:99], s6, v49
    s_nop 0
    s_or_b64 vcc, vcc, s[98:99]
    v_cmp_ne_u32 s[98:99], s6, v51
    s_nop 0
    s_or_b64 vcc, vcc, s[98:99]
    v_cmp_ne_u32 s[98:99], s6, v53
    s_nop 0
    s_or_b64 vcc, vcc, s[98:99]
    v_cmp_ne_u32 s[98:99], s6, v55
    s_nop 0
    s_or_b64 vcc, vcc, s[98:99]
    v_cmp_ne_u32 s[98:99], s6, v57
    s_nop 0
    s_or_b64 vcc, vcc, s[98:99]
    v_cmp_ne_u32 s[98:99], s6, v59
    s_nop 0
    s_or_b64 vcc, vcc, s[98:99]
    s_nop 4
    s_cbranch_vccz L_done_46
    s_add_u32 s90, s90, 1
    s_cmp_lt_u32 s90, 40000
    s_cbranch_scc1 L_poll_45
L_done_46:
    s_nop 1
    v_cndmask_b32 v56, 0, v56, s[56:57]
    v_cndmask_b32 v58, 0, v58, s[56:57]
    v_add_f32 v44, v44, v48
    v_add_f32 v52, v52, v56
    v_add_f32 v46, v46, v50
    v_add_f32 v54, v54, v58
    v_add_f32 v44, v44, v52
    v_add_f32 v45, v46, v54
    s_nop 0
    v_add_f32_dpp v44, v44, v44 row_ror:8 row_mask:0xf bank_mask:0xf
    v_add_f32_dpp v45, v45, v45 row_ror:8 row_mask:0xf bank_mask:0xf
    v_mov_b32 v46, v44
    v_mov_b32 v47, v45
    s_nop 0
    v_permlane16_swap_b32 v44, v46
    v_permlane16_swap_b32 v45, v47
    v_add_f32 v44, v44, v46
    v_add_f32 v45, v45, v47
    v_mov_b32 v46, v44
    v_mov_b32 v47, v45
    s_nop 0
    v_permlane32_swap_b32 v44, v46
    v_permlane32_swap_b32 v45, v47
    v_add_f32 v44, v44, v46
    v_add_f32 v45, v45, v47
    v_cvt_pk_bf16_f32 v46, v44, v45
    v_lshlrev_b32 v44, 16, v46
    v_and_b32 v45, s84, v46
    v_pk_mul_f32 v[44:45], v[44:45], v[110:111] op_sel_hi:[1,0]
    v_cvt_pk_bf16_f32 v46, v44, v45
    v_lshlrev_b32 v44, 16, v46
    v_and_b32 v45, s84, v46
    v_pk_add_f32 v[44:45], v[44:45], v[104:105]
    v_cvt_pk_bf16_f32 v46, v44, v45
    v_lshlrev_b32 v44, 16, v46
    v_and_b32 v45, s84, v46
    v_pk_mul_f32 v[44:45], v[44:45], v[108:109]
    v_cvt_pk_bf16_f32 v46, v44, v45
    v_lshlrev_b32 v44, 16, v46
    v_and_b32 v45, s84, v46
    v_pk_add_f32 v[44:45], v[44:45], v[106:107]
    v_cvt_pk_bf16_f32 v46, v44, v45
    s_mov_b64 exec, 0xff
    buffer_store_dword v46, v5, s[28:31], s61 offen
L_fin_32:
    s_nop 0
    s_endpgm
L_exit:
    s_endpgm
L_code_end:
.section .rodata,"a"
.p2align 6
.amdhsa_kernel adaLN_cond__sliding_local_dilated__moe_arch_mod__prompt_kernel
  .amdhsa_next_free_vgpr 512
  .amdhsa_next_free_sgpr 102
  .amdhsa_accum_offset 256
  .amdhsa_group_segment_fixed_size 0
  .amdhsa_kernarg_size 104
  .amdhsa_user_sgpr_count 2
  .amdhsa_user_sgpr_kernarg_segment_ptr 1
  .amdhsa_system_sgpr_workgroup_id_x 1
.end_amdhsa_kernel
```

```asm
; @launch grid=(256,1,1) block=(256,1,1) lds=163840
.amdgcn_target "amdgcn-amd-amdhsa--gfx950"
.text
.globl adaLN_cond__sliding_local_dilated__moe_arch_mod__prompt_kernel
.p2align 8
.type adaLN_cond__sliding_local_dilated__moe_arch_mod__prompt_kernel,@function
adaLN_cond__sliding_local_dilated__moe_arch_mod__prompt_kernel:
    s_cmp_ge_u32 s2, 256
    s_cbranch_scc1 L_exit
    s_load_dwordx8 s[64:71], s[0:1], 64
    s_load_dwordx2 s[72:73], s[0:1], 96
    s_load_dwordx16 s[48:63], s[0:1], 0
    s_getpc_b64 s[74:75]
L_pc:
    s_and_b32 s94, s2, 7
    s_lshr_b32 s95, s2, 3
    s_sub_u32 s96, s95, 24
    s_lshl_b32 s96, s96, 13
    v_lshl_add_u32 v2, v0, 7, s96
    v_cmp_gt_u32 vcc, 64, v0
    s_mov_b32 s97, L_code_end-L_pc-4
    v_cmp_gt_u32 s[98:99], s97, v2
    v_lshrrev_b32 v3, 6, v0
    s_and_b64 exec, vcc, s[98:99]
    s_cbranch_execz L_nopf
    global_load_dword v253, v2, s[74:75]
L_nopf:
    s_mov_b64 exec, -1
    v_readfirstlane_b32 s3, v3
    s_and_b32 s96, s94, 3
    s_mov_b32 s85, s2
    v_lshrrev_b32 v6, 3, v0
    v_and_b32 v7, 7, v0
    v_mul_u32_u24 v40, 7680, v6
    v_lshl_add_u32 v40, v7, 4, v40
    v_lshlrev_b32 v44, 1, v0
    s_lshr_b32 s97, s85, 2
    s_min_u32 s97, s97, 59
    s_lshl_b32 s82, s97, 7
    s_mul_i32 s83, s96, 320
    s_mul_i32 s96, s96, 1228800
    s_add_u32 s82, s82, s96
    s_lshl_b32 s78, s3, 10
    s_add_u32 m0, s78, 110592
    s_mov_b32 s22, 0x4b0000
    s_mov_b32 s23, 0x20000
    s_mov_b32 s34, 0x500
    s_mov_b32 s35, 0x20000
    s_waitcnt lgkmcnt(0)
    s_mov_b64 s[32:33], s[64:65]
    s_mov_b64 s[20:21], s[66:67]
    buffer_load_ushort v60, v44, s[32:35], s83 offen
    buffer_load_dwordx4 v40, s[20:23], s82 offen lds
    s_add_u32 m0, m0, 4096
    s_add_u32 s82, s82, 245760
    buffer_load_dwordx4 v40, s[20:23], s82 offen lds
    s_add_u32 m0, m0, 4096
    s_add_u32 s82, s82, 245760
    buffer_load_dwordx4 v40, s[20:23], s82 offen lds
    s_add_u32 m0, m0, 4096
    s_add_u32 s82, s82, 245760
    buffer_load_dwordx4 v40, s[20:23], s82 offen lds
    s_add_u32 m0, m0, 4096
    s_add_u32 s82, s82, 245760
    buffer_load_dwordx4 v40, s[20:23], s82 offen lds
    s_load_dword s6, s[72:73], 0
    v_and_b32 v1, 63, v0
    s_lshr_b32 s96, s94, 0
    s_lshl_b32 s4, s96, 1
    s_lshr_b32 s96, s95, 4
    s_add_u32 s4, s4, s96
    s_and_b32 s5, s95, 15
    s_lshr_b32 s88, s5, 3
    s_and_b32 s87, s5, 7
    s_mov_b64 s[8:9], s[48:49]
    s_mov_b32 s10, 0x280000
    s_mov_b32 s11, 0x20000
    s_lshl_b32 s48, s4, 7
    v_lshrrev_b32 v10, 5, v1
    v_and_b32 v11, 31, v1
    s_lshl_b32 s96, s5, 3
    s_add_u32 s96, s96, s48
    s_lshl_b32 s97, s3, 1
    s_add_u32 s96, s96, s97
    v_add_u32 v62, s96, v10
    v_mul_u32_u24 v53, 1280, v62
    v_lshl_add_u32 v2, v11, 3, v53
    v_lshl_add_u32 v53, v11, 4, v53
    buffer_load_dwordx4 v[160:163], v53, s[8:11], 0 offen offset:0
    buffer_load_dwordx4 v[164:167], v53, s[8:11], 0 offen offset:512
    buffer_load_dwordx2 v[168:169], v2, s[8:11], 0 offen offset:1024
    v_mul_u32_u24 v3, 13, v1
    v_lshrrev_b32 v3, 6, v3
    v_mul_u32_u24 v4, 5, v3
    v_sub_u32 v4, v1, v4
    s_mul_i32 s96, s3, 1280
    s_mul_i32 s97, s5, 80
    s_add_u32 s96, s96, s97
    s_lshl_b32 s97, s87, 1
    s_add_u32 s97, s97, s88
    s_mul_i32 s97, s97, 80
    s_movk_i32 s98, 3840
    s_mov_b32 s18, 2457600
    s_cmp_eq_u32 s3, 3
    s_cselect_b32 s98, 1280, s98
    s_cselect_b32 s96, s97, s96
    s_cselect_b64 s[16:17], s[52:53], s[50:51]
    s_cselect_b32 s18, 819200, s18
    s_cselect_b32 s13, 0xffff, -1
    s_mov_b32 s19, 0x20000
    s_mul_i32 s97, s98, 40
    s_mul_i32 s97, s97, s4
    s_add_u32 s96, s96, s97
    s_mul_i32 s99, s98, 10
    v_mul_lo_u32 v3, v3, s98
    v_lshl_add_u32 v55, v4, 4, v3
    s_mov_b32 s86, s96
    s_mov_b32 s89, s99
    v_lshlrev_b32 v62, 4, v62
    v_and_b32 v14, 15, v1
    v_lshrrev_b32 v15, 4, v1
    v_xor_b32 v19, v14, v15
    v_lshlrev_b32 v19, 4, v19
    v_mul_u32_u24 v2, 1280, v15
    v_add_u32 v236, v2, v19
    v_add_u32 v3, 4096, v2
    v_xad_u32 v237, v19, 64, v3
    v_add_u32 v3, 8192, v2
    s_movk_i32 s96, 128
    v_xad_u32 v238, v19, s96, v3
    v_add_u32 v3, 12288, v2
    s_movk_i32 s96, 192
    v_xad_u32 v239, v19, s96, v3
    s_lshl_b32 s96, s3, 5
    s_add_u32 s96, s96, s48
    s_mul_i32 s79, s96, 1280
    s_lshl_b32 s96, s3, 2
    s_add_u32 s96, s96, s48
    s_sub_u32 s96, s96, 16
    v_add_u32 v3, s96, v15
    v_max_i32 v3, 0, v3
    v_mul_u32_u24 v3, 1280, v3
    s_lshl_b32 s96, s3, 6
    v_xad_u32 v240, v19, s96, v3
    s_mul_i32 s76, s5, 5
    s_lshr_b32 s76, s76, 4
    s_lshl_b32 s77, s76, 8
    s_lshl_b32 s49, s3, 13
    s_lshl_b32 s96, s95, 2
    s_add_u32 s96, s96, s3
    s_lshl_b32 s96, s96, 8
    s_min_u32 s96, s96, L_code_end-L_pc-132
    s_add_u32 s0, s74, s96
    s_addc_u32 s1, s75, 0
    s_mov_b64 s[24:25], s[72:73]
    s_mov_b32 s26, 0xc00000
    s_mov_b32 s27, 0x20000
    s_mov_b64 s[36:37], s[56:57]
    s_mov_b32 s38, 0x500
    s_mov_b32 s39, 0x20000
    s_mov_b64 s[28:29], s[68:69]
    s_mov_b32 s30, 0x280000
    s_mov_b32 s31, 0x20000
    s_mov_b64 s[40:41], s[58:59]
    s_mov_b32 s42, 0x21c000
    s_mov_b32 s43, 0x20000
    s_mov_b64 s[44:45], s[60:61]
    s_mov_b32 s46, 0x21c000
    s_mov_b32 s47, 0x20000
    s_mov_b64 s[32:33], s[62:63]
    s_mov_b32 s34, 2211840
    s_mov_b32 s84, 0xffff0000
    s_mov_b32 s94, s87
    s_lshl_b32 s95, s4, 1
    s_add_u32 s95, s95, s88
    s_lshl_b32 s93, s95, 3
    s_add_u32 s93, s93, s94
    s_mov_b32 s70, 0xd0000
    s_mov_b32 s65, 0x8000
    v_lshrrev_b32 v2, 2, v14
    v_and_b32 v3, 3, v14
    v_lshlrev_b32 v3, 3, v3
    s_lshl_b32 s52, s3, 5
    s_add_u32 s52, s52, 110592
    v_lshl_add_u32 v4, v15, 3, v2
    v_lshlrev_b32 v4, 7, v4
    v_add3_u32 v42, v4, v3, s52
    s_mov_b32 s52, 160512
    v_lshl_add_u32 v41, v15, 4, s52
    v_add_u32 v44, s52, v44
    v_lshlrev_b32 v43, 3, v14
    s_lshl_b32 s83, s85, 9
    s_lshl_b32 s52, s3, 7
    s_add_u32 s83, s83, s52
    s_add_u32 s83, s83, 0xd0000
    s_lshl_b32 s52, s3, 2
    v_add_u32 v4, s52, v15
    v_mul_u32_u24 v5, 13, v4
    v_lshrrev_b32 v5, 6, v5
    v_mul_u32_u24 v6, 5, v5
    v_sub_u32 v6, v4, v6
    v_mul_u32_u24 v2, 80, v2
    s_mov_b32 s52, 147456
    v_add3_u32 v2, v2, v3, s52
    v_mul_u32_u24 v4, 640, v4
    v_add_u32 v45, v4, v2
    v_mul_u32_u24 v4, 320, v6
    v_lshl_add_u32 v4, v5, 5, v4
    v_add_u32 v46, v4, v2
    v_mul_u32_u24 v7, 40, v5
    v_add_u32 v7, v7, v14
    v_lshrrev_b32 v8, 4, v7
    v_mul_u32_u24 v8, 768, v8
    v_lshl_add_u32 v8, v7, 4, v8
    s_mul_i32 s53, s4, 5
    v_add_u32 v9, s53, v6
    v_lshl_add_u32 v8, v9, 8, v8
    v_lshrrev_b32 v4, 2, v9
    v_mul_u32_u24 v4, 7168, v4
    v_add_u32 v47, v4, v8
    s_mul_i32 s75, s5, 167936
    s_add_u32 s75, s75, 0x800000
    v_lshlrev_b32 v7, 3, v7
    v_lshl_add_u32 v7, v6, 10, v7
    v_add_u32 v51, s52, v7
    v_and_b32 v4, 7, v14
    v_lshl_add_u32 v4, v9, 3, v4
    v_cmp_gt_u32 vcc, 8, v14
    v_add_u32 v7, 640, v4
    s_mov_b32 s12, -1
    v_cndmask_b32 v4, v4, v7, vcc
    v_cndmask_b32 v50, 0, 1.0, vcc
    s_and_b64 s[14:15], s[12:13], vcc
    v_lshrrev_b32 v7, 6, v4
    v_mul_u32_u24 v7, 1536, v7
    v_lshl_add_u32 v49, v4, 3, v7
    v_lshl_add_u32 v4, v5, 4, v14
    v_mul_u32_u24 v7, 1280, v6
    v_lshl_add_u32 v7, v4, 4, v7
    s_mul_i32 s53, s4, -3840
    s_add_u32 s53, s53, 76800
    v_cmp_eq_u32 vcc, 4, v6
    v_add_u32 v8, s53, v7
    v_mov_b32 v9, 0x7ff00000
    v_cndmask_b32 v7, v7, v8, vcc
    v_cmp_gt_u32 vcc, 40, v4
    s_mul_i32 s53, s87, 102400
    s_mul_i32 s54, s4, 5120
    v_cndmask_b32 v48, v9, v7, vcc
    s_add_u32 s60, s53, 0x700000
    s_add_u32 s53, s60, s54
    s_mul_i32 s54, s88, 640
    s_add_u32 s81, s53, s54
    s_lshl_b32 s52, s5, 11
    s_add_u32 s51, s52, 0x3c0000
    s_lshl_b32 s52, s4, 7
    s_add_u32 s50, s52, s51
    v_lshlrev_b32 v52, 7, v14
    s_lshl_b32 s52, s87, 12
    s_add_u32 s69, s52, 0xc0000
    s_lshl_b32 s53, s95, 7
    s_add_u32 s68, s69, s53
    s_lshl_b32 s52, s4, 4
    s_add_u32 s52, s52, s5
    s_lshl_b32 s52, s52, 7
    s_add_u32 s52, s52, 0x8000
    s_cmp_eq_u32 s3, 1
    s_cselect_b32 s52, s68, s52
    s_cmp_eq_u32 s3, 0
    s_cselect_b32 s52, s50, s52
    s_sub_u32 s52, s52, 128
    v_mov_b32 v2, s83
    v_mov_b32 v3, s52
    v_cndmask_b32 v2, v3, v2, s[14:15]
    v_lshl_add_u32 v63, v14, 4, v2
    v_lshlrev_b32 v26, 4, v1
    v_lshlrev_b32 v2, 8, v14
    v_add_u32 v2, 73728, v2
    v_add_u32 v20, v2, v19
    v_xad_u32 v21, v19, 64, v2
    s_movk_i32 s52, 128
    v_xad_u32 v22, v19, s52, v2
    s_movk_i32 s52, 192
    v_xad_u32 v23, v19, s52, v2
    s_cmp_eq_u32 s3, 3
    s_cselect_b32 s52, 0x37f, -1
    v_and_b32 v29, s52, v26
    s_lshl_b32 s52, s3, 11
    s_add_u32 s80, s75, s52
    s_lshl_b32 s52, s76, 15
    s_add_u32 s72, s80, s52
    s_add_u32 s73, s80, 163840
    s_waitcnt vmcnt(8)
    v_lshlrev_b32 v60, 16, v60
    v_mul_f32 v2, 0xbfb8aa3b, v60
    v_exp_f32 v2, v2
    s_nop 0
    v_add_f32 v2, 1.0, v2
    v_rcp_f32 v2, v2
    s_nop 0
    v_mul_f32 v2, v2, v60
    v_cvt_pk_bf16_f32 v2, v2, v2
    ds_write_b16 v44, v2
    s_waitcnt lgkmcnt(0)
    s_add_u32 s6, s6, 0x9e3779b9
    v_mov_b32 v39, s6
    v_not_b32 v56, v39
    v_not_b32 v57, v39
    v_not_b32 v58, v39
    v_not_b32 v59, v39
    s_cmp_eq_u32 s3, 3
    s_movk_i32 s52, 0xff
    s_cselect_b32 exec_lo, s52, 0xffff
    s_mov_b32 exec_hi, 0
    buffer_store_dwordx4 v[56:59], v63, s[24:27], 0 offen sc0 sc1
    s_mov_b64 exec, -1
    s_mul_i32 s97, s3, 3200
    s_add_u32 m0, s97, 147456
    s_mov_b32 exec_hi, 0x3ffff
    buffer_load_dwordx4 v55, s[16:19], s86 offen lds
    s_add_u32 m0, m0, 800
    s_add_u32 s86, s86, s89
    buffer_load_dwordx4 v55, s[16:19], s86 offen lds
    s_add_u32 m0, m0, 800
    s_add_u32 s86, s86, s89
    buffer_load_dwordx4 v55, s[16:19], s86 offen lds
    s_add_u32 m0, m0, 800
    s_add_u32 s86, s86, s89
    buffer_load_dwordx4 v55, s[16:19], s86 offen lds
    s_mov_b32 exec_hi, -1
    s_waitcnt vmcnt(8)
    s_barrier
    ds_read_b128 v[112:115], v41 offset:0
    ds_read_b64_tr_b16 v[132:133], v42 offset:0
    ds_read_b64_tr_b16 v[134:135], v42 offset:512
    ds_read_b128 v[116:119], v41 offset:64
    ds_read_b64_tr_b16 v[136:137], v42 offset:4096
    ds_read_b64_tr_b16 v[138:139], v42 offset:4608
    ds_read_b128 v[120:123], v41 offset:128
    ds_read_b64_tr_b16 v[140:141], v42 offset:8192
    ds_read_b64_tr_b16 v[142:143], v42 offset:8704
    ds_read_b128 v[124:127], v41 offset:192
    ds_read_b64_tr_b16 v[144:145], v42 offset:12288
    ds_read_b64_tr_b16 v[146:147], v42 offset:12800
    ds_read_b128 v[128:131], v41 offset:256
    ds_read_b64_tr_b16 v[148:149], v42 offset:16384
    ds_read_b64_tr_b16 v[150:151], v42 offset:16896
    s_waitcnt lgkmcnt(12)
    v_mfma_f32_16x16x32_bf16 v[152:155], v[112:115], v[132:135], 0
    s_waitcnt lgkmcnt(9)
    v_mfma_f32_16x16x32_bf16 v[152:155], v[116:119], v[136:139], v[152:155]
    s_waitcnt lgkmcnt(6)
    v_mfma_f32_16x16x32_bf16 v[152:155], v[120:123], v[140:143], v[152:155]
    s_waitcnt lgkmcnt(3)
    v_mfma_f32_16x16x32_bf16 v[152:155], v[124:127], v[144:147], v[152:155]
    s_waitcnt lgkmcnt(0)
    v_mfma_f32_16x16x32_bf16 v[152:155], v[128:131], v[148:151], v[152:155]
    s_mov_b64 exec, 0xffff
    s_nop 6
    v_mov_b32 v153, s6
    buffer_store_dwordx2 v[152:153], v43, s[24:27], s83 offen sc0 sc1
    s_mov_b64 exec, -1
    s_add_u32 m0, s49, 77824
    s_add_u32 s7, s79, s77
    buffer_load_dwordx4 v236, s[8:11], s7 offen offset:0 lds
    buffer_load_dwordx4 v237, s[8:11], s7 offen offset:1024 lds
    buffer_load_dwordx4 v238, s[8:11], s7 offen offset:2048 lds
    buffer_load_dwordx4 v239, s[8:11], s7 offen offset:3072 lds
    s_add_u32 m0, m0, 4096
    s_add_u32 s7, s7, 20480
    buffer_load_dwordx4 v236, s[8:11], s7 offen offset:0 lds
    buffer_load_dwordx4 v237, s[8:11], s7 offen offset:1024 lds
    buffer_load_dwordx4 v238, s[8:11], s7 offen offset:2048 lds
    buffer_load_dwordx4 v239, s[8:11], s7 offen offset:3072 lds
    s_add_u32 m0, s78, 73728
    s_nop 0
    buffer_load_dwordx4 v240, s[8:11], s77 offen lds
    s_add_u32 s77, s77, 256
    s_cmp_eq_u32 s77, 1280
    s_cselect_b32 s77, 0, s77
    s_lshl_b32 s86, s95, 2
    s_add_u32 s86, s86, s3
    s_mul_i32 s52, s86, 1280
    s_mul_i32 s53, s87, 160
    s_add_u32 s52, s52, s53
    s_add_u32 s92, s52, 0x60000
    s_lshl_b32 s52, s5, 4
    s_add_u32 s52, s52, s4
    s_lshl_b32 s52, s52, 10
    s_add_u32 s74, s52, 0x380000
    v_lshrrev_b32 v4, 3, v0
    v_and_b32 v5, 7, v0
    s_mul_i32 s56, s94, 80
    v_add_u32 v6, s56, v4
    v_mul_u32_u24 v6, 3456, v6
    v_lshl_add_u32 v6, v5, 4, v6
    s_lshl_b32 s56, s95, 7
    s_mul_i32 s89, s95, 81920
    s_mul_i32 s55, s94, 160
    s_add_u32 s89, s89, s55
    s_cmp_ge_u32 s93, 216
    s_cselect_b32 s56, 0x7ff00000, s56
    s_cselect_b32 s89, 0, s89
    v_add_u32 v31, s56, v6
    v_mov_b32 v7, 0x7ff00000
    v_cmp_gt_u32 vcc, 16, v4
    s_mov_b32 s16, 110592
    s_mov_b32 s17, 221184
    v_cndmask_b32 v32, v7, v31, vcc
    s_waitcnt vmcnt(10)
    s_barrier
    ds_read_b64_tr_b16 v[76:77], v46 offset:9600
    ds_read_b64_tr_b16 v[78:79], v46 offset:11200
    ds_read_b64_tr_b16 v[64:65], v45 offset:0
    ds_read_b64_tr_b16 v[66:67], v45 offset:320
    ds_read_b64_tr_b16 v[68:69], v45 offset:32
    ds_read_b64_tr_b16 v[70:71], v45 offset:352
    ds_read_b64_tr_b16 v[72:73], v45 offset:64
    ds_read_b64_tr_b16 v[74:75], v45 offset:384
    s_waitcnt lgkmcnt(6)
    buffer_store_dwordx4 v[76:79], v48, s[24:27], s81 offen sc0 sc1
    buffer_load_dwordx2 v[104:105], v49, s[24:27], s70 offen offset:0 sc1
    buffer_load_dwordx2 v[106:107], v49, s[24:27], s70 offen offset:512 sc1
    buffer_load_dwordx2 v[108:109], v49, s[24:27], s70 offen offset:1024 sc1
    buffer_load_dwordx2 v[110:111], v49, s[24:27], s70 offen offset:1536 sc1
    s_waitcnt lgkmcnt(5)
    v_lshlrev_b32 v80, 16, v64
    v_and_b32 v81, s84, v64
    v_lshlrev_b32 v82, 16, v65
    v_and_b32 v83, s84, v65
    s_waitcnt lgkmcnt(4)
    v_lshlrev_b32 v84, 16, v66
    v_and_b32 v85, s84, v66
    v_lshlrev_b32 v86, 16, v67
    v_and_b32 v87, s84, v67
    s_waitcnt lgkmcnt(3)
    v_lshlrev_b32 v88, 16, v68
    v_and_b32 v89, s84, v68
    v_lshlrev_b32 v90, 16, v69
    v_and_b32 v91, s84, v69
    s_waitcnt lgkmcnt(2)
    v_lshlrev_b32 v92, 16, v70
    v_and_b32 v93, s84, v70
    v_lshlrev_b32 v94, 16, v71
    v_and_b32 v95, s84, v71
    s_waitcnt lgkmcnt(1)
    v_lshlrev_b32 v96, 16, v72
    v_and_b32 v97, s84, v72
    v_lshlrev_b32 v98, 16, v73
    v_and_b32 v99, s84, v73
    s_waitcnt lgkmcnt(0)
    v_lshlrev_b32 v100, 16, v74
    v_and_b32 v101, s84, v74
    v_lshlrev_b32 v102, 16, v75
    v_and_b32 v103, s84, v75
    s_barrier
    s_waitcnt vmcnt(3)
    v_cmp_ne_u32 vcc, s6, v105
    s_waitcnt vmcnt(2)
    v_cmp_ne_u32 s[98:99], s6, v107
    s_nop 0
    s_or_b64 vcc, vcc, s[98:99]
    s_waitcnt vmcnt(1)
    v_cmp_ne_u32 s[98:99], s6, v109
    s_nop 0
    s_or_b64 vcc, vcc, s[98:99]
    s_waitcnt vmcnt(0)
    v_cmp_ne_u32 s[98:99], s6, v111
    s_nop 0
    s_or_b64 vcc, vcc, s[98:99]
    s_nop 4
    s_cbranch_vccz L_done_2
    s_mov_b32 s90, 0
L_poll_1:
    s_nop 1
    buffer_load_dwordx2 v[104:105], v49, s[24:27], s70 offen offset:0 sc1
    buffer_load_dwordx2 v[106:107], v49, s[24:27], s70 offen offset:512 sc1
    buffer_load_dwordx2 v[108:109], v49, s[24:27], s70 offen offset:1024 sc1
    buffer_load_dwordx2 v[110:111], v49, s[24:27], s70 offen offset:1536 sc1
    s_waitcnt vmcnt(0)
    v_cmp_ne_u32 vcc, s6, v105
    v_cmp_ne_u32 s[98:99], s6, v107
    s_nop 0
    s_or_b64 vcc, vcc, s[98:99]
    v_cmp_ne_u32 s[98:99], s6, v109
    s_nop 0
    s_or_b64 vcc, vcc, s[98:99]
    v_cmp_ne_u32 s[98:99], s6, v111
    s_nop 0
    s_or_b64 vcc, vcc, s[98:99]
    s_nop 4
    s_cbranch_vccz L_done_2
    s_add_u32 s90, s90, 1
    s_cmp_lt_u32 s90, 40000
    s_cbranch_scc1 L_poll_1
L_done_2:
    s_nop 1
    v_add_f32 v104, v104, v106
    v_add_f32 v108, v108, v110
    v_add_f32 v104, v104, v108
    v_cvt_pk_bf16_f32 v104, 0, v104
    v_add_f32 v104, v104, v50
    v_cvt_pk_bf16_f32 v104, 0, v104
    s_nop 1
    v_mul_f32_dpp v112, v104, v80 row_newbcast:0 row_mask:0xf bank_mask:0xf
    v_mul_f32_dpp v113, v104, v81 row_newbcast:1 row_mask:0xf bank_mask:0xf
    v_mul_f32_dpp v114, v104, v82 row_newbcast:2 row_mask:0xf bank_mask:0xf
    v_mul_f32_dpp v115, v104, v83 row_newbcast:3 row_mask:0xf bank_mask:0xf
    v_mul_f32_dpp v116, v104, v84 row_newbcast:4 row_mask:0xf bank_mask:0xf
    v_mul_f32_dpp v117, v104, v85 row_newbcast:5 row_mask:0xf bank_mask:0xf
    v_mul_f32_dpp v118, v104, v86 row_newbcast:6 row_mask:0xf bank_mask:0xf
    v_mul_f32_dpp v119, v104, v87 row_newbcast:7 row_mask:0xf bank_mask:0xf
    v_cvt_pk_bf16_f32 v64, v112, v113
    v_cvt_pk_bf16_f32 v65, v114, v115
    v_cvt_pk_bf16_f32 v66, v116, v117
    v_cvt_pk_bf16_f32 v67, v118, v119
    s_mov_b64 exec, s[12:13]
    buffer_store_dwordx4 v[64:67], v47, s[24:27], s75 offen offset:0 sc0 sc1
    s_mov_b64 exec, -1
    v_mul_f32_dpp v120, v104, v88 row_newbcast:0 row_mask:0xf bank_mask:0xf
    v_mul_f32_dpp v121, v104, v89 row_newbcast:1 row_mask:0xf bank_mask:0xf
    v_mul_f32_dpp v122, v104, v90 row_newbcast:2 row_mask:0xf bank_mask:0xf
    v_mul_f32_dpp v123, v104, v91 row_newbcast:3 row_mask:0xf bank_mask:0xf
    v_mul_f32_dpp v124, v104, v92 row_newbcast:4 row_mask:0xf bank_mask:0xf
    v_mul_f32_dpp v125, v104, v93 row_newbcast:5 row_mask:0xf bank_mask:0xf
    v_mul_f32_dpp v126, v104, v94 row_newbcast:6 row_mask:0xf bank_mask:0xf
    v_mul_f32_dpp v127, v104, v95 row_newbcast:7 row_mask:0xf bank_mask:0xf
    v_cvt_pk_bf16_f32 v68, v120, v121
    v_cvt_pk_bf16_f32 v69, v122, v123
    v_cvt_pk_bf16_f32 v70, v124, v125
    v_cvt_pk_bf16_f32 v71, v126, v127
    s_mov_b64 exec, s[12:13]
    buffer_store_dwordx4 v[68:71], v47, s[24:27], s75 offen offset:1024 sc0 sc1
    s_mov_b64 exec, -1
    v_mul_f32_dpp v128, v104, v96 row_newbcast:0 row_mask:0xf bank_mask:0xf
    v_mul_f32_dpp v129, v104, v97 row_newbcast:1 row_mask:0xf bank_mask:0xf
    v_mul_f32_dpp v130, v104, v98 row_newbcast:2 row_mask:0xf bank_mask:0xf
    v_mul_f32_dpp v131, v104, v99 row_newbcast:3 row_mask:0xf bank_mask:0xf
    v_mul_f32_dpp v132, v104, v100 row_newbcast:4 row_mask:0xf bank_mask:0xf
    v_mul_f32_dpp v133, v104, v101 row_newbcast:5 row_mask:0xf bank_mask:0xf
    v_mul_f32_dpp v134, v104, v102 row_newbcast:6 row_mask:0xf bank_mask:0xf
    v_mul_f32_dpp v135, v104, v103 row_newbcast:7 row_mask:0xf bank_mask:0xf
    v_cvt_pk_bf16_f32 v72, v128, v129
    v_cvt_pk_bf16_f32 v73, v130, v131
    v_cvt_pk_bf16_f32 v74, v132, v133
    v_cvt_pk_bf16_f32 v75, v134, v135
    s_mov_b64 exec, s[14:15]
    buffer_store_dwordx4 v[72:75], v47, s[24:27], s75 offen offset:2048 sc0 sc1
    s_mov_b64 exec, -1
    s_add_u32 m0, s49, 4096
    s_add_u32 s7, s79, s77
    buffer_load_dwordx4 v236, s[8:11], s7 offen offset:0 lds
    buffer_load_dwordx4 v237, s[8:11], s7 offen offset:1024 lds
    buffer_load_dwordx4 v238, s[8:11], s7 offen offset:2048 lds
    buffer_load_dwordx4 v239, s[8:11], s7 offen offset:3072 lds
    s_add_u32 m0, m0, 4096
    s_add_u32 s7, s7, 20480
    buffer_load_dwordx4 v236, s[8:11], s7 offen offset:0 lds
    buffer_load_dwordx4 v237, s[8:11], s7 offen offset:1024 lds
    buffer_load_dwordx4 v238, s[8:11], s7 offen offset:2048 lds
    buffer_load_dwordx4 v239, s[8:11], s7 offen offset:3072 lds
    s_add_u32 m0, s78, 0
    s_nop 0
    buffer_load_dwordx4 v240, s[8:11], s77 offen lds
    s_add_u32 s77, s77, 256
    s_cmp_eq_u32 s77, 1280
    s_cselect_b32 s77, 0, s77
    s_mov_b32 s52, 0x3f803f80
    v_dot2_f32_bf16 v172, v64, s52, 0
    v_dot2_f32_bf16 v174, v68, s52, 0
    v_dot2_f32_bf16 v176, v72, s52, 0
    v_mul_f32_dpp v173, v104, v80 row_newbcast:8 row_mask:0xf bank_mask:0xf
    v_mul_f32_dpp v175, v104, v88 row_newbcast:8 row_mask:0xf bank_mask:0xf
    v_mul_f32_dpp v177, v104, v96 row_newbcast:8 row_mask:0xf bank_mask:0xf
    v_fmac_f32_dpp v173, v104, v81 row_newbcast:9 row_mask:0xf bank_mask:0xf
    v_fmac_f32_dpp v175, v104, v89 row_newbcast:9 row_mask:0xf bank_mask:0xf
    v_fmac_f32_dpp v177, v104, v97 row_newbcast:9 row_mask:0xf bank_mask:0xf
    v_dot2_f32_bf16 v172, v65, s52, v172
    v_dot2_f32_bf16 v174, v69, s52, v174
    v_dot2_f32_bf16 v176, v73, s52, v176
    v_fmac_f32_dpp v173, v104, v82 row_newbcast:10 row_mask:0xf bank_mask:0xf
    v_fmac_f32_dpp v175, v104, v90 row_newbcast:10 row_mask:0xf bank_mask:0xf
    v_fmac_f32_dpp v177, v104, v98 row_newbcast:10 row_mask:0xf bank_mask:0xf
    v_fmac_f32_dpp v173, v104, v83 row_newbcast:11 row_mask:0xf bank_mask:0xf
    v_fmac_f32_dpp v175, v104, v91 row_newbcast:11 row_mask:0xf bank_mask:0xf
    v_fmac_f32_dpp v177, v104, v99 row_newbcast:11 row_mask:0xf bank_mask:0xf
    v_dot2_f32_bf16 v172, v66, s52, v172
    v_dot2_f32_bf16 v174, v70, s52, v174
    v_dot2_f32_bf16 v176, v74, s52, v176
    v_fmac_f32_dpp v173, v104, v84 row_newbcast:12 row_mask:0xf bank_mask:0xf
    v_fmac_f32_dpp v175, v104, v92 row_newbcast:12 row_mask:0xf bank_mask:0xf
    v_fmac_f32_dpp v177, v104, v100 row_newbcast:12 row_mask:0xf bank_mask:0xf
    v_fmac_f32_dpp v173, v104, v85 row_newbcast:13 row_mask:0xf bank_mask:0xf
    v_fmac_f32_dpp v175, v104, v93 row_newbcast:13 row_mask:0xf bank_mask:0xf
    v_fmac_f32_dpp v177, v104, v101 row_newbcast:13 row_mask:0xf bank_mask:0xf
    v_dot2_f32_bf16 v172, v67, s52, v172
    v_dot2_f32_bf16 v174, v71, s52, v174
    v_dot2_f32_bf16 v176, v75, s52, v176
    v_fmac_f32_dpp v173, v104, v86 row_newbcast:14 row_mask:0xf bank_mask:0xf
    v_fmac_f32_dpp v175, v104, v94 row_newbcast:14 row_mask:0xf bank_mask:0xf
    v_fmac_f32_dpp v177, v104, v102 row_newbcast:14 row_mask:0xf bank_mask:0xf
    v_fmac_f32_dpp v173, v104, v87 row_newbcast:15 row_mask:0xf bank_mask:0xf
    v_fmac_f32_dpp v175, v104, v95 row_newbcast:15 row_mask:0xf bank_mask:0xf
    v_fmac_f32_dpp v177, v104, v103 row_newbcast:15 row_mask:0xf bank_mask:0xf
    s_mov_b64 exec, s[12:13]
    ds_write_b64 v51, v[172:173] offset:0
    ds_write_b64 v51, v[174:175] offset:128
    s_mov_b64 exec, s[14:15]
    ds_write_b64 v51, v[176:177] offset:256
    s_mov_b64 exec, -1
    s_mov_b32 s52, 0x3f803f80
    v_dot2_f32_bf16 v170, v160, s52, 0
    v_dot2_f32_bf16 v171, v160, v160, 0
    v_dot2_f32_bf16 v170, v161, s52, v170
    v_dot2_f32_bf16 v171, v161, v161, v171
    v_dot2_f32_bf16 v170, v162, s52, v170
    v_dot2_f32_bf16 v171, v162, v162, v171
    v_dot2_f32_bf16 v170, v163, s52, v170
    v_dot2_f32_bf16 v171, v163, v163, v171
    v_dot2_f32_bf16 v170, v164, s52, v170
    v_dot2_f32_bf16 v171, v164, v164, v171
    v_dot2_f32_bf16 v170, v165, s52, v170
    v_dot2_f32_bf16 v171, v165, v165, v171
    v_dot2_f32_bf16 v170, v166, s52, v170
    v_dot2_f32_bf16 v171, v166, v166, v171
    v_dot2_f32_bf16 v170, v167, s52, v170
    v_dot2_f32_bf16 v171, v167, v167, v171
    v_dot2_f32_bf16 v170, v168, s52, v170
    v_dot2_f32_bf16 v171, v168, v168, v171
    v_dot2_f32_bf16 v170, v169, s52, v170
    v_dot2_f32_bf16 v171, v169, v169, v171
    s_nop 1
    v_add_f32_dpp v170, v170, v170 quad_perm:[1,0,3,2] row_mask:0xf bank_mask:0xf
    v_add_f32_dpp v171, v171, v171 quad_perm:[1,0,3,2] row_mask:0xf bank_mask:0xf
    s_nop 0
    v_add_f32_dpp v170, v170, v170 quad_perm:[2,3,0,1] row_mask:0xf bank_mask:0xf
    v_add_f32_dpp v171, v171, v171 quad_perm:[2,3,0,1] row_mask:0xf bank_mask:0xf
    s_nop 0
    v_add_f32_dpp v170, v170, v170 row_ror:4 row_mask:0xf bank_mask:0xf
    v_add_f32_dpp v171, v171, v171 row_ror:4 row_mask:0xf bank_mask:0xf
    s_nop 0
    v_add_f32_dpp v170, v170, v170 row_ror:8 row_mask:0xf bank_mask:0xf
    v_add_f32_dpp v171, v171, v171 row_ror:8 row_mask:0xf bank_mask:0xf
    v_mov_b32 v160, v170
    v_mov_b32 v161, v171
    s_nop 0
    v_permlane16_swap_b32 v170, v160
    v_permlane16_swap_b32 v171, v161
    v_add_f32 v170, v170, v160
    v_add_f32 v171, v171, v161
    v_mul_f32 v36, 0xbacccccd, v170
    v_mov_b32 v38, 0x3727c5ac
    v_fmac_f32 v38, 0x3acccccd, v171
    v_fma_f32 v38, -v36, v36, v38
    v_max_f32 v38, 0x3727c5ac, v38
    v_rsq_f32 v38, v38
    s_getreg_b32 s88, hwreg(HW_REG_XCC_ID, 0, 4)
    v_mul_f32 v36, v36, v38
    v_mov_b32 v37, s88
    s_mov_b32 exec_lo, 1
    s_mov_b32 exec_hi, 1
    buffer_store_dwordx4 v[36:39], v62, s[24:27], s65 offen sc0 sc1
    s_mov_b64 exec, -1
    s_waitcnt vmcnt(10)
    s_waitcnt lgkmcnt(0)
    s_barrier
    s_cmp_lg_u32 s3, 0
    s_cbranch_scc1 L_skip_3
    s_mov_b64 exec, 0xff
    buffer_store_dwordx4 v[36:39], v26, s[24:27], s50 offen sc0 sc1
    s_mov_b64 exec, -1
L_skip_3:
    s_nop 1
    s_cmp_lg_u32 s3, 1
    s_cbranch_scc1 L_skip_4
    v_lshlrev_b32 v3, 8, v15
    v_lshl_add_u32 v3, v14, 3, v3
    v_add_u32 v3, 147456, v3
    ds_read_b64 v[112:113], v3 offset:0
    ds_read_b64 v[114:115], v3 offset:128
    ds_read_b64 v[116:117], v3 offset:1024
    ds_read_b64 v[118:119], v3 offset:1152
    ds_read_b64 v[120:121], v3 offset:2048
    ds_read_b64 v[122:123], v3 offset:2176
    ds_read_b64 v[124:125], v3 offset:3072
    ds_read_b64 v[126:127], v3 offset:3200
    ds_read_b64 v[128:129], v3 offset:4096
    ds_read_b64 v[130:131], v3 offset:4224
    s_waitcnt lgkmcnt(7)
    v_pk_add_f32 v[112:113], v[112:113], v[116:117]
    s_waitcnt lgkmcnt(6)
    v_pk_add_f32 v[114:115], v[114:115], v[118:119]
    s_waitcnt lgkmcnt(3)
    v_pk_add_f32 v[120:121], v[120:121], v[124:125]
    s_waitcnt lgkmcnt(2)
    v_pk_add_f32 v[122:123], v[122:123], v[126:127]
    s_waitcnt lgkmcnt(1)
    v_pk_add_f32 v[112:113], v[112:113], v[128:129]
    s_waitcnt lgkmcnt(0)
    v_pk_add_f32 v[114:115], v[114:115], v[130:131]
    v_pk_add_f32 v[112:113], v[112:113], v[120:121]
    v_pk_add_f32 v[114:115], v[114:115], v[122:123]
    buffer_store_dwordx4 v[112:115], v26, s[24:27], s74 offen sc0 sc1
L_skip_4:
    s_nop 1
    s_add_u32 m0, s49, 40960
    s_add_u32 s7, s79, s77
    buffer_load_dwordx4 v236, s[8:11], s7 offen offset:0 lds
    buffer_load_dwordx4 v237, s[8:11], s7 offen offset:1024 lds
    buffer_load_dwordx4 v238, s[8:11], s7 offen offset:2048 lds
    buffer_load_dwordx4 v239, s[8:11], s7 offen offset:3072 lds
    s_add_u32 m0, m0, 4096
    s_add_u32 s7, s7, 20480
    buffer_load_dwordx4 v236, s[8:11], s7 offen offset:0 lds
    buffer_load_dwordx4 v237, s[8:11], s7 offen offset:1024 lds
    buffer_load_dwordx4 v238, s[8:11], s7 offen offset:2048 lds
    buffer_load_dwordx4 v239, s[8:11], s7 offen offset:3072 lds
    s_add_u32 m0, s78, 36864
    s_nop 0
    buffer_load_dwordx4 v240, s[8:11], s77 offen lds
    s_add_u32 s77, s77, 256
    s_cmp_eq_u32 s77, 1280
    s_cselect_b32 s77, 0, s77
    s_add_u32 m0, s49, 114688
    s_add_u32 s7, s79, s77
    buffer_load_dwordx4 v236, s[8:11], s7 offen offset:0 lds
    buffer_load_dwordx4 v237, s[8:11], s7 offen offset:1024 lds
    buffer_load_dwordx4 v238, s[8:11], s7 offen offset:2048 lds
    buffer_load_dwordx4 v239, s[8:11], s7 offen offset:3072 lds
    s_add_u32 m0, m0, 4096
    s_add_u32 s7, s7, 20480
    buffer_load_dwordx4 v236, s[8:11], s7 offen offset:0 lds
    buffer_load_dwordx4 v237, s[8:11], s7 offen offset:1024 lds
    buffer_load_dwordx4 v238, s[8:11], s7 offen offset:2048 lds
    buffer_load_dwordx4 v239, s[8:11], s7 offen offset:3072 lds
    s_add_u32 m0, s78, 110592
    s_nop 0
    buffer_load_dwordx4 v240, s[8:11], s77 offen lds
    s_add_u32 s77, s77, 256
    s_cmp_eq_u32 s77, 1280
    s_cselect_b32 s77, 0, s77
    s_min_u32 s52, s3, 2
    s_lshl_b32 s67, s52, 10
    s_lshl_b32 s52, s52, 6
    s_add_u32 s52, s52, s48
    s_sub_u32 s52, s52, 16
    v_add_u32 v2, s52, v1
    v_max_i32 v2, 0, v2
    v_lshlrev_b32 v12, 4, v2
    v_lshlrev_b32 v13, 7, v11
    s_mov_b32 s52, 153600
    v_lshl_add_u32 v28, v14, 4, s52
    s_lshl_b32 s66, s5, 14
    s_lshl_b32 s53, s3, 8
    s_add_u32 s66, s66, s53
    s_add_u32 s66, s66, 0x380000
    v_lshlrev_b32 v33, 12, v15
    v_lshl_add_u32 v33, v14, 4, v33
    s_mul_i32 s63, s3, 9216
    s_add_u32 s64, s60, s63
    s_lshl_b32 s52, s4, 3
    s_lshl_b32 s53, s3, 1
    s_add_u32 s52, s52, s53
    s_mul_i32 s52, s52, 20480
    s_add_u32 s91, s52, 0x100000
    s_lshl_b32 s53, s5, 10
    v_lshl_add_u32 v24, v1, 4, s53
    v_mul_u32_u24 v25, 20480, v10
    v_lshl_add_u32 v25, v14, 4, v25
    v_and_b32 v2, 1, v15
    v_lshl_add_u32 v25, v2, 3, v25
    s_lshl_b32 s53, s5, 8
    s_add_u32 s53, s53, 16384
    v_add_u32 v25, s53, v25
    s_lshr_b32 s54, s86, 1
    s_lshl_b32 s54, s54, 5
    s_and_b32 s55, s86, 1
    s_add_u32 s54, s54, s55
    v_lshl_add_u32 v35, v14, 1, s54
    v_mul_u32_u24 v30, 1280, v35
    v_lshl_add_u32 v30, v15, 3, v30
    s_mul_i32 s55, s87, 160
    v_add_u32 v30, s55, v30
    s_mul_i32 s71, s54, 1280
    s_add_u32 s71, s71, s55
    s_mul_i32 s53, s3, 640
    s_lshr_b32 s54, s55, 1
    s_add_u32 s53, s53, s54
    s_add_u32 s53, s53, 1280
    v_min_u32 v4, 39, v1
    v_lshl_add_u32 v5, v4, 1, s53
    v_lshrrev_b32 v3, 6, v5
    v_and_b32 v5, 63, v5
    v_lshlrev_b32 v5, 3, v5
    v_lshl_add_u32 v27, v3, 11, v5
    v_lshl_add_u32 v10, v4, 2, s55
    s_mul_i32 s58, s3, 3072
    s_add_u32 s58, s58, 149760
    s_lshl_b32 s59, s4, 2
    s_add_u32 s59, s59, s3
    s_lshl_b32 s59, s59, 4
    s_add_u32 s59, s59, s5
    s_lshl_b32 s59, s59, 7
    s_add_u32 s59, s59, 0x3e0000
    s_lshr_b32 s57, s86, 1
    s_lshl_b32 s57, s57, 11
    s_add_u32 s57, s57, 0x3e0000
    s_mov_b64 exec, 3
    global_load_dword a77, v52, s[0:1] sc1
    s_mov_b64 exec, -1
    s_add_u32 m0, s67, 153600
    s_nop 0
    buffer_load_dwordx4 v12, s[24:27], s65 offen sc1 lds
    s_mov_b64 exec, 0xffff
    buffer_load_dword v61, v52, s[24:27], s51 offen offset:12 sc1
    s_mov_b64 exec, -1
    s_cmp_lg_u32 s3, 1
    s_cbranch_scc1 L_skip_5
    s_waitcnt vmcnt(21)
    s_mov_b64 exec, 0xff
    buffer_store_dwordx4 v[36:39], v26, s[24:27], s68 offen sc0 sc1
    s_mov_b64 exec, -1
L_skip_5:
    s_nop 1
    ds_read_b128 a[40:43], v20 offset:0
    ds_read_b128 a[44:47], v20 offset:4096
    ds_read_b128 a[48:51], v20 offset:8192
    ds_read_b128 a[52:55], v20 offset:12288
    ds_read_b128 a[56:59], v20 offset:16384
    ds_read_b128 a[60:63], v20 offset:20480
    ds_read_b128 a[64:67], v20 offset:24576
    ds_read_b128 a[68:71], v20 offset:28672
    ds_read_b128 a[72:75], v20 offset:32768
    v_and_b32 v2, 7, v1
    s_lshl_b32 s52, s5, 10
    v_lshl_add_u32 v2, v2, 7, s52
    v_and_b32 v3, 1, v1
    s_lshl_b32 s52, s5, 8
    s_add_u32 s52, s52, 16384
    v_cmp_gt_u32 vcc, 16, v1
    v_lshl_add_u32 v3, v3, 7, s52
    v_bfe_u32 v4, v1, 3, 1
    v_cndmask_b32 v2, v3, v2, vcc
    v_mul_u32_u24 v4, 20480, v4
    v_add3_u32 v34, v2, v4, s91
    v_writelane_b32 v34, s59, 32
    s_lshl_b32 s52, s86, 3
    s_add_u32 s52, s52, s87
    s_lshl_b32 s52, s52, 8
    s_add_u32 s52, s52, 0x10000
    v_writelane_b32 v34, s52, 33
    s_add_u32 s52, s52, 128
    v_writelane_b32 v34, s52, 34
    s_lshl_b32 s52, s93, 2
    s_add_u32 s52, s52, s3
    s_lshl_b32 s52, s52, 8
    s_add_u32 s52, s52, 0x680000
    v_writelane_b32 v34, s52, 35
    s_add_u32 s52, s52, 128
    v_writelane_b32 v34, s52, 36
    s_lshl_b32 s52, s93, 7
    s_add_u32 s52, s52, 0xc8000
    v_writelane_b32 v34, s52, 37
    s_lshl_b32 s53, s95, 7
    s_add_u32 s52, s53, 0x50000
    v_writelane_b32 v34, s52, 38
    s_mul_i32 s52, s94, 20480
    s_add_u32 s52, s52, s53
    s_add_u32 s52, s52, 0x6c4000
    v_writelane_b32 v34, s52, 39
    s_lshl_b32 s53, s3, 12
    s_add_u32 s52, s52, s53
    s_sub_u32 s52, s52, 16384
    v_writelane_b32 v34, s52, 40
    s_waitcnt vmcnt(0)
    v_cmp_ne_u32 vcc, s6, v61
    s_nop 0
    s_and_b64 vcc, vcc, 0xffff
    s_cbranch_vccz L_done_7
    s_mov_b32 s90, 0
L_poll_6:
    s_nop 1
    s_add_u32 m0, s67, 153600
    s_nop 0
    buffer_load_dwordx4 v12, s[24:27], s65 offen sc1 lds
    s_mov_b64 exec, 0xffff
    buffer_load_dword v61, v52, s[24:27], s51 offen offset:12 sc1
    s_mov_b64 exec, -1
    s_waitcnt vmcnt(0)
    v_cmp_ne_u32 vcc, s6, v61
    s_nop 0
    s_and_b64 vcc, vcc, 0xffff
    s_cbranch_vccz L_done_7
    s_add_u32 s90, s90, 1
    s_cmp_lt_u32 s90, 40000
    s_cbranch_scc1 L_poll_6
L_done_7:
    s_nop 1
    buffer_load_dwordx4 a[96:99], v26, s[24:27], s72 offen sc1
    buffer_load_dwordx4 a[100:103], v29, s[24:27], s72 offen offset:1024 sc1
    s_barrier
    s_add_u32 s72, s72, 8192
    buffer_load_dwordx4 a[104:107], v26, s[24:27], s72 offen sc1
    buffer_load_dwordx4 a[108:111], v29, s[24:27], s72 offen offset:1024 sc1
    s_add_u32 s72, s72, 8192
    buffer_load_dwordx4 a[112:115], v26, s[24:27], s72 offen sc1
    buffer_load_dwordx4 a[116:119], v29, s[24:27], s72 offen offset:1024 sc1
    s_add_u32 s72, s72, 8192
    buffer_load_dwordx4 a[120:123], v26, s[24:27], s72 offen sc1
    buffer_load_dwordx4 a[124:127], v29, s[24:27], s72 offen offset:1024 sc1
    s_add_u32 s72, s72, 8192
    s_cmp_eq_u32 s72, s73
    s_cselect_b32 s72, s80, s72
    buffer_load_dwordx4 a[128:131], v26, s[24:27], s72 offen sc1
    buffer_load_dwordx4 a[132:135], v29, s[24:27], s72 offen offset:1024 sc1
    s_waitcnt vmcnt(9) lgkmcnt(8)
    v_mfma_f32_16x16x32_bf16 v[40:43], a[96:99], a[40:43], 0
    ds_read_b128 v[184:187], v28 offset:0
    s_add_u32 s72, s72, 8192
    s_waitcnt vmcnt(8)
    v_mfma_f32_16x16x32_bf16 v[44:47], a[100:103], a[40:43], 0
    ds_read_b128 a[40:43], v21 offset:0
    s_lshl_b32 s54, s3, 5
    s_waitcnt lgkmcnt(9)
    v_mfma_f32_16x16x32_bf16 v[48:51], a[96:99], a[44:47], 0
    buffer_load_dwordx4 a[136:139], v26, s[24:27], s72 offen sc1
    v_mfma_f32_16x16x32_bf16 v[52:55], a[100:103], a[44:47], 0
    ds_read_b128 a[44:47], v21 offset:4096
    s_add_u32 s54, s54, 16
    s_waitcnt lgkmcnt(9)
    v_mfma_f32_16x16x32_bf16 v[56:59], a[96:99], a[48:51], 0
    s_waitcnt lgkmcnt(6)
    v_lshlrev_b32 v2, 2, v15
    v_sub_u32 v2, v2, v14
    v_mfma_f32_16x16x32_bf16 v[60:63], a[100:103], a[48:51], 0
    ds_read_b128 a[48:51], v21 offset:8192
    v_mfma_f32_16x16x32_bf16 v[64:67], a[96:99], a[52:55], 0
    ds_read_b128 v[188:191], v28 offset:256
    v_mov_b32 v4, 0xff7fffff
    v_mfma_f32_16x16x32_bf16 v[68:71], a[100:103], a[52:55], 0
    ds_read_b128 a[52:55], v21 offset:12288
    v_mfma_f32_16x16x32_bf16 v[72:75], a[96:99], a[56:59], 0
    buffer_load_dwordx4 a[140:143], v29, s[24:27], s72 offen offset:1024 sc1
    v_mfma_f32_16x16x32_bf16 v[76:79], a[100:103], a[56:59], 0
    ds_read_b128 a[56:59], v21 offset:16384
    v_mfma_f32_16x16x32_bf16 v[80:83], a[96:99], a[60:63], 0
    s_waitcnt lgkmcnt(7)
    s_or_b32 s55, s4, s3
    s_cmp_eq_u32 s55, 0
    s_cselect_b32 s55, 100, 0
    v_mfma_f32_16x16x32_bf16 v[84:87], a[100:103], a[60:63], 0
    ds_read_b128 a[60:63], v21 offset:20480
    v_subrev_u32 v3, s55, v2
    v_mfma_f32_16x16x32_bf16 v[88:91], a[96:99], a[64:67], 0
    v_cmp_le_i32 vcc, 9, v3
    v_mfma_f32_16x16x32_bf16 v[92:95], a[100:103], a[64:67], 0
    ds_read_b128 a[64:67], v21 offset:24576
    v_mfma_f32_16x16x32_bf16 v[96:99], a[96:99], a[68:71], 0
    ds_read_b128 v[192:195], v28 offset:512
    v_add_u32 v5, 7, v2
    v_mfma_f32_16x16x32_bf16 v[100:103], a[100:103], a[68:71], 0
    ds_read_b128 a[68:71], v21 offset:28672
    v_cmp_gt_u32 s[98:99], 8, v5
    v_mfma_f32_16x16x32_bf16 v[104:107], a[96:99], a[72:75], 0
    s_waitcnt vmcnt(8) lgkmcnt(7)
    v_cndmask_b32 v6, v4, 0, vcc
    s_mov_b32 s55, 0x05040100
    v_mfma_f32_16x16x32_bf16 v[108:111], a[100:103], a[72:75], 0
    ds_read_b128 a[72:75], v21 offset:32768
    v_mfma_f32_16x16x32_bf16 v[40:43], a[104:107], a[40:43], v[40:43]
    ds_read_b128 v[196:199], v28 offset:768
    s_add_u32 s72, s72, 8192
    v_mfma_f32_16x16x32_bf16 v[44:47], a[108:111], a[40:43], v[44:47]
    ds_read_b128 a[40:43], v22 offset:0
    v_cndmask_b32 v248, v4, 0, s[98:99]
    v_mfma_f32_16x16x32_bf16 v[48:51], a[104:107], a[44:47], v[48:51]
    buffer_load_dwordx4 a[144:147], v26, s[24:27], s72 offen sc1
    v_mfma_f32_16x16x32_bf16 v[52:55], a[108:111], a[44:47], v[52:55]
    ds_read_b128 a[44:47], v22 offset:4096
    v_cmp_le_i32 vcc, 8, v3
    v_mfma_f32_16x16x32_bf16 v[56:59], a[104:107], a[48:51], v[56:59]
    buffer_load_dwordx4 a[148:151], v29, s[24:27], s72 offen offset:1024 sc1
    v_mfma_f32_16x16x32_bf16 v[60:63], a[108:111], a[48:51], v[60:63]
    ds_read_b128 a[48:51], v22 offset:8192
    s_waitcnt lgkmcnt(8)
    v_mfma_f32_16x16x32_bf16 v[64:67], a[104:107], a[52:55], v[64:67]
    v_add_u32 v5, 8, v2
    v_cmp_gt_u32 s[98:99], 8, v5
    v_mfma_f32_16x16x32_bf16 v[68:71], a[108:111], a[52:55], v[68:71]
    ds_read_b128 a[52:55], v22 offset:12288
    v_mfma_f32_16x16x32_bf16 v[72:75], a[104:107], a[56:59], v[72:75]
    buffer_load_dword v253, v13, s[24:27], s69 offen offset:12 sc1
    v_mfma_f32_16x16x32_bf16 v[76:79], a[108:111], a[56:59], v[76:79]
    ds_read_b128 a[56:59], v22 offset:16384
    v_mfma_f32_16x16x32_bf16 v[80:83], a[104:107], a[60:63], v[80:83]
    s_waitcnt lgkmcnt(6)
    v_mfma_f32_16x16x32_bf16 v[84:87], a[108:111], a[60:63], v[84:87]
    ds_read_b128 a[60:63], v22 offset:20480
    v_mfma_f32_16x16x32_bf16 v[88:91], a[104:107], a[64:67], v[88:91]
    buffer_load_dwordx4 v[168:171], v33, s[24:27], s66 offen offset:0 sc1
    v_mfma_f32_16x16x32_bf16 v[92:95], a[108:111], a[64:67], v[92:95]
    ds_read_b128 a[64:67], v22 offset:24576
    v_mfma_f32_16x16x32_bf16 v[96:99], a[104:107], a[68:71], v[96:99]
    ds_read_b128 v[200:203], v28 offset:1024
    v_cndmask_b32 v7, v4, 0, vcc
    v_mfma_f32_16x16x32_bf16 v[100:103], a[108:111], a[68:71], v[100:103]
    ds_read_b128 a[68:71], v22 offset:28672
    s_mov_b32 s55, 0x05040100
    v_mfma_f32_16x16x32_bf16 v[104:107], a[104:107], a[72:75], v[104:107]
    s_waitcnt vmcnt(10) lgkmcnt(6)
    v_cndmask_b32 v249, v4, 0, s[98:99]
    v_cmp_le_i32 vcc, 7, v3
    v_mfma_f32_16x16x32_bf16 v[108:111], a[108:111], a[72:75], v[108:111]
    ds_read_b128 a[72:75], v22 offset:32768
    v_mfma_f32_16x16x32_bf16 v[40:43], a[112:115], a[40:43], v[40:43]
    s_add_u32 s72, s72, 8192
    v_add_u32 v20, 0xfffee000, v20
    v_add_u32 v21, 0xfffee000, v21
    v_mfma_f32_16x16x32_bf16 v[44:47], a[116:119], a[40:43], v[44:47]
    ds_read_b128 a[40:43], v23 offset:0
    v_add_u32 v22, 0xfffee000, v22
    v_mfma_f32_16x16x32_bf16 v[48:51], a[112:115], a[44:47], v[48:51]
    buffer_load_dwordx4 a[152:155], v26, s[24:27], s72 offen sc1
    v_mfma_f32_16x16x32_bf16 v[52:55], a[116:119], a[44:47], v[52:55]
    ds_read_b128 a[44:47], v23 offset:4096
    v_mfma_f32_16x16x32_bf16 v[56:59], a[112:115], a[48:51], v[56:59]
    buffer_load_dwordx4 a[156:159], v29, s[24:27], s72 offen offset:1024 sc1
    v_mfma_f32_16x16x32_bf16 v[60:63], a[116:119], a[48:51], v[60:63]
    ds_read_b128 a[48:51], v23 offset:8192
    s_waitcnt lgkmcnt(7)
    v_mfma_f32_16x16x32_bf16 v[64:67], a[112:115], a[52:55], v[64:67]
    ds_read_b128 v[204:207], v28 offset:1280
    v_add_u32 v5, 9, v2
    v_mfma_f32_16x16x32_bf16 v[68:71], a[116:119], a[52:55], v[68:71]
    ds_read_b128 a[52:55], v23 offset:12288
    v_cmp_gt_u32 s[98:99], 8, v5
    v_mfma_f32_16x16x32_bf16 v[72:75], a[112:115], a[56:59], v[72:75]
    buffer_load_dwordx4 v[172:175], v33, s[24:27], s66 offen offset:1024 sc1
    v_mfma_f32_16x16x32_bf16 v[76:79], a[116:119], a[56:59], v[76:79]
    ds_read_b128 a[56:59], v23 offset:16384
    v_cndmask_b32 v8, v4, 0, vcc
    v_mfma_f32_16x16x32_bf16 v[80:83], a[112:115], a[60:63], v[80:83]
    s_waitcnt lgkmcnt(6)
    s_mov_b32 s55, 0x05040100
    v_mfma_f32_16x16x32_bf16 v[84:87], a[116:119], a[60:63], v[84:87]
    ds_read_b128 a[60:63], v23 offset:20480
    v_mfma_f32_16x16x32_bf16 v[88:91], a[112:115], a[64:67], v[88:91]
    buffer_load_dwordx4 v[176:179], v33, s[24:27], s66 offen offset:2048 sc1
    v_mfma_f32_16x16x32_bf16 v[92:95], a[116:119], a[64:67], v[92:95]
    ds_read_b128 a[64:67], v23 offset:24576
    v_mfma_f32_16x16x32_bf16 v[96:99], a[112:115], a[68:71], v[96:99]
    ds_read_b128 v[208:211], v28 offset:1536
    v_cndmask_b32 v250, v4, 0, s[98:99]
    v_mfma_f32_16x16x32_bf16 v[100:103], a[116:119], a[68:71], v[100:103]
    ds_read_b128 a[68:71], v23 offset:28672
    v_cmp_le_i32 vcc, 6, v3
    v_mfma_f32_16x16x32_bf16 v[104:107], a[112:115], a[72:75], v[104:107]
    s_waitcnt vmcnt(12) lgkmcnt(7)
    v_add_u32 v5, 10, v2
    v_cmp_gt_u32 s[98:99], 8, v5
    v_mfma_f32_16x16x32_bf16 v[108:111], a[116:119], a[72:75], v[108:111]
    ds_read_b128 a[72:75], v23 offset:32768
    v_mfma_f32_16x16x32_bf16 v[40:43], a[120:123], a[40:43], v[40:43]
    s_add_u32 s72, s72, 8192
    s_cmp_eq_u32 s72, s73
    s_cselect_b32 s72, s80, s72
    v_mfma_f32_16x16x32_bf16 v[44:47], a[124:127], a[40:43], v[44:47]
    ds_read_b128 a[40:43], v20 offset:0
    v_add_u32 v23, 0xfffee000, v23
    v_mfma_f32_16x16x32_bf16 v[48:51], a[120:123], a[44:47], v[48:51]
    buffer_load_dwordx4 a[160:163], v26, s[24:27], s72 offen sc1
    v_mfma_f32_16x16x32_bf16 v[52:55], a[124:127], a[44:47], v[52:55]
    ds_read_b128 a[44:47], v20 offset:4096
    v_mfma_f32_16x16x32_bf16 v[56:59], a[120:123], a[48:51], v[56:59]
    s_waitcnt lgkmcnt(6)
    v_mfma_f32_16x16x32_bf16 v[60:63], a[124:127], a[48:51], v[60:63]
    ds_read_b128 a[48:51], v20 offset:8192
    v_mfma_f32_16x16x32_bf16 v[64:67], a[120:123], a[52:55], v[64:67]
    buffer_load_dwordx4 a[164:167], v29, s[24:27], s72 offen offset:1024 sc1
    v_mfma_f32_16x16x32_bf16 v[68:71], a[124:127], a[52:55], v[68:71]
    ds_read_b128 a[52:55], v20 offset:12288
    v_mfma_f32_16x16x32_bf16 v[72:75], a[120:123], a[56:59], v[72:75]
    ds_read_b128 v[212:215], v28 offset:1792
    v_cndmask_b32 v9, v4, 0, vcc
    v_mfma_f32_16x16x32_bf16 v[76:79], a[124:127], a[56:59], v[76:79]
    ds_read_b128 a[56:59], v20 offset:16384
    s_mov_b32 s55, 0x05040100
    v_mfma_f32_16x16x32_bf16 v[80:83], a[120:123], a[60:63], v[80:83]
    s_waitcnt lgkmcnt(6)
    v_cndmask_b32 v251, v4, 0, s[98:99]
    v_perm_b32 v19, v7, v6, s55
    v_mfma_f32_16x16x32_bf16 v[84:87], a[124:127], a[60:63], v[84:87]
    ds_read_b128 a[60:63], v20 offset:20480
    v_mfma_f32_16x16x32_bf16 v[88:91], a[120:123], a[64:67], v[88:91]
    buffer_load_dwordx4 v[180:183], v33, s[24:27], s66 offen offset:3072 sc1
    v_mfma_f32_16x16x32_bf16 v[92:95], a[124:127], a[64:67], v[92:95]
    ds_read_b128 a[64:67], v20 offset:24576
    v_mfma_f32_16x16x32_bf16 v[96:99], a[120:123], a[68:71], v[96:99]
    ds_read_b128 v[216:219], v28 offset:2048
    v_perm_b32 v36, v9, v8, s55
    v_mfma_f32_16x16x32_bf16 v[100:103], a[124:127], a[68:71], v[100:103]
    ds_read_b128 a[68:71], v20 offset:28672
    v_perm_b32 v37, v249, v248, s55
    v_mfma_f32_16x16x32_bf16 v[104:107], a[120:123], a[72:75], v[104:107]
    s_waitcnt vmcnt(13) lgkmcnt(7)
    v_perm_b32 v254, v251, v250, s55
    s_mov_b32 s55, 110592
    v_mfma_f32_16x16x32_bf16 v[108:111], a[124:127], a[72:75], v[108:111]
    ds_read_b128 a[72:75], v20 offset:32768
    v_lshl_add_u32 v2, v14, 1, s54
    v_mfma_f32_16x16x32_bf16 v[40:43], a[128:131], a[40:43], v[40:43]
    s_add_u32 s72, s72, 8192
    v_subrev_u32 v3, 32, v2
    v_mul_u32_u24 v2, 272, v2
    v_mfma_f32_16x16x32_bf16 v[44:47], a[132:135], a[40:43], v[44:47]
    ds_read_b128 a[40:43], v21 offset:0
    v_max_i32 v3, 0, v3
    v_mfma_f32_16x16x32_bf16 v[48:51], a[128:131], a[44:47], v[48:51]
    buffer_load_dwordx4 a[168:171], v26, s[24:27], s72 offen sc1
    v_mfma_f32_16x16x32_bf16 v[52:55], a[132:135], a[44:47], v[52:55]
    ds_read_b128 a[44:47], v21 offset:4096
    v_mul_u32_u24 v3, 272, v3
    v_mfma_f32_16x16x32_bf16 v[56:59], a[128:131], a[48:51], v[56:59]
    buffer_load_dwordx4 a[172:175], v29, s[24:27], s72 offen offset:1024 sc1
    v_mfma_f32_16x16x32_bf16 v[60:63], a[132:135], a[48:51], v[60:63]
    ds_read_b128 a[48:51], v21 offset:8192
    s_waitcnt lgkmcnt(7)
    v_mfma_f32_16x16x32_bf16 v[64:67], a[128:131], a[52:55], v[64:67]
    s_add_u32 s72, s72, 8192
    v_lshl_add_u32 v4, v15, 4, s55
    v_add_u32 v241, v4, v2
    v_mfma_f32_16x16x32_bf16 v[68:71], a[132:135], a[52:55], v[68:71]
    ds_read_b128 a[52:55], v21 offset:12288
    v_add_u32 v242, v4, v3
    v_mfma_f32_16x16x32_bf16 v[72:75], a[128:131], a[56:59], v[72:75]
    buffer_load_dwordx4 a[176:179], v26, s[24:27], s72 offen sc1
    v_mfma_f32_16x16x32_bf16 v[76:79], a[132:135], a[56:59], v[76:79]
    ds_read_b128 a[56:59], v21 offset:16384
    v_lshrrev_b32 v5, 2, v1
    v_mfma_f32_16x16x32_bf16 v[80:83], a[128:131], a[60:63], v[80:83]
    s_waitcnt lgkmcnt(5)
    v_lshl_add_u32 v2, v5, 1, s54
    v_subrev_u32 v3, 32, v2
    v_mfma_f32_16x16x32_bf16 v[84:87], a[132:135], a[60:63], v[84:87]
    ds_read_b128 a[60:63], v21 offset:20480
    v_mul_u32_u24 v2, 272, v2
    v_mfma_f32_16x16x32_bf16 v[88:91], a[128:131], a[64:67], v[88:91]
    buffer_load_dwordx4 a[180:183], v29, s[24:27], s72 offen offset:1024 sc1
    v_mfma_f32_16x16x32_bf16 v[92:95], a[132:135], a[64:67], v[92:95]
    ds_read_b128 a[64:67], v21 offset:24576
    v_max_i32 v3, 0, v3
    v_mfma_f32_16x16x32_bf16 v[96:99], a[128:131], a[68:71], v[96:99]
    v_mul_u32_u24 v3, 272, v3
    v_and_b32 v4, 3, v1
    v_mfma_f32_16x16x32_bf16 v[100:103], a[132:135], a[68:71], v[100:103]
    ds_read_b128 a[68:71], v21 offset:28672
    v_lshl_add_u32 v4, v4, 3, s55
    v_mfma_f32_16x16x32_bf16 v[104:107], a[128:131], a[72:75], v[104:107]
    s_waitcnt vmcnt(15) lgkmcnt(5)
    v_add_u32 v243, v4, v2
    v_add_u32 v244, v4, v3
    v_mfma_f32_16x16x32_bf16 v[108:111], a[132:135], a[72:75], v[108:111]
    ds_read_b128 a[72:75], v21 offset:32768
    v_and_b32 v4, 1, v1
    v_mfma_f32_16x16x32_bf16 v[40:43], a[136:139], a[40:43], v[40:43]
    s_add_u32 s72, s72, 8192
    v_mul_u32_u24 v4, 40, v4
    v_add3_u32 v245, v4, v2, s55
    v_mfma_f32_16x16x32_bf16 v[44:47], a[140:143], a[40:43], v[44:47]
    ds_read_b128 a[40:43], v22 offset:0
    v_add3_u32 v246, v4, v3, s55
    v_mfma_f32_16x16x32_bf16 v[48:51], a[136:139], a[44:47], v[48:51]
    buffer_load_dwordx4 a[184:187], v26, s[24:27], s72 offen sc1
    v_mfma_f32_16x16x32_bf16 v[52:55], a[140:143], a[44:47], v[52:55]
    ds_read_b128 a[44:47], v22 offset:4096
    s_mov_b32 s50, -1
    v_mfma_f32_16x16x32_bf16 v[56:59], a[136:139], a[48:51], v[56:59]
    s_waitcnt lgkmcnt(5)
    s_mov_b32 s51, 0xffff
    s_mov_b32 s12, -1
    v_mfma_f32_16x16x32_bf16 v[60:63], a[140:143], a[48:51], v[60:63]
    ds_read_b128 a[48:51], v22 offset:8192
    s_mov_b32 s13, 0
    v_mfma_f32_16x16x32_bf16 v[64:67], a[136:139], a[52:55], v[64:67]
    s_mov_b32 s74, 0xffff0000
    s_mov_b32 s75, 0xffff
    v_lshlrev_b32 v247, 7, v14
    v_mfma_f32_16x16x32_bf16 v[68:71], a[140:143], a[52:55], v[68:71]
    ds_read_b128 a[52:55], v22 offset:12288
    v_mul_u32_u24 v38, 272, v14
    v_mfma_f32_16x16x32_bf16 v[72:75], a[136:139], a[56:59], v[72:75]
    buffer_load_dwordx4 a[188:191], v29, s[24:27], s72 offen offset:1024 sc1
    v_mfma_f32_16x16x32_bf16 v[76:79], a[140:143], a[56:59], v[76:79]
    ds_read_b128 a[56:59], v22 offset:16384
    s_lshl_b32 s55, s3, 6
    v_mfma_f32_16x16x32_bf16 v[80:83], a[136:139], a[60:63], v[80:83]
    s_waitcnt lgkmcnt(5)
    s_add_u32 s55, s55, 110592
    v_lshl_add_u32 v38, v15, 3, v38
    v_mfma_f32_16x16x32_bf16 v[84:87], a[140:143], a[60:63], v[84:87]
    ds_read_b128 a[60:63], v22 offset:20480
    v_add_u32 v38, s55, v38
    v_mfma_f32_16x16x32_bf16 v[88:91], a[136:139], a[64:67], v[88:91]
    v_add_u32 v2, 0, v1
    v_mul_u32_u24 v3, 205, v2
    v_mfma_f32_16x16x32_bf16 v[92:95], a[140:143], a[64:67], v[92:95]
    ds_read_b128 a[64:67], v22 offset:24576
    v_lshrrev_b32 v3, 11, v3
    v_mfma_f32_16x16x32_bf16 v[96:99], a[136:139], a[68:71], v[96:99]
    v_mul_u32_u24 v3, 2400, v3
    v_lshl_add_u32 v16, v2, 4, v3
    v_mfma_f32_16x16x32_bf16 v[100:103], a[140:143], a[68:71], v[100:103]
    ds_read_b128 a[68:71], v22 offset:28672
    v_add_u32 v2, 64, v1
    v_mfma_f32_16x16x32_bf16 v[104:107], a[136:139], a[72:75], v[104:107]
    s_waitcnt vmcnt(15) lgkmcnt(5)
    v_mul_u32_u24 v3, 205, v2
    v_lshrrev_b32 v3, 11, v3
    v_mfma_f32_16x16x32_bf16 v[108:111], a[140:143], a[72:75], v[108:111]
    ds_read_b128 a[72:75], v22 offset:32768
    v_mul_u32_u24 v3, 2400, v3
    v_mfma_f32_16x16x32_bf16 v[40:43], a[144:147], a[40:43], v[40:43]
    s_add_u32 s72, s72, 8192
    s_cmp_eq_u32 s72, s73
    s_cselect_b32 s72, s80, s72
    v_mfma_f32_16x16x32_bf16 v[44:47], a[148:151], a[40:43], v[44:47]
    ds_read_b128 a[40:43], v23 offset:0
    v_add_u32 v20, 0x9000, v20
    v_mfma_f32_16x16x32_bf16 v[48:51], a[144:147], a[44:47], v[48:51]
    buffer_load_dwordx4 a[192:195], v26, s[24:27], s72 offen sc1
    v_mfma_f32_16x16x32_bf16 v[52:55], a[148:151], a[44:47], v[52:55]
    ds_read_b128 a[44:47], v23 offset:4096
    v_add_u32 v21, 0x9000, v21
    v_mfma_f32_16x16x32_bf16 v[56:59], a[144:147], a[48:51], v[56:59]
    buffer_load_dwordx4 a[196:199], v29, s[24:27], s72 offen offset:1024 sc1
    v_mfma_f32_16x16x32_bf16 v[60:63], a[148:151], a[48:51], v[60:63]
    ds_read_b128 a[48:51], v23 offset:8192
    s_waitcnt lgkmcnt(6)
    v_mfma_f32_16x16x32_bf16 v[64:67], a[144:147], a[52:55], v[64:67]
    s_add_u32 s72, s72, 8192
    v_add_u32 v22, 0x9000, v22
    v_lshl_add_u32 v17, v2, 4, v3
    v_mfma_f32_16x16x32_bf16 v[68:71], a[148:151], a[52:55], v[68:71]
    ds_read_b128 a[52:55], v23 offset:12288
    v_add_u32 v2, 128, v1
    v_mfma_f32_16x16x32_bf16 v[72:75], a[144:147], a[56:59], v[72:75]
    buffer_load_dwordx4 a[200:203], v26, s[24:27], s72 offen sc1
    v_mfma_f32_16x16x32_bf16 v[76:79], a[148:151], a[56:59], v[76:79]
    ds_read_b128 a[56:59], v23 offset:16384
    v_min_u32 v2, 159, v2
    v_mfma_f32_16x16x32_bf16 v[80:83], a[144:147], a[60:63], v[80:83]
    s_waitcnt lgkmcnt(5)
    v_mul_u32_u24 v3, 205, v2
    v_lshrrev_b32 v3, 11, v3
    v_mfma_f32_16x16x32_bf16 v[84:87], a[148:151], a[60:63], v[84:87]
    ds_read_b128 a[60:63], v23 offset:20480
    v_mul_u32_u24 v3, 2400, v3
    v_mfma_f32_16x16x32_bf16 v[88:91], a[144:147], a[64:67], v[88:91]
    buffer_load_dwordx4 a[204:207], v29, s[24:27], s72 offen offset:1024 sc1
    v_mfma_f32_16x16x32_bf16 v[92:95], a[148:151], a[64:67], v[92:95]
    ds_read_b128 a[64:67], v23 offset:24576
    v_lshl_add_u32 v18, v2, 4, v3
    v_mfma_f32_16x16x32_bf16 v[96:99], a[144:147], a[68:71], v[96:99]
    v_xor_b32 v2, s6, v187
    v_bitop3_b32 v2, v2, v191, s6 bitop3:0xf6
    v_mfma_f32_16x16x32_bf16 v[100:103], a[148:151], a[68:71], v[100:103]
    ds_read_b128 a[68:71], v23 offset:28672
    v_bitop3_b32 v2, v2, v195, s6 bitop3:0xf6
    v_mfma_f32_16x16x32_bf16 v[104:107], a[144:147], a[72:75], v[104:107]
    s_waitcnt vmcnt(15) lgkmcnt(5)
    v_bitop3_b32 v2, v2, v199, s6 bitop3:0xf6
    v_bitop3_b32 v2, v2, v203, s6 bitop3:0xf6
    v_mfma_f32_16x16x32_bf16 v[108:111], a[148:151], a[72:75], v[108:111]
    ds_read_b128 a[72:75], v23 offset:32768
    v_bitop3_b32 v2, v2, v207, s6 bitop3:0xf6
    v_mfma_f32_16x16x32_bf16 v[40:43], a[152:155], a[40:43], v[40:43]
    s_add_u32 s72, s72, 8192
    v_add_u32 v23, 0x9000, v23
    v_bitop3_b32 v2, v2, v211, s6 bitop3:0xf6
    v_mfma_f32_16x16x32_bf16 v[44:47], a[156:159], a[40:43], v[44:47]
    ds_read_b128 a[40:43], v20 offset:0
    v_bitop3_b32 v2, v2, v215, s6 bitop3:0xf6
    v_mfma_f32_16x16x32_bf16 v[48:51], a[152:155], a[44:47], v[48:51]
    buffer_load_dwordx4 a[208:211], v26, s[24:27], s72 offen sc1
    v_mfma_f32_16x16x32_bf16 v[52:55], a[156:159], a[44:47], v[52:55]
    ds_read_b128 a[44:47], v20 offset:4096
    v_bitop3_b32 v2, v2, v219, s6 bitop3:0xf6
    v_mfma_f32_16x16x32_bf16 v[56:59], a[152:155], a[48:51], v[56:59]
    s_waitcnt lgkmcnt(5)
    v_bitop3_b32 v2, v2, v253, s6 bitop3:0xf6
    v_cmp_ne_u32 vcc, 0, v2
    v_mfma_f32_16x16x32_bf16 v[60:63], a[156:159], a[48:51], v[60:63]
    ds_read_b128 a[48:51], v20 offset:8192
    s_lshl_b32 s52, s3, 8
    v_mfma_f32_16x16x32_bf16 v[64:67], a[152:155], a[52:55], v[64:67]
    buffer_load_dwordx4 a[212:215], v29, s[24:27], s72 offen offset:1024 sc1
    v_mfma_f32_16x16x32_bf16 v[68:71], a[156:159], a[52:55], v[68:71]
    ds_read_b128 a[52:55], v20 offset:12288
    s_add_u32 s52, s52, 150016
    v_mfma_f32_16x16x32_bf16 v[72:75], a[152:155], a[56:59], v[72:75]
    v_lshl_add_u32 v12, v14, 4, s52
    v_lshl_add_u32 v5, v15, 6, s52
    v_mfma_f32_16x16x32_bf16 v[76:79], a[156:159], a[56:59], v[76:79]
    ds_read_b128 a[56:59], v20 offset:16384
    s_cbranch_vccz L_sm_8
    v_add_u32 v2, s48, v14
    v_lshlrev_b32 v3, 4, v2
    v_subrev_u32 v2, 16, v2
    v_max_i32 v2, 0, v2
    v_lshlrev_b32 v4, 4, v2
    s_mov_b32 s90, 0
L_poll_9:
    s_nop 1
    buffer_load_dword v253, v13, s[24:27], s69 offen offset:12 sc1
    buffer_load_dwordx4 v[168:171], v33, s[24:27], s66 offen offset:0 sc1
    s_waitcnt vmcnt(18)
    buffer_load_dwordx4 v[172:175], v33, s[24:27], s66 offen offset:1024 sc1
    s_waitcnt vmcnt(18)
    buffer_load_dwordx4 v[176:179], v33, s[24:27], s66 offen offset:2048 sc1
    s_waitcnt vmcnt(16)
    buffer_load_dwordx4 v[180:183], v33, s[24:27], s66 offen offset:3072 sc1
    buffer_load_dwordx4 v[184:187], v4, s[24:27], s65 offen sc1
    buffer_load_dwordx4 v[188:191], v3, s[24:27], s65 offen offset:0 sc1
    buffer_load_dwordx4 v[192:195], v3, s[24:27], s65 offen offset:256 sc1
    buffer_load_dwordx4 v[196:199], v3, s[24:27], s65 offen offset:512 sc1
    buffer_load_dwordx4 v[200:203], v3, s[24:27], s65 offen offset:768 sc1
    buffer_load_dwordx4 v[204:207], v3, s[24:27], s65 offen offset:1024 sc1
    buffer_load_dwordx4 v[208:211], v3, s[24:27], s65 offen offset:1280 sc1
    buffer_load_dwordx4 v[212:215], v3, s[24:27], s65 offen offset:1536 sc1
    buffer_load_dwordx4 v[216:219], v3, s[24:27], s65 offen offset:1792 sc1
    s_waitcnt vmcnt(0)
    v_xor_b32 v2, s6, v187
    v_bitop3_b32 v2, v2, v191, s6 bitop3:0xf6
    v_bitop3_b32 v2, v2, v195, s6 bitop3:0xf6
    v_bitop3_b32 v2, v2, v199, s6 bitop3:0xf6
    v_bitop3_b32 v2, v2, v203, s6 bitop3:0xf6
    v_bitop3_b32 v2, v2, v207, s6 bitop3:0xf6
    v_bitop3_b32 v2, v2, v211, s6 bitop3:0xf6
    v_bitop3_b32 v2, v2, v215, s6 bitop3:0xf6
    v_bitop3_b32 v2, v2, v219, s6 bitop3:0xf6
    v_bitop3_b32 v2, v2, v253, s6 bitop3:0xf6
    v_cmp_ne_u32 vcc, 0, v2
    s_nop 4
    s_cbranch_vccz L_done_10
    s_add_u32 s90, s90, 1
    s_cmp_lt_u32 s90, 40000
    s_cbranch_scc1 L_poll_9
L_done_10:
    s_nop 1
L_sm_8:
    v_mfma_f32_16x16x32_bf16 v[80:83], a[152:155], a[60:63], v[80:83]
    s_waitcnt lgkmcnt(5)
    s_waitcnt vmcnt(16)
    v_add_f32 v168, v168, v172
    v_add_f32 v169, v169, v173
    v_mfma_f32_16x16x32_bf16 v[84:87], a[156:159], a[60:63], v[84:87]
    ds_read_b128 a[60:63], v20 offset:20480
    v_add_f32 v170, v170, v174
    v_mfma_f32_16x16x32_bf16 v[88:91], a[152:155], a[64:67], v[88:91]
    s_mov_b64 exec, 3
    global_load_dword a77, v247, s[0:1] sc1
    s_mov_b64 exec, -1
    v_mfma_f32_16x16x32_bf16 v[92:95], a[156:159], a[64:67], v[92:95]
    ds_read_b128 a[64:67], v20 offset:24576
    v_add_f32 v171, v171, v175
    v_mfma_f32_16x16x32_bf16 v[96:99], a[152:155], a[68:71], v[96:99]
    s_waitcnt vmcnt(13)
    v_add_f32 v176, v176, v180
    v_add_f32 v177, v177, v181
    v_mfma_f32_16x16x32_bf16 v[100:103], a[156:159], a[68:71], v[100:103]
    ds_read_b128 a[68:71], v20 offset:28672
    v_add_f32 v178, v178, v182
    v_mfma_f32_16x16x32_bf16 v[104:107], a[152:155], a[72:75], v[104:107]
    s_waitcnt lgkmcnt(5)
    v_add_f32 v179, v179, v183
    v_add_f32 v168, v168, v176
    v_mfma_f32_16x16x32_bf16 v[108:111], a[156:159], a[72:75], v[108:111]
    ds_read_b128 a[72:75], v20 offset:32768
    v_add_f32 v169, v169, v177
    s_barrier
    v_mfma_f32_16x16x32_bf16 v[40:43], a[160:163], a[40:43], v[40:43]
    s_add_u32 s72, s72, 8192
    v_add_f32 v170, v170, v178
    v_add_f32 v171, v171, v179
    v_mfma_f32_16x16x32_bf16 v[44:47], a[164:167], a[40:43], v[44:47]
    ds_read_b128 a[40:43], v21 offset:0
    v_lshl_add_u32 v12, v15, 2, v12
    v_mfma_f32_16x16x32_bf16 v[48:51], a[160:163], a[44:47], v[48:51]
    buffer_load_dwordx4 a[216:219], v26, s[24:27], s72 offen sc1
    v_mfma_f32_16x16x32_bf16 v[52:55], a[164:167], a[44:47], v[52:55]
    ds_read_b128 a[44:47], v21 offset:4096
    v_xor_b32 v3, s88, v189
    v_mfma_f32_16x16x32_bf16 v[56:59], a[160:163], a[48:51], v[56:59]
    buffer_load_dwordx4 a[220:223], v29, s[24:27], s72 offen offset:1024 sc1
    v_mfma_f32_16x16x32_bf16 v[60:63], a[164:167], a[48:51], v[60:63]
    ds_read_b128 a[48:51], v21 offset:8192
    s_waitcnt lgkmcnt(6)
    v_mfma_f32_16x16x32_bf16 v[64:67], a[160:163], a[52:55], v[64:67]
    s_add_u32 m0, s49, 77824
    s_add_u32 s7, s79, s77
    v_mfma_f32_16x16x32_bf16 v[68:71], a[164:167], a[52:55], v[68:71]
    ds_read_b128 a[52:55], v21 offset:12288
    v_mfma_f32_16x16x32_bf16 v[72:75], a[160:163], a[56:59], v[72:75]
    buffer_load_dwordx4 v236, s[8:11], s7 offen offset:0 lds
    v_mfma_f32_16x16x32_bf16 v[76:79], a[164:167], a[56:59], v[76:79]
    ds_read_b128 a[56:59], v21 offset:16384
    v_mfma_f32_16x16x32_bf16 v[80:83], a[160:163], a[60:63], v[80:83]
    s_waitcnt lgkmcnt(5)
    v_permlane32_swap_b32 v168, v170
    v_mfma_f32_16x16x32_bf16 v[84:87], a[164:167], a[60:63], v[84:87]
    ds_read_b128 a[60:63], v21 offset:20480
    v_bitop3_b32 v3, v3, v193, s88 bitop3:0xf6
    v_mfma_f32_16x16x32_bf16 v[88:91], a[160:163], a[64:67], v[88:91]
    buffer_load_dwordx4 v237, s[8:11], s7 offen offset:1024 lds
    v_mfma_f32_16x16x32_bf16 v[92:95], a[164:167], a[64:67], v[92:95]
    ds_read_b128 a[64:67], v21 offset:24576
    v_mfma_f32_16x16x32_bf16 v[96:99], a[160:163], a[68:71], v[96:99]
    v_permlane32_swap_b32 v169, v171
    v_mfma_f32_16x16x32_bf16 v[100:103], a[164:167], a[68:71], v[100:103]
    ds_read_b128 a[68:71], v21 offset:28672
    v_add_f32 v168, v168, v170
    v_mfma_f32_16x16x32_bf16 v[104:107], a[160:163], a[72:75], v[104:107]
    s_waitcnt vmcnt(15) lgkmcnt(5)
    v_add_f32 v169, v169, v171
    v_bitop3_b32 v3, v3, v197, s88 bitop3:0xf6
    v_mfma_f32_16x16x32_bf16 v[108:111], a[164:167], a[72:75], v[108:111]
    ds_read_b128 a[72:75], v21 offset:32768
    v_bitop3_b32 v3, v3, v201, s88 bitop3:0xf6
    v_mfma_f32_16x16x32_bf16 v[40:43], a[168:171], a[40:43], v[40:43]
    s_add_u32 s72, s72, 8192
    s_cmp_eq_u32 s72, s73
    s_cselect_b32 s72, s80, s72
    v_mfma_f32_16x16x32_bf16 v[44:47], a[172:175], a[40:43], v[44:47]
    ds_read_b128 a[40:43], v22 offset:0
    v_mfma_f32_16x16x32_bf16 v[48:51], a[168:171], a[44:47], v[48:51]
    buffer_load_dwordx4 a[224:227], v26, s[24:27], s72 offen sc1
    v_mfma_f32_16x16x32_bf16 v[52:55], a[172:175], a[44:47], v[52:55]
    ds_read_b128 a[44:47], v22 offset:4096
    v_mfma_f32_16x16x32_bf16 v[56:59], a[168:171], a[48:51], v[56:59]
    buffer_load_dwordx4 a[228:231], v29, s[24:27], s72 offen offset:1024 sc1
    v_mfma_f32_16x16x32_bf16 v[60:63], a[172:175], a[48:51], v[60:63]
    ds_read_b128 a[48:51], v22 offset:8192
    s_waitcnt lgkmcnt(6)
    v_mfma_f32_16x16x32_bf16 v[64:67], a[168:171], a[52:55], v[64:67]
    v_permlane16_swap_b32 v168, v169
    v_mfma_f32_16x16x32_bf16 v[68:71], a[172:175], a[52:55], v[68:71]
    ds_read_b128 a[52:55], v22 offset:12288
    v_add_f32 v168, v168, v169
    v_mfma_f32_16x16x32_bf16 v[72:75], a[168:171], a[56:59], v[72:75]
    buffer_load_dwordx4 v238, s[8:11], s7 offen offset:2048 lds
    v_mfma_f32_16x16x32_bf16 v[76:79], a[172:175], a[56:59], v[76:79]
    ds_read_b128 a[56:59], v22 offset:16384
    v_mfma_f32_16x16x32_bf16 v[80:83], a[168:171], a[60:63], v[80:83]
    s_waitcnt lgkmcnt(5)
    v_mfma_f32_16x16x32_bf16 v[84:87], a[172:175], a[60:63], v[84:87]
    ds_read_b128 a[60:63], v22 offset:20480
    v_mfma_f32_16x16x32_bf16 v[88:91], a[168:171], a[64:67], v[88:91]
    buffer_load_dwordx4 v239, s[8:11], s7 offen offset:3072 lds
    v_mfma_f32_16x16x32_bf16 v[92:95], a[172:175], a[64:67], v[92:95]
    ds_read_b128 a[64:67], v22 offset:24576
    v_mfma_f32_16x16x32_bf16 v[96:99], a[168:171], a[68:71], v[96:99]
    ds_write_b32 v12, v168
    v_mfma_f32_16x16x32_bf16 v[100:103], a[172:175], a[68:71], v[100:103]
    ds_read_b128 a[68:71], v22 offset:28672
    v_bitop3_b32 v3, v3, v205, s88 bitop3:0xf6
    v_mfma_f32_16x16x32_bf16 v[104:107], a[168:171], a[72:75], v[104:107]
    s_waitcnt vmcnt(17) lgkmcnt(6)
    v_mfma_f32_16x16x32_bf16 v[108:111], a[172:175], a[72:75], v[108:111]
    ds_read_b128 a[72:75], v22 offset:32768
    v_mfma_f32_16x16x32_bf16 v[40:43], a[176:179], a[40:43], v[40:43]
    s_add_u32 s72, s72, 8192
    v_add_u32 v20, 0x12000, v20
    v_add_u32 v21, 0x12000, v21
    v_mfma_f32_16x16x32_bf16 v[44:47], a[180:183], a[40:43], v[44:47]
    ds_read_b128 a[40:43], v23 offset:0
    v_add_u32 v22, 0x12000, v22
    v_mfma_f32_16x16x32_bf16 v[48:51], a[176:179], a[44:47], v[48:51]
    buffer_load_dwordx4 a[232:235], v26, s[24:27], s72 offen sc1
    v_mfma_f32_16x16x32_bf16 v[52:55], a[180:183], a[44:47], v[52:55]
    ds_read_b128 a[44:47], v23 offset:4096
    v_mfma_f32_16x16x32_bf16 v[56:59], a[176:179], a[48:51], v[56:59]
    buffer_load_dwordx4 a[236:239], v29, s[24:27], s72 offen offset:1024 sc1
    v_mfma_f32_16x16x32_bf16 v[60:63], a[180:183], a[48:51], v[60:63]
    ds_read_b128 a[48:51], v23 offset:8192
    s_waitcnt lgkmcnt(7)
    v_mfma_f32_16x16x32_bf16 v[64:67], a[176:179], a[52:55], v[64:67]
    ds_read_b128 v[220:223], v5 offset:0
    s_add_u32 m0, m0, 4096
    v_mfma_f32_16x16x32_bf16 v[68:71], a[180:183], a[52:55], v[68:71]
    ds_read_b128 a[52:55], v23 offset:12288
    s_add_u32 s7, s7, 20480
    v_mfma_f32_16x16x32_bf16 v[72:75], a[176:179], a[56:59], v[72:75]
    buffer_load_dwordx4 v236, s[8:11], s7 offen offset:0 lds
    v_mfma_f32_16x16x32_bf16 v[76:79], a[180:183], a[56:59], v[76:79]
    ds_read_b128 a[56:59], v23 offset:16384
    v_bitop3_b32 v3, v3, v209, s88 bitop3:0xf6
    v_mfma_f32_16x16x32_bf16 v[80:83], a[176:179], a[60:63], v[80:83]
    s_waitcnt lgkmcnt(6)
    v_mfma_f32_16x16x32_bf16 v[84:87], a[180:183], a[60:63], v[84:87]
    ds_read_b128 a[60:63], v23 offset:20480
    v_mfma_f32_16x16x32_bf16 v[88:91], a[176:179], a[64:67], v[88:91]
    buffer_load_dwordx4 v237, s[8:11], s7 offen offset:1024 lds
    v_mfma_f32_16x16x32_bf16 v[92:95], a[180:183], a[64:67], v[92:95]
    ds_read_b128 a[64:67], v23 offset:24576
    v_mfma_f32_16x16x32_bf16 v[96:99], a[176:179], a[68:71], v[96:99]
    ds_read_b128 v[224:227], v5 offset:16
    v_bitop3_b32 v3, v3, v213, s88 bitop3:0xf6
    v_mfma_f32_16x16x32_bf16 v[100:103], a[180:183], a[68:71], v[100:103]
    ds_read_b128 a[68:71], v23 offset:28672
    v_mfma_f32_16x16x32_bf16 v[104:107], a[176:179], a[72:75], v[104:107]
    s_waitcnt vmcnt(19) lgkmcnt(7)
    v_mfma_f32_16x16x32_bf16 v[108:111], a[180:183], a[72:75], v[108:111]
    ds_read_b128 a[72:75], v23 offset:32768
    v_mfma_f32_16x16x32_bf16 v[40:43], a[184:187], a[40:43], v[40:43]
    s_add_u32 s72, s72, 8192
    v_add_u32 v23, 0x12000, v23
    v_mfma_f32_16x16x32_bf16 v[44:47], a[188:191], a[40:43], v[44:47]
    ds_read_b128 a[40:43], v20 offset:0
    v_mfma_f32_16x16x32_bf16 v[48:51], a[184:187], a[44:47], v[48:51]
    buffer_load_dwordx4 a[240:243], v26, s[24:27], s72 offen sc1
    v_mfma_f32_16x16x32_bf16 v[52:55], a[188:191], a[44:47], v[52:55]
    ds_read_b128 a[44:47], v20 offset:4096
    v_mfma_f32_16x16x32_bf16 v[56:59], a[184:187], a[48:51], v[56:59]
    buffer_load_dwordx4 a[244:247], v29, s[24:27], s72 offen offset:1024 sc1
    v_mfma_f32_16x16x32_bf16 v[60:63], a[188:191], a[48:51], v[60:63]
    ds_read_b128 a[48:51], v20 offset:8192
    s_waitcnt lgkmcnt(7)
    v_mfma_f32_16x16x32_bf16 v[64:67], a[184:187], a[52:55], v[64:67]
    ds_read_b128 v[228:231], v5 offset:32
    v_bitop3_b32 v3, v3, v217, s88 bitop3:0xf6
    v_mfma_f32_16x16x32_bf16 v[68:71], a[188:191], a[52:55], v[68:71]
    ds_read_b128 a[52:55], v20 offset:12288
    v_mfma_f32_16x16x32_bf16 v[72:75], a[184:187], a[56:59], v[72:75]
    buffer_load_dwordx4 v238, s[8:11], s7 offen offset:2048 lds
    v_mfma_f32_16x16x32_bf16 v[76:79], a[188:191], a[56:59], v[76:79]
    ds_read_b128 a[56:59], v20 offset:16384
    v_mfma_f32_16x16x32_bf16 v[80:83], a[184:187], a[60:63], v[80:83]
    s_waitcnt lgkmcnt(6)
    v_mfma_f32_16x16x32_bf16 v[84:87], a[188:191], a[60:63], v[84:87]
    ds_read_b128 a[60:63], v20 offset:20480
    v_mfma_f32_16x16x32_bf16 v[88:91], a[184:187], a[64:67], v[88:91]
    buffer_load_dwordx4 v239, s[8:11], s7 offen offset:3072 lds
    v_mfma_f32_16x16x32_bf16 v[92:95], a[188:191], a[64:67], v[92:95]
    ds_read_b128 a[64:67], v20 offset:24576
    v_mfma_f32_16x16x32_bf16 v[96:99], a[184:187], a[68:71], v[96:99]
    ds_read_b128 v[232:235], v5 offset:48
    v_cmp_ne_u32 vcc, 0, v3
    v_mfma_f32_16x16x32_bf16 v[100:103], a[188:191], a[68:71], v[100:103]
    ds_read_b128 a[68:71], v20 offset:28672
    v_mfma_f32_16x16x32_bf16 v[104:107], a[184:187], a[72:75], v[104:107]
    s_waitcnt vmcnt(21) lgkmcnt(7)
    s_cmp_eq_u64 vcc, 0
    s_cselect_b32 s88, 1, 0
    v_mfma_f32_16x16x32_bf16 v[108:111], a[188:191], a[72:75], v[108:111]
    ds_read_b128 a[72:75], v20 offset:32768
    v_mul_u32_u24 v13, 0x30000, v15
    v_mfma_f32_16x16x32_bf16 v[40:43], a[192:195], a[40:43], v[40:43]
    s_add_u32 s72, s72, 8192
    v_lshl_add_u32 v13, v14, 4, v13
    v_accvgpr_write_b32 a80, -1
    v_mfma_f32_16x16x32_bf16 v[44:47], a[196:199], a[40:43], v[44:47]
    ds_read_b128 a[40:43], v21 offset:0
    v_accvgpr_write_b32 a81, -1
    v_mfma_f32_16x16x32_bf16 v[48:51], a[192:195], a[44:47], v[48:51]
    buffer_load_dwordx4 a[248:251], v26, s[24:27], s72 offen sc1
    v_mfma_f32_16x16x32_bf16 v[52:55], a[196:199], a[44:47], v[52:55]
    ds_read_b128 a[44:47], v21 offset:4096
    v_accvgpr_write_b32 a82, -1
    v_mfma_f32_16x16x32_bf16 v[56:59], a[192:195], a[48:51], v[56:59]
    buffer_load_dwordx4 a[252:255], v29, s[24:27], s72 offen offset:1024 sc1
    v_mfma_f32_16x16x32_bf16 v[60:63], a[196:199], a[48:51], v[60:63]
    ds_read_b128 a[48:51], v21 offset:8192
    s_waitcnt lgkmcnt(7)
    v_mfma_f32_16x16x32_bf16 v[64:67], a[192:195], a[52:55], v[64:67]
    s_add_u32 m0, s78, 73728
    v_accvgpr_write_b32 a83, -1
    v_fma_f32 v112, v184, v220, v221
    v_mfma_f32_16x16x32_bf16 v[68:71], a[196:199], a[52:55], v[68:71]
    ds_read_b128 a[52:55], v21 offset:12288
    v_fma_f32 v113, v184, v224, v225
    v_mfma_f32_16x16x32_bf16 v[72:75], a[192:195], a[56:59], v[72:75]
    buffer_load_dwordx4 v240, s[8:11], s77 offen lds
    v_mfma_f32_16x16x32_bf16 v[76:79], a[196:199], a[56:59], v[76:79]
    ds_read_b128 a[56:59], v21 offset:16384
    v_fma_f32 v114, v184, v228, v229
    v_mfma_f32_16x16x32_bf16 v[80:83], a[192:195], a[60:63], v[80:83]
    s_waitcnt lgkmcnt(5)
    s_add_u32 m0, s63, 0
    s_add_u32 s7, s64, 0
    v_mfma_f32_16x16x32_bf16 v[84:87], a[196:199], a[60:63], v[84:87]
    ds_read_b128 a[60:63], v21 offset:20480
    v_fma_f32 v115, v184, v232, v233
    v_mfma_f32_16x16x32_bf16 v[88:91], a[192:195], a[64:67], v[88:91]
    buffer_load_dwordx4 v26, s[24:27], s7 offen offset:0 sc1 lds
    v_mfma_f32_16x16x32_bf16 v[92:95], a[196:199], a[64:67], v[92:95]
    ds_read_b128 a[64:67], v21 offset:24576
    v_fma_f32 v116, v184, v222, v223
    v_mfma_f32_16x16x32_bf16 v[96:99], a[192:195], a[68:71], v[96:99]
    v_fma_f32 v117, v184, v226, v227
    v_fma_f32 v118, v184, v230, v231
    v_mfma_f32_16x16x32_bf16 v[100:103], a[196:199], a[68:71], v[100:103]
    ds_read_b128 a[68:71], v21 offset:28672
    v_fma_f32 v119, v184, v234, v235
    v_mfma_f32_16x16x32_bf16 v[104:107], a[192:195], a[72:75], v[104:107]
    s_waitcnt vmcnt(23) lgkmcnt(5)
    v_fma_f32 v120, v188, v220, v221
    v_fma_f32 v121, v188, v224, v225
    v_mfma_f32_16x16x32_bf16 v[108:111], a[196:199], a[72:75], v[108:111]
    ds_read_b128 a[72:75], v21 offset:32768
    v_fma_f32 v122, v188, v228, v229
    v_mfma_f32_16x16x32_bf16 v[40:43], a[200:203], a[40:43], v[40:43]
    buffer_load_dwordx4 v26, s[24:27], s7 offen offset:1024 sc1 lds
    v_mfma_f32_16x16x32_bf16 v[44:47], a[204:207], a[40:43], v[44:47]
    ds_read_b128 a[40:43], v22 offset:0
    v_fma_f32 v123, v188, v232, v233
    v_mfma_f32_16x16x32_bf16 v[48:51], a[200:203], a[44:47], v[48:51]
    v_fma_f32 v124, v188, v222, v223
    v_fma_f32 v125, v188, v226, v227
    v_mfma_f32_16x16x32_bf16 v[52:55], a[204:207], a[44:47], v[52:55]
    ds_read_b128 a[44:47], v22 offset:4096
    v_fma_f32 v126, v188, v230, v231
    v_mfma_f32_16x16x32_bf16 v[56:59], a[200:203], a[48:51], v[56:59]
    s_waitcnt lgkmcnt(5)
    v_fma_f32 v127, v188, v234, v235
    v_fma_f32 v128, v192, v220, v221
    v_mfma_f32_16x16x32_bf16 v[60:63], a[204:207], a[48:51], v[60:63]
    ds_read_b128 a[48:51], v22 offset:8192
    v_fma_f32 v129, v192, v224, v225
    v_mfma_f32_16x16x32_bf16 v[64:67], a[200:203], a[52:55], v[64:67]
    buffer_load_dwordx4 v26, s[24:27], s7 offen offset:2048 sc1 lds
    v_mfma_f32_16x16x32_bf16 v[68:71], a[204:207], a[52:55], v[68:71]
    ds_read_b128 a[52:55], v22 offset:12288
    v_fma_f32 v130, v192, v228, v229
    v_mfma_f32_16x16x32_bf16 v[72:75], a[200:203], a[56:59], v[72:75]
    v_fma_f32 v131, v192, v232, v233
    v_fma_f32 v132, v192, v222, v223
    v_mfma_f32_16x16x32_bf16 v[76:79], a[204:207], a[56:59], v[76:79]
    ds_read_b128 a[56:59], v22 offset:16384
    v_fma_f32 v133, v192, v226, v227
    v_mfma_f32_16x16x32_bf16 v[80:83], a[200:203], a[60:63], v[80:83]
    s_waitcnt lgkmcnt(5)
    v_fma_f32 v134, v192, v230, v231
    v_fma_f32 v135, v192, v234, v235
    v_mfma_f32_16x16x32_bf16 v[84:87], a[204:207], a[60:63], v[84:87]
    ds_read_b128 a[60:63], v22 offset:20480
    v_fma_f32 v136, v196, v220, v221
    v_mfma_f32_16x16x32_bf16 v[88:91], a[200:203], a[64:67], v[88:91]
    buffer_load_dwordx4 v26, s[24:27], s7 offen offset:3072 sc1 lds
    v_mfma_f32_16x16x32_bf16 v[92:95], a[204:207], a[64:67], v[92:95]
    ds_read_b128 a[64:67], v22 offset:24576
    v_fma_f32 v137, v196, v224, v225
    v_mfma_f32_16x16x32_bf16 v[96:99], a[200:203], a[68:71], v[96:99]
    v_fma_f32 v138, v196, v228, v229
    v_fma_f32 v139, v196, v232, v233
    v_mfma_f32_16x16x32_bf16 v[100:103], a[204:207], a[68:71], v[100:103]
    ds_read_b128 a[68:71], v22 offset:28672
    v_fma_f32 v140, v196, v222, v223
    v_mfma_f32_16x16x32_bf16 v[104:107], a[200:203], a[72:75], v[104:107]
    s_waitcnt vmcnt(24) lgkmcnt(5)
    v_fma_f32 v141, v196, v226, v227
    v_fma_f32 v142, v196, v230, v231
    v_mfma_f32_16x16x32_bf16 v[108:111], a[204:207], a[72:75], v[108:111]
    ds_read_b128 a[72:75], v22 offset:32768
    v_fma_f32 v143, v196, v234, v235
    v_mfma_f32_16x16x32_bf16 v[40:43], a[208:211], a[40:43], v[40:43]
    s_add_u32 m0, s63, 4096
    s_add_u32 s7, s64, 4096
    v_add_u32 v20, 0xffff7000, v20
    v_mfma_f32_16x16x32_bf16 v[44:47], a[212:215], a[40:43], v[44:47]
    ds_read_b128 a[40:43], v23 offset:0
    v_add_u32 v21, 0xffff7000, v21
    v_mfma_f32_16x16x32_bf16 v[48:51], a[208:211], a[44:47], v[48:51]
    buffer_load_dwordx4 v26, s[24:27], s7 offen offset:0 sc1 lds
    v_mfma_f32_16x16x32_bf16 v[52:55], a[212:215], a[44:47], v[52:55]
    ds_read_b128 a[44:47], v23 offset:4096
    v_add_u32 v22, 0xffff7000, v22
    v_mfma_f32_16x16x32_bf16 v[56:59], a[208:211], a[48:51], v[56:59]
    s_waitcnt lgkmcnt(5)
    v_fma_f32 v144, v200, v220, v221
    v_fma_f32 v145, v200, v224, v225
    v_mfma_f32_16x16x32_bf16 v[60:63], a[212:215], a[48:51], v[60:63]
    ds_read_b128 a[48:51], v23 offset:8192
    v_fma_f32 v146, v200, v228, v229
    v_mfma_f32_16x16x32_bf16 v[64:67], a[208:211], a[52:55], v[64:67]
    buffer_load_dwordx4 v26, s[24:27], s7 offen offset:1024 sc1 lds
    v_mfma_f32_16x16x32_bf16 v[68:71], a[212:215], a[52:55], v[68:71]
    ds_read_b128 a[52:55], v23 offset:12288
    v_fma_f32 v147, v200, v232, v233
    v_mfma_f32_16x16x32_bf16 v[72:75], a[208:211], a[56:59], v[72:75]
    v_fma_f32 v148, v200, v222, v223
    v_fma_f32 v149, v200, v226, v227
    v_mfma_f32_16x16x32_bf16 v[76:79], a[212:215], a[56:59], v[76:79]
    ds_read_b128 a[56:59], v23 offset:16384
    v_fma_f32 v150, v200, v230, v231
    v_mfma_f32_16x16x32_bf16 v[80:83], a[208:211], a[60:63], v[80:83]
    s_waitcnt lgkmcnt(5)
    v_fma_f32 v151, v200, v234, v235
    v_fma_f32 v152, v204, v220, v221
    v_mfma_f32_16x16x32_bf16 v[84:87], a[212:215], a[60:63], v[84:87]
    ds_read_b128 a[60:63], v23 offset:20480
    v_fma_f32 v153, v204, v224, v225
    v_mfma_f32_16x16x32_bf16 v[88:91], a[208:211], a[64:67], v[88:91]
    buffer_load_dwordx4 v26, s[24:27], s7 offen offset:2048 sc1 lds
    v_mfma_f32_16x16x32_bf16 v[92:95], a[212:215], a[64:67], v[92:95]
    ds_read_b128 a[64:67], v23 offset:24576
    v_fma_f32 v154, v204, v228, v229
    v_mfma_f32_16x16x32_bf16 v[96:99], a[208:211], a[68:71], v[96:99]
    v_fma_f32 v155, v204, v232, v233
    v_fma_f32 v156, v204, v222, v223
    v_mfma_f32_16x16x32_bf16 v[100:103], a[212:215], a[68:71], v[100:103]
    ds_read_b128 a[68:71], v23 offset:28672
    v_fma_f32 v157, v204, v226, v227
    v_mfma_f32_16x16x32_bf16 v[104:107], a[208:211], a[72:75], v[104:107]
    s_waitcnt vmcnt(24) lgkmcnt(5)
    v_fma_f32 v158, v204, v230, v231
    v_fma_f32 v159, v204, v234, v235
    v_mfma_f32_16x16x32_bf16 v[108:111], a[212:215], a[72:75], v[108:111]
    ds_read_b128 a[72:75], v23 offset:32768
    v_fma_f32 v160, v208, v220, v221
    v_mfma_f32_16x16x32_bf16 v[40:43], a[216:219], a[40:43], v[40:43]
    buffer_load_dwordx4 v26, s[24:27], s7 offen offset:3072 sc1 lds
    v_mfma_f32_16x16x32_bf16 v[44:47], a[220:223], a[40:43], v[44:47]
    v_add_u32 v23, 0xffff7000, v23
    v_fma_f32 v161, v208, v224, v225
    v_mfma_f32_16x16x32_bf16 v[48:51], a[216:219], a[44:47], v[48:51]
    s_add_u32 m0, s63, 8192
    v_fma_f32 v162, v208, v228, v229
    v_fma_f32 v163, v208, v232, v233
    v_mfma_f32_16x16x32_bf16 v[52:55], a[220:223], a[44:47], v[52:55]
    s_add_u32 s7, s64, 8192
    v_fma_f32 v164, v208, v222, v223
    v_fma_f32 v165, v208, v226, v227
    v_mfma_f32_16x16x32_bf16 v[56:59], a[216:219], a[48:51], v[56:59]
    s_waitcnt lgkmcnt(3)
    v_fma_f32 v166, v208, v230, v231
    v_fma_f32 v167, v208, v234, v235
    v_mfma_f32_16x16x32_bf16 v[60:63], a[220:223], a[48:51], v[60:63]
    v_fma_f32 v168, v212, v220, v221
    v_fma_f32 v169, v212, v224, v225
    v_mfma_f32_16x16x32_bf16 v[64:67], a[216:219], a[52:55], v[64:67]
    buffer_load_dwordx4 v26, s[24:27], s7 offen offset:0 sc1 lds
    v_mfma_f32_16x16x32_bf16 v[68:71], a[220:223], a[52:55], v[68:71]
    s_waitcnt vmcnt(9)
    s_waitcnt lgkmcnt(0)
    s_barrier
    ds_read_b128 a[40:43], v20 offset:0
    ds_read_b128 a[44:47], v21 offset:0
    ds_read_b128 a[48:51], v22 offset:0
    ds_read_b128 a[52:55], v23 offset:0
    v_mfma_f32_16x16x32_bf16 v[72:75], a[216:219], a[56:59], v[72:75]
    v_fma_f32 v170, v212, v228, v229
    v_fma_f32 v171, v212, v232, v233
    v_mfma_f32_16x16x32_bf16 v[76:79], a[220:223], a[56:59], v[76:79]
    ds_read_b128 a[56:59], v20 offset:4096
    v_fma_f32 v172, v212, v222, v223
    v_mfma_f32_16x16x32_bf16 v[80:83], a[216:219], a[60:63], v[80:83]
    v_fma_f32 v173, v212, v226, v227
    v_fma_f32 v174, v212, v230, v231
    v_mfma_f32_16x16x32_bf16 v[84:87], a[220:223], a[60:63], v[84:87]
    ds_read_b128 a[60:63], v21 offset:4096
    v_fma_f32 v175, v212, v234, v235
    v_mfma_f32_16x16x32_bf16 v[88:91], a[216:219], a[64:67], v[88:91]
    buffer_load_dword a36, v10, s[36:39], 0 offen
    v_mfma_f32_16x16x32_bf16 v[92:95], a[220:223], a[64:67], v[92:95]
    ds_read_b128 a[64:67], v22 offset:4096
    v_fma_f32 v176, v216, v220, v221
    v_mfma_f32_16x16x32_bf16 v[96:99], a[216:219], a[68:71], v[96:99]
    v_fma_f32 v177, v216, v224, v225
    v_fma_f32 v178, v216, v228, v229
    v_mfma_f32_16x16x32_bf16 v[100:103], a[220:223], a[68:71], v[100:103]
    ds_read_b128 a[68:71], v23 offset:4096
    v_fma_f32 v179, v216, v232, v233
    v_mfma_f32_16x16x32_bf16 v[104:107], a[216:219], a[72:75], v[104:107]
    s_waitcnt lgkmcnt(5)
    v_fma_f32 v180, v216, v222, v223
    v_fma_f32 v181, v216, v226, v227
    v_mfma_f32_16x16x32_bf16 v[108:111], a[220:223], a[72:75], v[108:111]
    ds_read_b128 a[72:75], v20 offset:8192
    v_fma_f32 v182, v216, v230, v231
    v_mfma_f32_16x16x32_bf16 v[40:43], a[224:227], a[40:43], v[40:43]
    s_mov_b64 exec, 0x03ff03ff
    buffer_store_dwordx4 a[80:83], v13, s[24:27], s92 offen sc0 sc1
    s_mov_b64 exec, -1
    v_mfma_f32_16x16x32_bf16 v[44:47], a[228:231], a[40:43], v[44:47]
    ds_read_b128 a[40:43], v21 offset:8192
    v_fma_f32 v183, v216, v234, v235
    v_mfma_f32_16x16x32_bf16 v[40:43], a[232:235], a[44:47], v[40:43]
    v_mfma_f32_16x16x32_bf16 v[44:47], a[236:239], a[44:47], v[44:47]
    ds_read_b128 a[44:47], v22 offset:8192
    v_mfma_f32_16x16x32_bf16 v[40:43], a[240:243], a[48:51], v[40:43]
    s_waitcnt lgkmcnt(5)
    v_mfma_f32_16x16x32_bf16 v[44:47], a[244:247], a[48:51], v[44:47]
    ds_read_b128 a[48:51], v23 offset:8192
    v_mfma_f32_16x16x32_bf16 v[40:43], a[248:251], a[52:55], v[40:43]
    v_mfma_f32_16x16x32_bf16 v[44:47], a[252:255], a[52:55], v[44:47]
    ds_read_b128 a[52:55], v20 offset:12288
    v_mfma_f32_16x16x32_bf16 v[48:51], a[224:227], a[56:59], v[48:51]
    v_mfma_f32_16x16x32_bf16 v[52:55], a[228:231], a[56:59], v[52:55]
    ds_read_b128 a[56:59], v21 offset:12288
    v_mfma_f32_16x16x32_bf16 v[48:51], a[232:235], a[60:63], v[48:51]
    s_waitcnt lgkmcnt(5)
    s_nop 0
    v_fma_f32 v40, v40, v186, v112
    v_fma_f32 v41, v41, v186, v113
    v_fma_f32 v42, v42, v186, v114
    v_mfma_f32_16x16x32_bf16 v[52:55], a[236:239], a[60:63], v[52:55]
    ds_read_b128 a[60:63], v22 offset:12288
    v_fma_f32 v43, v43, v186, v115
    v_mfma_f32_16x16x32_bf16 v[48:51], a[240:243], a[64:67], v[48:51]
    v_fma_f32 v44, v44, v186, v116
    v_fma_f32 v45, v45, v186, v117
    v_mfma_f32_16x16x32_bf16 v[52:55], a[244:247], a[64:67], v[52:55]
    ds_read_b128 a[64:67], v23 offset:12288
    v_fma_f32 v46, v46, v186, v118
    v_mfma_f32_16x16x32_bf16 v[48:51], a[248:251], a[68:71], v[48:51]
    v_fma_f32 v47, v47, v186, v119
    v_cvt_pk_bf16_f32 v40, v40, v41
    v_mfma_f32_16x16x32_bf16 v[52:55], a[252:255], a[68:71], v[52:55]
    ds_read_b128 a[68:71], v20 offset:16384
    v_cvt_pk_bf16_f32 v41, v42, v43
    v_mfma_f32_16x16x32_bf16 v[56:59], a[224:227], a[72:75], v[56:59]
    s_waitcnt lgkmcnt(5)
    v_cvt_pk_bf16_f32 v42, v44, v45
    v_cvt_pk_bf16_f32 v43, v46, v47
    v_mfma_f32_16x16x32_bf16 v[60:63], a[228:231], a[72:75], v[60:63]
    ds_read_b128 a[72:75], v21 offset:16384
    v_mfma_f32_16x16x32_bf16 v[56:59], a[232:235], a[40:43], v[56:59]
    s_mov_b64 exec, 3
    global_load_dword a77, v247, s[0:1] sc1
    s_mov_b64 exec, -1
    v_fma_f32 v48, v48, v190, v120
    v_mfma_f32_16x16x32_bf16 v[60:63], a[236:239], a[40:43], v[60:63]
    ds_read_b128 a[40:43], v22 offset:16384
    v_fma_f32 v49, v49, v190, v121
    v_fma_f32 v50, v50, v190, v122
    v_mfma_f32_16x16x32_bf16 v[56:59], a[240:243], a[44:47], v[56:59]
    ds_write_b64 v38, v[40:41] offset:0
    v_fma_f32 v51, v51, v190, v123
    v_mfma_f32_16x16x32_bf16 v[60:63], a[244:247], a[44:47], v[60:63]
    ds_read_b128 a[44:47], v23 offset:16384
    v_fma_f32 v52, v52, v190, v124
    v_mfma_f32_16x16x32_bf16 v[56:59], a[248:251], a[48:51], v[56:59]
    ds_write_b64 v38, v[42:43] offset:32
    v_mfma_f32_16x16x32_bf16 v[60:63], a[252:255], a[48:51], v[60:63]
    ds_read_b128 a[48:51], v20 offset:20480
    s_waitcnt lgkmcnt(8)
    v_mfma_f32_16x16x32_bf16 v[64:67], a[224:227], a[52:55], v[64:67]
    v_fma_f32 v53, v53, v190, v125
    v_fma_f32 v54, v54, v190, v126
    v_mfma_f32_16x16x32_bf16 v[68:71], a[228:231], a[52:55], v[68:71]
    ds_read_b128 a[52:55], v21 offset:20480
    v_fma_f32 v55, v55, v190, v127
    v_mfma_f32_16x16x32_bf16 v[64:67], a[232:235], a[56:59], v[64:67]
    v_cvt_pk_bf16_f32 v48, v48, v49
    v_cvt_pk_bf16_f32 v49, v50, v51
    v_cvt_pk_bf16_f32 v50, v52, v53
    v_mfma_f32_16x16x32_bf16 v[68:71], a[236:239], a[56:59], v[68:71]
    ds_read_b128 a[56:59], v22 offset:20480
    v_cvt_pk_bf16_f32 v51, v54, v55
    v_mfma_f32_16x16x32_bf16 v[64:67], a[240:243], a[60:63], v[64:67]
    ds_write_b64 v38, v[48:49] offset:4352
    v_fma_f32 v56, v56, v194, v128
    v_mfma_f32_16x16x32_bf16 v[68:71], a[244:247], a[60:63], v[68:71]
    ds_read_b128 a[60:63], v23 offset:20480
    s_waitcnt lgkmcnt(9)
    v_fma_f32 v57, v57, v194, v129
    v_mfma_f32_16x16x32_bf16 v[64:67], a[248:251], a[64:67], v[64:67]
    ds_write_b64 v38, v[50:51] offset:4384
    v_fma_f32 v58, v58, v194, v130
    v_mfma_f32_16x16x32_bf16 v[68:71], a[252:255], a[64:67], v[68:71]
    ds_read_b128 a[64:67], v20 offset:24576
    v_fma_f32 v59, v59, v194, v131
    v_mfma_f32_16x16x32_bf16 v[72:75], a[224:227], a[68:71], v[72:75]
    v_fma_f32 v60, v60, v194, v132
    v_fma_f32 v61, v61, v194, v133
    v_mfma_f32_16x16x32_bf16 v[76:79], a[228:231], a[68:71], v[76:79]
    ds_read_b128 a[68:71], v21 offset:24576
    v_fma_f32 v62, v62, v194, v134
    v_mfma_f32_16x16x32_bf16 v[72:75], a[232:235], a[72:75], v[72:75]
    s_waitcnt lgkmcnt(7)
    v_fma_f32 v63, v63, v194, v135
    v_cvt_pk_bf16_f32 v56, v56, v57
    v_cvt_pk_bf16_f32 v57, v58, v59
    v_mfma_f32_16x16x32_bf16 v[76:79], a[236:239], a[72:75], v[76:79]
    ds_read_b128 a[72:75], v22 offset:24576
    v_cvt_pk_bf16_f32 v58, v60, v61
    v_cvt_pk_bf16_f32 v59, v62, v63
    v_mfma_f32_16x16x32_bf16 v[72:75], a[240:243], a[40:43], v[72:75]
    s_mov_b32 exec_hi, 0x1ff
    buffer_load_dword a76, v34, s[24:27], 0 offen
    s_mov_b64 exec, -1
    v_fma_f32 v64, v64, v198, v136
    v_mfma_f32_16x16x32_bf16 v[76:79], a[244:247], a[40:43], v[76:79]
    ds_read_b128 a[40:43], v23 offset:24576
    v_fma_f32 v65, v65, v198, v137
    v_fma_f32 v66, v66, v198, v138
    v_mfma_f32_16x16x32_bf16 v[72:75], a[248:251], a[44:47], v[72:75]
    ds_write_b64 v38, v[56:57] offset:8704
    v_fma_f32 v67, v67, v198, v139
    v_mfma_f32_16x16x32_bf16 v[76:79], a[252:255], a[44:47], v[76:79]
    ds_read_b128 a[44:47], v20 offset:28672
    v_fma_f32 v68, v68, v198, v140
    v_mfma_f32_16x16x32_bf16 v[80:83], a[224:227], a[48:51], v[80:83]
    ds_write_b64 v38, v[58:59] offset:8736
    v_mfma_f32_16x16x32_bf16 v[84:87], a[228:231], a[48:51], v[84:87]
    ds_read_b128 a[48:51], v21 offset:28672
    s_waitcnt lgkmcnt(9)
    v_mfma_f32_16x16x32_bf16 v[80:83], a[232:235], a[52:55], v[80:83]
    v_fma_f32 v69, v69, v198, v141
    v_fma_f32 v70, v70, v198, v142
    v_fma_f32 v71, v71, v198, v143
    v_mfma_f32_16x16x32_bf16 v[84:87], a[236:239], a[52:55], v[84:87]
    ds_read_b128 a[52:55], v22 offset:28672
    v_cvt_pk_bf16_f32 v64, v64, v65
    v_cvt_pk_bf16_f32 v65, v66, v67
    v_mfma_f32_16x16x32_bf16 v[80:83], a[240:243], a[56:59], v[80:83]
    v_cvt_pk_bf16_f32 v66, v68, v69
    v_cvt_pk_bf16_f32 v67, v70, v71
    v_mfma_f32_16x16x32_bf16 v[84:87], a[244:247], a[56:59], v[84:87]
    ds_read_b128 a[56:59], v23 offset:28672
    v_fma_f32 v72, v72, v202, v144
    v_fma_f32 v73, v73, v202, v145
    v_mfma_f32_16x16x32_bf16 v[80:83], a[248:251], a[60:63], v[80:83]
    ds_write_b64 v38, v[64:65] offset:13056
    v_fma_f32 v74, v74, v202, v146
    v_mfma_f32_16x16x32_bf16 v[84:87], a[252:255], a[60:63], v[84:87]
    ds_read_b128 a[60:63], v20 offset:32768
    s_waitcnt lgkmcnt(9)
    v_fma_f32 v75, v75, v202, v147
    v_mfma_f32_16x16x32_bf16 v[88:91], a[224:227], a[64:67], v[88:91]
    ds_write_b64 v38, v[66:67] offset:13088
    v_mfma_f32_16x16x32_bf16 v[92:95], a[228:231], a[64:67], v[92:95]
    ds_read_b128 a[64:67], v21 offset:32768
    v_fma_f32 v76, v76, v202, v148
    v_mfma_f32_16x16x32_bf16 v[88:91], a[232:235], a[68:71], v[88:91]
    v_fma_f32 v77, v77, v202, v149
    v_fma_f32 v78, v78, v202, v150
    v_fma_f32 v79, v79, v202, v151
    v_mfma_f32_16x16x32_bf16 v[92:95], a[236:239], a[68:71], v[92:95]
    ds_read_b128 a[68:71], v22 offset:32768
    v_cvt_pk_bf16_f32 v72, v72, v73
    v_cvt_pk_bf16_f32 v73, v74, v75
    v_mfma_f32_16x16x32_bf16 v[88:91], a[240:243], a[72:75], v[88:91]
    s_waitcnt lgkmcnt(7)
    v_cvt_pk_bf16_f32 v74, v76, v77
    v_cvt_pk_bf16_f32 v75, v78, v79
    v_mfma_f32_16x16x32_bf16 v[92:95], a[244:247], a[72:75], v[92:95]
    ds_read_b128 a[72:75], v23 offset:32768
    v_fma_f32 v80, v80, v206, v152
    v_fma_f32 v81, v81, v206, v153
    v_mfma_f32_16x16x32_bf16 v[88:91], a[248:251], a[40:43], v[88:91]
    ds_write_b64 v38, v[72:73] offset:17408
    v_fma_f32 v82, v82, v206, v154
    v_mfma_f32_16x16x32_bf16 v[92:95], a[252:255], a[40:43], v[92:95]
    ds_write_b64 v38, v[74:75] offset:17440
    v_fma_f32 v83, v83, v206, v155
    v_mfma_f32_16x16x32_bf16 v[96:99], a[224:227], a[44:47], v[96:99]
    s_add_u32 m0, s63, 36864
    s_add_u32 s7, s64, 36864
    v_fma_f32 v84, v84, v206, v156
    v_mfma_f32_16x16x32_bf16 v[100:103], a[228:231], a[44:47], v[100:103]
    buffer_load_dwordx4 v26, s[24:27], s7 offen offset:0 sc1 lds
    v_mfma_f32_16x16x32_bf16 v[96:99], a[232:235], a[48:51], v[96:99]
    s_waitcnt lgkmcnt(6)
    v_fma_f32 v85, v85, v206, v157
    v_fma_f32 v86, v86, v206, v158
    v_fma_f32 v87, v87, v206, v159
    v_mfma_f32_16x16x32_bf16 v[100:103], a[236:239], a[48:51], v[100:103]
    v_cvt_pk_bf16_f32 v80, v80, v81
    v_cvt_pk_bf16_f32 v81, v82, v83
    v_cvt_pk_bf16_f32 v82, v84, v85
    v_mfma_f32_16x16x32_bf16 v[96:99], a[240:243], a[52:55], v[96:99]
    v_cvt_pk_bf16_f32 v83, v86, v87
    v_fma_f32 v88, v88, v210, v160
    v_fma_f32 v89, v89, v210, v161
    v_mfma_f32_16x16x32_bf16 v[100:103], a[244:247], a[52:55], v[100:103]
    ds_write_b64 v38, v[80:81] offset:21760
    v_fma_f32 v90, v90, v210, v162
    v_mfma_f32_16x16x32_bf16 v[96:99], a[248:251], a[56:59], v[96:99]
    ds_write_b64 v38, v[82:83] offset:21792
    v_fma_f32 v91, v91, v210, v163
    v_mfma_f32_16x16x32_bf16 v[100:103], a[252:255], a[56:59], v[100:103]
    v_fma_f32 v92, v92, v210, v164
    v_fma_f32 v93, v93, v210, v165
    v_mfma_f32_16x16x32_bf16 v[104:107], a[224:227], a[60:63], v[104:107]
    s_waitcnt lgkmcnt(4)
    v_fma_f32 v94, v94, v210, v166
    v_fma_f32 v95, v95, v210, v167
    v_mfma_f32_16x16x32_bf16 v[108:111], a[228:231], a[60:63], v[108:111]
    v_cvt_pk_bf16_f32 v88, v88, v89
    v_cvt_pk_bf16_f32 v89, v90, v91
    v_mfma_f32_16x16x32_bf16 v[104:107], a[232:235], a[64:67], v[104:107]
    v_cvt_pk_bf16_f32 v90, v92, v93
    v_cvt_pk_bf16_f32 v91, v94, v95
    v_mfma_f32_16x16x32_bf16 v[108:111], a[236:239], a[64:67], v[108:111]
    ds_write_b64 v38, v[88:89] offset:26112
    v_fma_f32 v96, v96, v214, v168
    v_mfma_f32_16x16x32_bf16 v[104:107], a[240:243], a[68:71], v[104:107]
    ds_write_b64 v38, v[90:91] offset:26144
    v_fma_f32 v97, v97, v214, v169
    v_mfma_f32_16x16x32_bf16 v[108:111], a[244:247], a[68:71], v[108:111]
    v_fma_f32 v98, v98, v214, v170
    v_fma_f32 v99, v99, v214, v171
    v_mfma_f32_16x16x32_bf16 v[104:107], a[248:251], a[72:75], v[104:107]
    v_fma_f32 v100, v100, v214, v172
    v_fma_f32 v101, v101, v214, v173
    v_mfma_f32_16x16x32_bf16 v[108:111], a[252:255], a[72:75], v[108:111]
    v_fma_f32 v102, v102, v214, v174
    v_fma_f32 v103, v103, v214, v175
    v_cvt_pk_bf16_f32 v96, v96, v97
    v_cvt_pk_bf16_f32 v97, v98, v99
    v_cvt_pk_bf16_f32 v98, v100, v101
    v_cvt_pk_bf16_f32 v99, v102, v103
    ds_write_b64 v38, v[96:97] offset:30464
    ds_write_b64 v38, v[98:99] offset:30496
    v_pk_fma_f32 v[104:105], v[104:105], v[218:219], v[176:177] op_sel_hi:[1,0,1]
    v_pk_fma_f32 v[106:107], v[106:107], v[218:219], v[178:179] op_sel_hi:[1,0,1]
    v_pk_fma_f32 v[108:109], v[108:109], v[218:219], v[180:181] op_sel_hi:[1,0,1]
    v_pk_fma_f32 v[110:111], v[110:111], v[218:219], v[182:183] op_sel_hi:[1,0,1]
    v_cvt_pk_bf16_f32 v104, v104, v105
    v_cvt_pk_bf16_f32 v105, v106, v107
    v_cvt_pk_bf16_f32 v106, v108, v109
    v_cvt_pk_bf16_f32 v107, v110, v111
    ds_write_b64 v38, v[104:105] offset:34816
    ds_write_b64 v38, v[106:107] offset:34848
    buffer_load_dwordx4 v26, s[24:27], s7 offen offset:1024 sc1 lds
    s_waitcnt lgkmcnt(0)
    s_barrier
    ds_read_b128 v[40:43], v241 offset:0
    ds_read_b128 v[56:59], v242 offset:80
    ds_read_b128 v[72:75], v241 offset:80
    ds_read_b128 v[44:47], v241 offset:32
    ds_read_b128 v[60:63], v242 offset:112
    ds_read_b128 v[76:79], v241 offset:112
    ds_read_b128 v[48:51], v241 offset:272
    ds_read_b128 v[64:67], v242 offset:352
    ds_read_b128 v[80:83], v241 offset:352
    ds_read_b128 v[52:55], v241 offset:304
    ds_read_b128 v[68:71], v242 offset:384
    ds_read_b128 v[84:87], v241 offset:384
    buffer_load_dwordx4 v26, s[24:27], s7 offen offset:2048 sc1 lds
    buffer_load_dwordx4 v26, s[24:27], s7 offen offset:3072 sc1 lds
    v_mov_b32 v184, 0x3f803f80
    v_mov_b32 v185, 0x3f803f80
    v_mov_b32 v186, 0x3f803f80
    v_mov_b32 v187, 0x3f803f80
    s_waitcnt lgkmcnt(11)
    v_cndmask_b32 v40, 0, v40, s[50:51]
    v_cndmask_b32 v41, 0, v41, s[50:51]
    v_cndmask_b32 v42, 0, v42, s[12:13]
    v_cndmask_b32 v43, 0, v43, s[12:13]
    s_waitcnt lgkmcnt(8)
    v_cndmask_b32 v44, 0, v44, s[74:75]
    v_cndmask_b32 v45, 0, v45, s[74:75]
    v_cndmask_b32 v46, 0, v46, s[50:51]
    v_cndmask_b32 v47, 0, v47, s[50:51]
    s_add_u32 m0, s63, 40960
    s_add_u32 s7, s64, 40960
    buffer_load_dwordx4 v26, s[24:27], s7 offen offset:0 sc1 lds
    s_waitcnt lgkmcnt(5)
    v_cndmask_b32 v48, 0, v48, s[50:51]
    v_cndmask_b32 v49, 0, v49, s[50:51]
    v_cndmask_b32 v50, 0, v50, s[12:13]
    v_cndmask_b32 v51, 0, v51, s[12:13]
    s_waitcnt lgkmcnt(2)
    v_cndmask_b32 v52, 0, v52, s[74:75]
    v_cndmask_b32 v53, 0, v53, s[74:75]
    v_cndmask_b32 v54, 0, v54, s[50:51]
    v_cndmask_b32 v55, 0, v55, s[50:51]
    v_mfma_f32_16x16x32_bf16 v[144:147], v[56:59], v[40:43], v[6:9]
    v_mfma_f32_16x16x32_bf16 v[160:163], v[72:75], v[40:43], v[248:251]
    v_mfma_f32_16x16x32_bf16 v[148:151], v[60:63], v[44:47], v[6:9]
    v_mfma_f32_16x16x32_bf16 v[164:167], v[76:79], v[44:47], v[248:251]
    buffer_load_dwordx4 v26, s[24:27], s7 offen offset:1024 sc1 lds
    v_mfma_f32_16x16x32_bf16 v[152:155], v[64:67], v[48:51], v[6:9]
    v_mfma_f32_16x16x32_bf16 v[168:171], v[80:83], v[48:51], v[248:251]
    s_waitcnt lgkmcnt(1)
    v_mfma_f32_16x16x32_bf16 v[156:159], v[68:71], v[52:55], v[6:9]
    s_waitcnt lgkmcnt(0)
    v_mfma_f32_16x16x32_bf16 v[172:175], v[84:87], v[52:55], v[248:251]
    ds_read_b64_tr_b16 v[88:89], v244 offset:160
    ds_read_b64_tr_b16 v[90:91], v243 offset:160
    ds_read_b64_tr_b16 v[92:93], v244 offset:200
    ds_read_b64_tr_b16 v[94:95], v243 offset:200
    ds_read_b64_tr_b16 v[104:105], v246 offset:192
    ds_read_b64_tr_b16 v[106:107], v245 offset:192
    ds_read_b64_tr_b16 v[96:97], v244 offset:432
    ds_read_b64_tr_b16 v[98:99], v243 offset:432
    buffer_load_dwordx4 v26, s[24:27], s7 offen offset:2048 sc1 lds
    ds_read_b64_tr_b16 v[100:101], v244 offset:472
    ds_read_b64_tr_b16 v[102:103], v243 offset:472
    ds_read_b64_tr_b16 v[108:109], v246 offset:464
    ds_read_b64_tr_b16 v[110:111], v245 offset:464
    v_mul_u32_u24 v4, 1280, v15
    v_lshl_add_u32 v4, v14, 4, v4
    v_add_u32 v6, 61440, v4
    v_max_f32 v144, v144, v160
    v_max_f32 v145, v145, v161
    v_max_f32 v146, v146, v162
    v_max_f32 v147, v147, v163
    v_max_f32 v148, v148, v164
    buffer_load_dwordx4 v26, s[24:27], s7 offen offset:3072 sc1 lds
    v_max_f32 v149, v149, v165
    v_max_f32 v150, v150, v166
    v_max_f32 v151, v151, v167
    v_max_f32 v152, v152, v168
    v_max_f32 v153, v153, v169
    v_max_f32 v154, v154, v170
    v_max_f32 v155, v155, v171
    v_max_f32 v156, v156, v172
    v_max_f32 v157, v157, v173
    v_max_f32 v158, v158, v174
    v_max_f32 v159, v159, v175
    v_max3_f32 v176, v144, v145, v146
    s_add_u32 m0, s63, 45056
    s_add_u32 s7, s64, 45056
    buffer_load_dwordx4 v26, s[24:27], s7 offen offset:0 sc1 lds
    v_max3_f32 v177, v148, v149, v150
    v_max3_f32 v178, v152, v153, v154
    v_max3_f32 v179, v156, v157, v158
    v_max_f32 v176, v176, v147
    v_max_f32 v177, v177, v151
    v_max_f32 v178, v178, v155
    v_max_f32 v179, v179, v159
    v_mov_b32 v180, v176
    v_mov_b32 v181, v177
    v_mov_b32 v182, v178
    v_mov_b32 v183, v179
    v_permlane16_swap_b32 v176, v180
    s_mul_i32 s63, s3, 7168
    s_add_u32 s64, s60, s63
    s_add_u32 m0, s63, 73728
    s_add_u32 s7, s64, 73728
    buffer_load_dwordx4 v26, s[24:27], s7 offen offset:0 sc1 lds
    v_permlane16_swap_b32 v177, v181
    v_permlane16_swap_b32 v178, v182
    v_permlane16_swap_b32 v179, v183
    v_max_f32 v176, v176, v180
    v_max_f32 v177, v177, v181
    v_max_f32 v178, v178, v182
    v_max_f32 v179, v179, v183
    v_mov_b32 v180, v176
    v_mov_b32 v181, v177
    v_mov_b32 v182, v178
    v_mov_b32 v183, v179
    v_permlane32_swap_b32 v176, v180
    buffer_load_dwordx4 v26, s[24:27], s7 offen offset:1024 sc1 lds
    v_permlane32_swap_b32 v177, v181
    v_permlane32_swap_b32 v178, v182
    v_permlane32_swap_b32 v179, v183
    v_max_f32 v176, v176, v180
    v_max_f32 v177, v177, v181
    v_max_f32 v178, v178, v182
    v_max_f32 v179, v179, v183
    s_mov_b32 s55, 0x3ea52b5c
    v_mul_f32 v176, s55, v176
    v_mul_f32 v177, s55, v177
    v_mul_f32 v178, s55, v178
    v_mul_f32 v179, s55, v179
    buffer_load_dwordx4 v26, s[24:27], s7 offen offset:2048 sc1 lds
    v_fma_f32 v144, v144, s55, -v176
    v_fma_f32 v145, v145, s55, -v176
    v_fma_f32 v146, v146, s55, -v176
    v_fma_f32 v147, v147, s55, -v176
    v_fma_f32 v148, v148, s55, -v177
    v_fma_f32 v149, v149, s55, -v177
    v_fma_f32 v150, v150, s55, -v177
    v_fma_f32 v151, v151, s55, -v177
    v_fma_f32 v152, v152, s55, -v178
    v_fma_f32 v153, v153, s55, -v178
    v_fma_f32 v154, v154, s55, -v178
    v_fma_f32 v155, v155, s55, -v178
    buffer_load_dwordx4 v26, s[24:27], s7 offen offset:3072 sc1 lds
    v_fma_f32 v156, v156, s55, -v179
    v_fma_f32 v157, v157, s55, -v179
    v_fma_f32 v158, v158, s55, -v179
    v_fma_f32 v159, v159, s55, -v179
    v_exp_f32 v144, v144
    v_exp_f32 v145, v145
    v_exp_f32 v146, v146
    v_exp_f32 v147, v147
    v_exp_f32 v148, v148
    v_exp_f32 v149, v149
    v_exp_f32 v150, v150
    v_exp_f32 v151, v151
    s_add_u32 m0, s63, 77824
    s_add_u32 s7, s64, 77824
    buffer_load_dwordx4 v26, s[24:27], s7 offen offset:0 sc1 lds
    v_exp_f32 v152, v152
    v_exp_f32 v153, v153
    v_exp_f32 v154, v154
    v_exp_f32 v155, v155
    v_exp_f32 v156, v156
    v_exp_f32 v157, v157
    v_exp_f32 v158, v158
    v_exp_f32 v159, v159
    v_cvt_pk_bf16_f32 v144, v144, v145
    v_cvt_pk_bf16_f32 v145, v146, v147
    v_cvt_pk_bf16_f32 v148, v148, v149
    v_cvt_pk_bf16_f32 v149, v150, v151
    buffer_load_dwordx4 v26, s[24:27], s7 offen offset:1024 sc1 lds
    v_cvt_pk_bf16_f32 v152, v152, v153
    v_cvt_pk_bf16_f32 v153, v154, v155
    v_cvt_pk_bf16_f32 v156, v156, v157
    v_cvt_pk_bf16_f32 v157, v158, v159
    v_bfi_b32 v160, v19, 0, v144
    v_bfi_b32 v161, v36, 0, v145
    v_bfi_b32 v162, v37, 0, v144
    v_bfi_b32 v163, v254, 0, v145
    v_bfi_b32 v164, v19, 0, v148
    v_bfi_b32 v165, v36, 0, v149
    v_bfi_b32 v166, v37, 0, v148
    v_bfi_b32 v167, v254, 0, v149
    buffer_load_dwordx4 v26, s[24:27], s7 offen offset:2048 sc1 lds
    v_bfi_b32 v168, v19, 0, v152
    v_bfi_b32 v169, v36, 0, v153
    v_bfi_b32 v170, v37, 0, v152
    v_bfi_b32 v171, v254, 0, v153
    v_bfi_b32 v172, v19, 0, v156
    v_bfi_b32 v173, v36, 0, v157
    v_bfi_b32 v174, v37, 0, v156
    v_bfi_b32 v175, v254, 0, v157
    v_mfma_f32_16x16x32_bf16 v[72:75], v[184:187], v[160:163], 0
    v_mfma_f32_16x16x32_bf16 v[76:79], v[184:187], v[164:167], 0
    v_mfma_f32_16x16x32_bf16 v[80:83], v[184:187], v[168:171], 0
    v_mfma_f32_16x16x32_bf16 v[84:87], v[184:187], v[172:175], 0
    s_waitcnt lgkmcnt(10)
    v_mfma_f32_16x16x32_bf16 v[40:43], v[88:91], v[160:163], 0
    s_waitcnt lgkmcnt(8)
    v_mfma_f32_16x16x32_bf16 v[44:47], v[92:95], v[164:167], 0
    s_waitcnt lgkmcnt(4)
    v_mfma_f32_16x16x32_bf16 v[48:51], v[96:99], v[168:171], 0
    s_waitcnt lgkmcnt(2)
    v_mfma_f32_16x16x32_bf16 v[52:55], v[100:103], v[172:175], 0
    v_mfma_f32_16x16x32_bf16 v[56:59], v[104:107], v[160:163], 0
    v_mfma_f32_16x16x32_bf16 v[60:63], v[104:107], v[164:167], 0
    s_waitcnt lgkmcnt(0)
    v_mfma_f32_16x16x32_bf16 v[64:67], v[108:111], v[168:171], 0
    v_mfma_f32_16x16x32_bf16 v[68:71], v[108:111], v[172:175], 0
    v_rcp_f32 v72, v72
    v_rcp_f32 v76, v76
    v_rcp_f32 v80, v80
    v_rcp_f32 v84, v84
    v_pk_mul_f32 v[40:41], v[40:41], v[72:73] op_sel_hi:[1,0]
    v_pk_mul_f32 v[42:43], v[42:43], v[72:73] op_sel_hi:[1,0]
    v_pk_mul_f32 v[44:45], v[44:45], v[76:77] op_sel_hi:[1,0]
    v_pk_mul_f32 v[46:47], v[46:47], v[76:77] op_sel_hi:[1,0]
    v_pk_mul_f32 v[48:49], v[48:49], v[80:81] op_sel_hi:[1,0]
    v_pk_mul_f32 v[50:51], v[50:51], v[80:81] op_sel_hi:[1,0]
    v_pk_mul_f32 v[52:53], v[52:53], v[84:85] op_sel_hi:[1,0]
    v_pk_mul_f32 v[54:55], v[54:55], v[84:85] op_sel_hi:[1,0]
    v_cvt_pk_bf16_f32 v144, v40, v41
    v_cvt_pk_bf16_f32 v145, v42, v43
    v_cvt_pk_bf16_f32 v146, v44, v45
    v_cvt_pk_bf16_f32 v147, v46, v47
    v_cvt_pk_bf16_f32 v148, v48, v49
    v_cvt_pk_bf16_f32 v149, v50, v51
    v_cvt_pk_bf16_f32 v150, v52, v53
    v_cvt_pk_bf16_f32 v151, v54, v55
    s_add_u32 s55, s91, 20480
    s_cmp_eq_u32 s88, 0
    s_cbranch_scc1 L_gs_11
    buffer_store_dwordx4 v[144:147], v24, s[24:27], s91 offen
    buffer_store_dwordx4 v[148:151], v24, s[24:27], s55 offen
    s_branch L_ge_12
L_gs_11:
    buffer_store_dwordx4 v[144:147], v24, s[24:27], s91 offen sc0 sc1
    buffer_store_dwordx4 v[148:151], v24, s[24:27], s55 offen sc0 sc1
L_ge_12:
    s_nop 1
    v_cmp_eq_u32 vcc, 1, v15
    s_nop 1
    v_cndmask_b32 v56, v56, v60, vcc
    v_cndmask_b32 v57, v57, v61, vcc
    v_cndmask_b32 v58, v58, v62, vcc
    v_cndmask_b32 v59, v59, v63, vcc
    v_cndmask_b32 v72, v72, v76, vcc
    v_cmp_eq_u32 vcc, 2, v15
    s_nop 1
    v_cndmask_b32 v56, v56, v64, vcc
    v_cndmask_b32 v57, v57, v65, vcc
    v_cndmask_b32 v58, v58, v66, vcc
    v_cndmask_b32 v59, v59, v67, vcc
    v_cndmask_b32 v72, v72, v80, vcc
    v_cmp_eq_u32 vcc, 3, v15
    s_nop 1
    v_cndmask_b32 v56, v56, v68, vcc
    v_cndmask_b32 v57, v57, v69, vcc
    v_cndmask_b32 v58, v58, v70, vcc
    v_cndmask_b32 v59, v59, v71, vcc
    v_cndmask_b32 v72, v72, v84, vcc
    v_pk_mul_f32 v[56:57], v[56:57], v[72:73] op_sel_hi:[1,0]
    v_pk_mul_f32 v[58:59], v[58:59], v[72:73] op_sel_hi:[1,0]
    v_cvt_pk_bf16_f32 v152, v56, v57
    v_cvt_pk_bf16_f32 v153, v58, v59
    s_cmp_eq_u32 s88, 0
    s_cbranch_scc1 L_gs_13
    buffer_store_dwordx2 v[152:153], v25, s[24:27], s91 offen
    s_branch L_ge_14
L_gs_13:
    buffer_store_dwordx2 v[152:153], v25, s[24:27], s91 offen sc0 sc1
L_ge_14:
    s_nop 1
    v_mul_u32_u24 v7, 160, v14
    v_lshl_add_u32 v7, v15, 3, v7
    v_add_u32 v7, s58, v7
    v_mov_b32 v33, v7
    v_add_u32 v34, s58, v26
    s_waitcnt vmcnt(0)
    s_mov_b64 exec, 1
    s_cmp_eq_u32 s88, 0
    s_cbranch_scc1 L_gs_15
    buffer_store_dword v39, off, s[24:27], s59
    s_branch L_ge_16
L_gs_15:
    buffer_store_dword v39, off, s[24:27], s59 sc0 sc1
L_ge_16:
    s_nop 1
    s_mov_b64 exec, -1
    buffer_load_dword v9, v247, s[24:27], s57 offen sc1
    buffer_load_dwordx4 v[64:67], v27, s[24:27], s70 offen offset:0 sc1
    buffer_load_dwordx4 v[68:71], v27, s[24:27], s70 offen offset:512 sc1
    buffer_load_dwordx4 v[72:75], v27, s[24:27], s70 offen offset:1024 sc1
    buffer_load_dwordx4 v[76:79], v27, s[24:27], s70 offen offset:1536 sc1
    s_add_u32 m0, s58, 0
    s_nop 0
    buffer_load_dwordx4 v16, s[8:11], s71 offen lds
    s_add_u32 m0, s58, 1024
    s_nop 0
    buffer_load_dwordx4 v17, s[8:11], s71 offen lds
    s_add_u32 m0, s58, 2048
    s_nop 0
    buffer_load_dwordx4 v18, s[8:11], s71 offen lds
    s_barrier
    s_mul_i32 s52, s86, 20480
    s_add_u32 s52, s52, 0x100000
    s_add_u32 s53, s52, 4096
    s_add_u32 s54, s52, 8192
    s_add_u32 s55, s52, 12288
    s_add_u32 s56, s52, 16384
    v_mov_b32 v2, v26
    v_lshlrev_b32 v3, 4, v15
    v_add_u32 v3, 102400, v3
    v_and_b32 v12, 7, v1
    v_lshlrev_b32 v12, 7, v12
    ds_read_b128 a[56:59], v4 offset:0
    ds_read_b128 a[60:63], v4 offset:256
    ds_read_b128 a[64:67], v4 offset:512
    ds_read_b128 a[68:71], v4 offset:768
    ds_read_b128 a[72:75], v4 offset:1024
    ds_read_b128 a[76:79], v4 offset:5120
    ds_read_b128 a[80:83], v4 offset:5376
    ds_read_b128 a[84:87], v4 offset:5632
    ds_read_b128 a[88:91], v4 offset:5888
    ds_read_b128 a[92:95], v4 offset:6144
    ds_read_b128 a[96:99], v4 offset:10240
    ds_read_b128 a[100:103], v4 offset:10496
    ds_read_b128 a[104:107], v4 offset:10752
    ds_read_b128 a[108:111], v4 offset:11008
    ds_read_b128 a[112:115], v4 offset:11264
    ds_read_b128 a[116:119], v4 offset:15360
    ds_read_b128 a[120:123], v4 offset:15616
    ds_read_b128 a[124:127], v4 offset:15872
    ds_read_b128 a[128:131], v4 offset:16128
    ds_read_b128 a[132:135], v4 offset:16384
    ds_read_b128 a[136:139], v4 offset:20480
    ds_read_b128 a[140:143], v4 offset:20736
    ds_read_b128 a[144:147], v4 offset:20992
    ds_read_b128 a[148:151], v4 offset:21248
    ds_read_b128 a[152:155], v4 offset:21504
    ds_read_b128 a[156:159], v4 offset:25600
    ds_read_b128 a[160:163], v4 offset:25856
    ds_read_b128 a[164:167], v4 offset:26112
    ds_read_b128 a[168:171], v4 offset:26368
    ds_read_b128 a[172:175], v4 offset:26624
    ds_read_b128 a[176:179], v4 offset:30720
    ds_read_b128 a[180:183], v4 offset:30976
    ds_read_b128 a[184:187], v4 offset:31232
    ds_read_b128 a[188:191], v4 offset:31488
    ds_read_b128 a[192:195], v4 offset:31744
    ds_read_b128 a[196:199], v4 offset:35840
    ds_read_b128 a[200:203], v4 offset:36096
    ds_read_b128 a[204:207], v4 offset:36352
    ds_read_b128 a[208:211], v4 offset:36608
    ds_read_b128 a[212:215], v4 offset:36864
    ds_read_b128 a[216:219], v4 offset:40960
    ds_read_b128 a[220:223], v4 offset:41216
    ds_read_b128 a[224:227], v4 offset:41472
    ds_read_b128 a[228:231], v4 offset:41728
    ds_read_b128 a[232:235], v4 offset:41984
    ds_read_b128 a[236:239], v4 offset:46080
    ds_read_b128 a[240:243], v4 offset:46336
    ds_read_b128 a[244:247], v4 offset:46592
    ds_read_b128 a[248:251], v4 offset:46848
    ds_read_b128 a[252:255], v4 offset:47104
    ds_read_b128 v[100:103], v4 offset:51200
    ds_read_b128 v[104:107], v4 offset:51456
    ds_read_b128 v[108:111], v4 offset:51712
    ds_read_b128 v[112:115], v4 offset:51968
    ds_read_b128 v[116:119], v4 offset:52224
    ds_read_b128 v[120:123], v4 offset:56320
    ds_read_b128 v[124:127], v4 offset:56576
    ds_read_b128 v[128:131], v4 offset:56832
    ds_read_b128 v[132:135], v4 offset:57088
    ds_read_b128 v[136:139], v4 offset:57344
    s_waitcnt vmcnt(7)
    v_cmp_ne_u32 vcc, s6, v9
    s_nop 4
    s_cbranch_vccz L_done_18
    s_mov_b32 s90, 0
L_poll_17:
    s_nop 1
    buffer_load_dword v9, v247, s[24:27], s57 offen sc1
    s_waitcnt vmcnt(0)
    v_cmp_ne_u32 vcc, s6, v9
    s_nop 4
    s_cbranch_vccz L_done_18
    s_add_u32 s90, s90, 1
    s_cmp_lt_u32 s90, 40000
    s_cbranch_scc1 L_poll_17
L_done_18:
    s_nop 1
    buffer_load_dwordx4 v[144:147], v2, s[24:27], s52 offen offset:0 sc1
    buffer_load_dwordx4 v[148:151], v2, s[24:27], s52 offen offset:1024 sc1
    buffer_load_dwordx4 v[152:155], v2, s[24:27], s52 offen offset:2048 sc1
    buffer_load_dwordx4 v[156:159], v2, s[24:27], s52 offen offset:3072 sc1
    buffer_load_dwordx4 v[160:163], v2, s[24:27], s53 offen offset:0 sc1
    buffer_load_dwordx4 v[164:167], v2, s[24:27], s53 offen offset:1024 sc1
    buffer_load_dwordx4 v[168:171], v2, s[24:27], s53 offen offset:2048 sc1
    buffer_load_dwordx4 v[172:175], v2, s[24:27], s53 offen offset:3072 sc1
    s_waitcnt vmcnt(14)
    v_cmp_ne_u32 vcc, s6, v65
    v_cmp_ne_u32 s[98:99], s6, v67
    s_nop 0
    s_or_b64 vcc, vcc, s[98:99]
    s_waitcnt vmcnt(13)
    v_cmp_ne_u32 s[98:99], s6, v69
    s_nop 0
    s_or_b64 vcc, vcc, s[98:99]
    v_cmp_ne_u32 s[98:99], s6, v71
    s_nop 0
    s_or_b64 vcc, vcc, s[98:99]
    s_waitcnt vmcnt(12)
    v_cmp_ne_u32 s[98:99], s6, v73
    s_nop 0
    s_or_b64 vcc, vcc, s[98:99]
    v_cmp_ne_u32 s[98:99], s6, v75
    s_nop 0
    s_or_b64 vcc, vcc, s[98:99]
    s_waitcnt vmcnt(11)
    v_cmp_ne_u32 s[98:99], s6, v77
    s_nop 0
    s_or_b64 vcc, vcc, s[98:99]
    v_cmp_ne_u32 s[98:99], s6, v79
    s_nop 0
    s_or_b64 vcc, vcc, s[98:99]
    s_nop 4
    s_cbranch_vccz L_done_20
    s_mov_b32 s90, 0
L_poll_19:
    s_nop 1
    buffer_load_dwordx4 v[64:67], v27, s[24:27], s70 offen offset:0 sc1
    buffer_load_dwordx4 v[68:71], v27, s[24:27], s70 offen offset:512 sc1
    buffer_load_dwordx4 v[72:75], v27, s[24:27], s70 offen offset:1024 sc1
    buffer_load_dwordx4 v[76:79], v27, s[24:27], s70 offen offset:1536 sc1
    s_waitcnt vmcnt(0)
    v_cmp_ne_u32 vcc, s6, v65
    v_cmp_ne_u32 s[98:99], s6, v67
    s_nop 0
    s_or_b64 vcc, vcc, s[98:99]
    v_cmp_ne_u32 s[98:99], s6, v69
    s_nop 0
    s_or_b64 vcc, vcc, s[98:99]
    v_cmp_ne_u32 s[98:99], s6, v71
    s_nop 0
    s_or_b64 vcc, vcc, s[98:99]
    v_cmp_ne_u32 s[98:99], s6, v73
    s_nop 0
    s_or_b64 vcc, vcc, s[98:99]
    v_cmp_ne_u32 s[98:99], s6, v75
    s_nop 0
    s_or_b64 vcc, vcc, s[98:99]
    v_cmp_ne_u32 s[98:99], s6, v77
    s_nop 0
    s_or_b64 vcc, vcc, s[98:99]
    v_cmp_ne_u32 s[98:99], s6, v79
    s_nop 0
    s_or_b64 vcc, vcc, s[98:99]
    s_nop 4
    s_cbranch_vccz L_done_20
    s_add_u32 s90, s90, 1
    s_cmp_lt_u32 s90, 40000
    s_cbranch_scc1 L_poll_19
L_done_20:
    s_nop 1
    s_waitcnt vmcnt(8)
    ds_read_b64 v[40:41], v7 offset:0
    ds_read_b64 v[42:43], v7 offset:32
    ds_read_b64 v[44:45], v7 offset:64
    ds_read_b64 v[46:47], v7 offset:96
    ds_read_b64 v[48:49], v7 offset:128
    v_accvgpr_read_b32 v52, a36
    v_add_f32 v64, v64, v68
    v_add_f32 v72, v72, v76
    v_add_f32 v66, v66, v70
    v_add_f32 v74, v74, v78
    s_cmp_eq_u32 s3, 2
    s_cselect_b32 s62, 1.0, 0
    s_movk_i32 s63, 1920
    s_cselect_b32 s63, 640, s63
    v_add_f32 v64, v64, v72
    v_add_f32 v66, v66, v74
    v_min_u32 v8, 39, v1
    v_cvt_pk_bf16_f32 v64, v64, v66
    s_mul_i32 s65, s3, 320
    v_lshlrev_b32 v66, 16, v64
    v_and_b32 v67, s84, v64
    s_add_u32 s65, s65, 102400
    v_add_f32 v66, s62, v66
    v_add_f32 v67, s62, v67
    v_lshl_add_u32 v8, v8, 3, s65
    v_cvt_pk_bf16_f32 v64, v66, v67
    v_lshlrev_b32 v68, 16, v52
    v_and_b32 v69, s84, v52
    v_lshlrev_b32 v66, 16, v64
    v_and_b32 v67, s84, v64
    v_add_u32 v7, s63, v8
    v_mul_f32 v68, v68, v66
    v_mul_f32 v69, v69, v67
    ds_write_b64 v8, v[66:67]
    v_cmp_gt_u32 vcc, 40, v1
    ds_write_b64 v7, v[68:69]
    v_add_f32 v50, v68, v69
    s_lshr_b32 s62, s86, 2
    v_cndmask_b32 v50, 0, v50, vcc
    s_waitcnt vmcnt(7) lgkmcnt(14)
    v_mfma_f32_16x16x32_bf16 v[244:247], a[56:59], v[144:147], 0
    buffer_load_dwordx4 v[176:179], v2, s[24:27], s54 offen offset:0 sc1
    buffer_load_dwordx4 v[180:183], v2, s[24:27], s54 offen offset:1024 sc1
    v_mfma_f32_16x16x32_bf16 v[248:251], a[60:63], v[144:147], 0
    s_lshl_b32 s62, s62, 10
    s_add_u32 s61, s62, 0xc8000
    v_mfma_f32_16x16x32_bf16 v[140:143], a[64:67], v[144:147], 0
    s_lshl_b32 s62, s87, 7
    s_add_u32 s62, s62, s61
    v_mfma_f32_16x16x32_bf16 v[20:23], a[68:71], v[144:147], 0
    s_lshl_b32 s63, s3, 3
    v_mfma_f32_16x16x32_bf16 v[36:39], a[72:75], v[144:147], 0
    s_waitcnt vmcnt(8)
    v_mfma_f32_16x16x32_bf16 v[244:247], a[76:79], v[148:151], v[244:247]
    buffer_load_dwordx4 v[184:187], v2, s[24:27], s54 offen offset:2048 sc1
    s_add_u32 s59, s62, s63
    v_mfma_f32_16x16x32_bf16 v[248:251], a[80:83], v[148:151], v[248:251]
    s_waitcnt lgkmcnt(6)
    v_lshlrev_b32 v80, 16, v40
    v_and_b32 v81, s84, v40
    v_mfma_f32_16x16x32_bf16 v[140:143], a[84:87], v[148:151], v[140:143]
    v_add_f32_dpp v50, v50, v50 quad_perm:[1,0,3,2] row_mask:0xf bank_mask:0xf
    v_lshlrev_b32 v82, 16, v41
    v_mfma_f32_16x16x32_bf16 v[20:23], a[88:91], v[148:151], v[20:23]
    v_mfma_f32_16x16x32_bf16 v[36:39], a[92:95], v[148:151], v[36:39]
    s_waitcnt vmcnt(8)
    v_mfma_f32_16x16x32_bf16 v[244:247], a[96:99], v[152:155], v[244:247]
    buffer_load_dwordx4 v[188:191], v2, s[24:27], s54 offen offset:3072 sc1
    buffer_load_dwordx4 v[192:195], v2, s[24:27], s55 offen offset:0 sc1
    v_mfma_f32_16x16x32_bf16 v[248:251], a[100:103], v[152:155], v[248:251]
    v_and_b32 v83, s84, v41
    v_add_f32_dpp v50, v50, v50 quad_perm:[2,3,0,1] row_mask:0xf bank_mask:0xf
    v_mfma_f32_16x16x32_bf16 v[140:143], a[104:107], v[152:155], v[140:143]
    s_waitcnt lgkmcnt(5)
    v_lshlrev_b32 v84, 16, v42
    v_and_b32 v85, s84, v42
    v_mfma_f32_16x16x32_bf16 v[20:23], a[108:111], v[152:155], v[20:23]
    v_add_f32_dpp v50, v50, v50 row_ror:4 row_mask:0xf bank_mask:0xf
    v_mfma_f32_16x16x32_bf16 v[36:39], a[112:115], v[152:155], v[36:39]
    s_waitcnt vmcnt(9)
    v_mfma_f32_16x16x32_bf16 v[244:247], a[116:119], v[156:159], v[244:247]
    buffer_load_dwordx4 v[196:199], v2, s[24:27], s55 offen offset:1024 sc1
    v_lshlrev_b32 v86, 16, v43
    v_mfma_f32_16x16x32_bf16 v[248:251], a[120:123], v[156:159], v[248:251]
    v_and_b32 v87, s84, v43
    v_add_f32_dpp v50, v50, v50 row_ror:8 row_mask:0xf bank_mask:0xf
    v_mfma_f32_16x16x32_bf16 v[140:143], a[124:127], v[156:159], v[140:143]
    v_mov_b32 v51, v50
    s_waitcnt lgkmcnt(4)
    v_lshlrev_b32 v88, 16, v44
    v_mfma_f32_16x16x32_bf16 v[20:23], a[128:131], v[156:159], v[20:23]
    v_mfma_f32_16x16x32_bf16 v[36:39], a[132:135], v[156:159], v[36:39]
    s_waitcnt vmcnt(9)
    v_mfma_f32_16x16x32_bf16 v[244:247], a[136:139], v[160:163], v[244:247]
    buffer_load_dwordx4 v[200:203], v2, s[24:27], s55 offen offset:2048 sc1
    buffer_load_dwordx4 v[204:207], v2, s[24:27], s55 offen offset:3072 sc1
    v_mfma_f32_16x16x32_bf16 v[248:251], a[140:143], v[160:163], v[248:251]
    ds_read_b128 a[56:59], v6 offset:0
    ds_read_b128 a[60:63], v6 offset:256
    v_mfma_f32_16x16x32_bf16 v[140:143], a[144:147], v[160:163], v[140:143]
    ds_read_b128 a[64:67], v6 offset:512
    ds_read_b128 a[68:71], v6 offset:768
    v_mfma_f32_16x16x32_bf16 v[20:23], a[148:151], v[160:163], v[20:23]
    ds_read_b128 a[72:75], v6 offset:1024
    v_mfma_f32_16x16x32_bf16 v[36:39], a[152:155], v[160:163], v[36:39]
    s_waitcnt lgkmcnt(0)
    s_barrier
    s_waitcnt vmcnt(10)
    v_mfma_f32_16x16x32_bf16 v[244:247], a[156:159], v[164:167], v[244:247]
    buffer_load_dwordx4 v[208:211], v2, s[24:27], s56 offen offset:0 sc1
    ds_read_b128 a[76:79], v6 offset:5120
    v_mfma_f32_16x16x32_bf16 v[248:251], a[160:163], v[164:167], v[248:251]
    ds_read_b128 a[80:83], v6 offset:5376
    ds_read_b128 a[84:87], v6 offset:5632
    v_mfma_f32_16x16x32_bf16 v[140:143], a[164:167], v[164:167], v[140:143]
    ds_read_b128 a[88:91], v6 offset:5888
    ds_read_b128 a[92:95], v6 offset:6144
    v_mfma_f32_16x16x32_bf16 v[20:23], a[168:171], v[164:167], v[20:23]
    v_mfma_f32_16x16x32_bf16 v[36:39], a[172:175], v[164:167], v[36:39]
    s_waitcnt vmcnt(10)
    v_mfma_f32_16x16x32_bf16 v[244:247], a[176:179], v[168:171], v[244:247]
    buffer_load_dwordx4 v[212:215], v2, s[24:27], s56 offen offset:1024 sc1
    buffer_load_dwordx4 v[216:219], v2, s[24:27], s56 offen offset:2048 sc1
    v_mfma_f32_16x16x32_bf16 v[248:251], a[180:183], v[168:171], v[248:251]
    ds_read_b128 a[96:99], v6 offset:10240
    ds_read_b128 a[100:103], v6 offset:10496
    v_mfma_f32_16x16x32_bf16 v[140:143], a[184:187], v[168:171], v[140:143]
    ds_read_b128 a[104:107], v6 offset:10752
    ds_read_b128 a[108:111], v6 offset:11008
    v_mfma_f32_16x16x32_bf16 v[20:23], a[188:191], v[168:171], v[20:23]
    ds_read_b128 a[112:115], v6 offset:11264
    v_mfma_f32_16x16x32_bf16 v[36:39], a[192:195], v[168:171], v[36:39]
    s_waitcnt vmcnt(11)
    v_mfma_f32_16x16x32_bf16 v[244:247], a[196:199], v[172:175], v[244:247]
    buffer_load_dwordx4 v[220:223], v2, s[24:27], s56 offen offset:3072 sc1
    ds_read_b128 a[116:119], v6 offset:15360
    v_mfma_f32_16x16x32_bf16 v[248:251], a[200:203], v[172:175], v[248:251]
    ds_read_b128 a[120:123], v6 offset:15616
    ds_read_b128 a[124:127], v6 offset:15872
    v_mfma_f32_16x16x32_bf16 v[140:143], a[204:207], v[172:175], v[140:143]
    ds_read_b128 a[128:131], v6 offset:16128
    ds_read_b128 a[132:135], v6 offset:16384
    v_mfma_f32_16x16x32_bf16 v[20:23], a[208:211], v[172:175], v[20:23]
    v_mfma_f32_16x16x32_bf16 v[36:39], a[212:215], v[172:175], v[36:39]
    s_waitcnt vmcnt(11)
    v_mfma_f32_16x16x32_bf16 v[244:247], a[216:219], v[176:179], v[244:247]
    ds_read_b128 a[136:139], v6 offset:20480
    v_mfma_f32_16x16x32_bf16 v[248:251], a[220:223], v[176:179], v[248:251]
    ds_read_b128 a[140:143], v6 offset:20736
    v_mfma_f32_16x16x32_bf16 v[140:143], a[224:227], v[176:179], v[140:143]
    ds_read_b128 a[144:147], v6 offset:20992
    v_mfma_f32_16x16x32_bf16 v[20:23], a[228:231], v[176:179], v[20:23]
    ds_read_b128 a[148:151], v6 offset:21248
    v_mfma_f32_16x16x32_bf16 v[36:39], a[232:235], v[176:179], v[36:39]
    ds_read_b128 a[152:155], v6 offset:21504
    s_waitcnt vmcnt(10)
    v_mfma_f32_16x16x32_bf16 v[244:247], a[236:239], v[180:183], v[244:247]
    ds_read_b128 a[156:159], v6 offset:25600
    v_mfma_f32_16x16x32_bf16 v[248:251], a[240:243], v[180:183], v[248:251]
    ds_read_b128 a[160:163], v6 offset:25856
    v_mfma_f32_16x16x32_bf16 v[140:143], a[244:247], v[180:183], v[140:143]
    ds_read_b128 a[164:167], v6 offset:26112
    v_mfma_f32_16x16x32_bf16 v[20:23], a[248:251], v[180:183], v[20:23]
    ds_read_b128 a[168:171], v6 offset:26368
    v_mfma_f32_16x16x32_bf16 v[36:39], a[252:255], v[180:183], v[36:39]
    ds_read_b128 a[172:175], v6 offset:26624
    s_waitcnt vmcnt(9)
    v_mfma_f32_16x16x32_bf16 v[244:247], v[100:103], v[184:187], v[244:247]
    ds_read_b128 a[176:179], v6 offset:30720
    ds_read_b128 a[180:183], v6 offset:30976
    v_mfma_f32_16x16x32_bf16 v[248:251], v[104:107], v[184:187], v[248:251]
    ds_read_b128 a[184:187], v6 offset:31232
    ds_read_b128 a[188:191], v6 offset:31488
    v_mfma_f32_16x16x32_bf16 v[140:143], v[108:111], v[184:187], v[140:143]
    ds_read_b128 a[192:195], v6 offset:31744
    buffer_load_dwordx4 a[0:3], v31, s[40:43], 0 offen
    v_mfma_f32_16x16x32_bf16 v[20:23], v[112:115], v[184:187], v[20:23]
    v_mfma_f32_16x16x32_bf16 v[36:39], v[116:119], v[184:187], v[36:39]
    s_waitcnt vmcnt(9)
    v_mfma_f32_16x16x32_bf16 v[244:247], v[120:123], v[188:191], v[244:247]
    ds_read_b128 a[196:199], v6 offset:35840
    ds_read_b128 a[200:203], v6 offset:36096
    v_mfma_f32_16x16x32_bf16 v[248:251], v[124:127], v[188:191], v[248:251]
    ds_read_b128 a[204:207], v6 offset:36352
    ds_read_b128 a[208:211], v6 offset:36608
    v_mfma_f32_16x16x32_bf16 v[140:143], v[128:131], v[188:191], v[140:143]
    ds_read_b128 a[212:215], v6 offset:36864
    buffer_load_dwordx4 a[4:7], v31, s[40:43], s16 offen
    v_mfma_f32_16x16x32_bf16 v[20:23], v[132:135], v[188:191], v[20:23]
    v_mfma_f32_16x16x32_bf16 v[36:39], v[136:139], v[188:191], v[36:39]
    s_waitcnt vmcnt(9)
    v_mfma_f32_16x16x32_bf16 v[244:247], a[56:59], v[192:195], v[244:247]
    buffer_load_dwordx4 a[8:11], v32, s[40:43], s17 offen
    v_and_b32 v89, s84, v44
    v_mfma_f32_16x16x32_bf16 v[248:251], a[60:63], v[192:195], v[248:251]
    v_permlane16_swap_b32 v50, v51
    v_add_f32 v50, v50, v51
    v_mfma_f32_16x16x32_bf16 v[140:143], a[64:67], v[192:195], v[140:143]
    v_mov_b32 v51, v50
    v_lshlrev_b32 v90, 16, v45
    v_mfma_f32_16x16x32_bf16 v[20:23], a[68:71], v[192:195], v[20:23]
    v_mfma_f32_16x16x32_bf16 v[36:39], a[72:75], v[192:195], v[36:39]
    s_waitcnt vmcnt(9) lgkmcnt(14)
    v_mfma_f32_16x16x32_bf16 v[244:247], a[76:79], v[196:199], v[244:247]
    buffer_load_dwordx4 a[12:15], v31, s[44:47], 0 offen
    v_and_b32 v91, s84, v45
    v_mfma_f32_16x16x32_bf16 v[248:251], a[80:83], v[196:199], v[248:251]
    v_permlane32_swap_b32 v50, v51
    v_add_f32 v50, v50, v51
    v_mfma_f32_16x16x32_bf16 v[140:143], a[84:87], v[196:199], v[140:143]
    v_mov_b32 v51, s6
    s_mov_b64 exec, 1
    s_cmp_eq_u32 s88, 0
    s_cbranch_scc1 L_gs_21
    buffer_store_dwordx2 v[50:51], off, s[24:27], s59 offset:8
    s_branch L_ge_22
L_gs_21:
    buffer_store_dwordx2 v[50:51], off, s[24:27], s59 offset:8 sc0 sc1
L_ge_22:
    s_nop 1
    s_mov_b64 exec, -1
    v_mfma_f32_16x16x32_bf16 v[20:23], a[88:91], v[196:199], v[20:23]
    v_mfma_f32_16x16x32_bf16 v[36:39], a[92:95], v[196:199], v[36:39]
    s_waitcnt vmcnt(10)
    v_mfma_f32_16x16x32_bf16 v[244:247], a[96:99], v[200:203], v[244:247]
    buffer_load_dwordx4 a[16:19], v31, s[44:47], s16 offen
    v_lshlrev_b32 v92, 16, v46
    v_mfma_f32_16x16x32_bf16 v[248:251], a[100:103], v[200:203], v[248:251]
    v_and_b32 v93, s84, v46
    v_lshlrev_b32 v94, 16, v47
    v_mfma_f32_16x16x32_bf16 v[140:143], a[104:107], v[200:203], v[140:143]
    v_and_b32 v95, s84, v47
    v_lshlrev_b32 v96, 16, v48
    v_mfma_f32_16x16x32_bf16 v[20:23], a[108:111], v[200:203], v[20:23]
    v_mfma_f32_16x16x32_bf16 v[36:39], a[112:115], v[200:203], v[36:39]
    s_waitcnt vmcnt(10)
    v_mfma_f32_16x16x32_bf16 v[244:247], a[116:119], v[204:207], v[244:247]
    buffer_load_dwordx4 a[20:23], v32, s[44:47], s17 offen
    v_mfma_f32_16x16x32_bf16 v[248:251], a[120:123], v[204:207], v[248:251]
    v_and_b32 v97, s84, v48
    v_mfma_f32_16x16x32_bf16 v[140:143], a[124:127], v[204:207], v[140:143]
    v_lshlrev_b32 v98, 16, v49
    v_mfma_f32_16x16x32_bf16 v[20:23], a[128:131], v[204:207], v[20:23]
    v_and_b32 v99, s84, v49
    v_mfma_f32_16x16x32_bf16 v[36:39], a[132:135], v[204:207], v[36:39]
    s_waitcnt vmcnt(10)
    v_mfma_f32_16x16x32_bf16 v[244:247], a[136:139], v[208:211], v[244:247]
    v_mfma_f32_16x16x32_bf16 v[248:251], a[140:143], v[208:211], v[248:251]
    v_mfma_f32_16x16x32_bf16 v[140:143], a[144:147], v[208:211], v[140:143]
    v_mfma_f32_16x16x32_bf16 v[20:23], a[148:151], v[208:211], v[20:23]
    v_mfma_f32_16x16x32_bf16 v[36:39], a[152:155], v[208:211], v[36:39]
    s_waitcnt vmcnt(9)
    v_mfma_f32_16x16x32_bf16 v[244:247], a[156:159], v[212:215], v[244:247]
    ds_read_b128 v[40:43], v3 offset:0
    s_waitcnt lgkmcnt(14)
    v_mfma_f32_16x16x32_bf16 v[248:251], a[160:163], v[212:215], v[248:251]
    ds_read_b128 v[44:47], v3 offset:64
    s_waitcnt lgkmcnt(14)
    v_mfma_f32_16x16x32_bf16 v[140:143], a[164:167], v[212:215], v[140:143]
    ds_read_b128 v[48:51], v3 offset:128
    s_waitcnt lgkmcnt(14)
    v_mfma_f32_16x16x32_bf16 v[20:23], a[168:171], v[212:215], v[20:23]
    ds_read_b128 v[52:55], v3 offset:192
    s_waitcnt lgkmcnt(14)
    v_mfma_f32_16x16x32_bf16 v[36:39], a[172:175], v[212:215], v[36:39]
    ds_read_b128 v[56:59], v3 offset:256
    s_waitcnt vmcnt(8) lgkmcnt(14)
    v_mfma_f32_16x16x32_bf16 v[244:247], a[176:179], v[216:219], v[244:247]
    ds_read_b128 v[224:227], v3 offset:1280
    s_waitcnt lgkmcnt(14)
    v_mfma_f32_16x16x32_bf16 v[248:251], a[180:183], v[216:219], v[248:251]
    ds_read_b128 v[228:231], v3 offset:1344
    s_waitcnt lgkmcnt(14)
    v_mfma_f32_16x16x32_bf16 v[140:143], a[184:187], v[216:219], v[140:143]
    ds_read_b128 v[232:235], v3 offset:1408
    s_waitcnt lgkmcnt(14)
    v_mfma_f32_16x16x32_bf16 v[20:23], a[188:191], v[216:219], v[20:23]
    ds_read_b128 v[236:239], v3 offset:1472
    s_waitcnt lgkmcnt(14)
    v_mfma_f32_16x16x32_bf16 v[36:39], a[192:195], v[216:219], v[36:39]
    ds_read_b128 v[240:243], v3 offset:1536
    s_waitcnt vmcnt(7) lgkmcnt(14)
    v_mfma_f32_16x16x32_bf16 v[244:247], a[196:199], v[220:223], v[244:247]
    s_waitcnt lgkmcnt(13)
    v_mfma_f32_16x16x32_bf16 v[248:251], a[200:203], v[220:223], v[248:251]
    s_waitcnt lgkmcnt(12)
    v_mfma_f32_16x16x32_bf16 v[140:143], a[204:207], v[220:223], v[140:143]
    s_waitcnt lgkmcnt(11)
    v_mfma_f32_16x16x32_bf16 v[20:23], a[208:211], v[220:223], v[20:23]
    s_waitcnt lgkmcnt(10)
    v_mfma_f32_16x16x32_bf16 v[36:39], a[212:215], v[220:223], v[36:39]
    s_lshl_b32 s52, s86, 11
    s_add_u32 s52, s52, 0x10000
    s_lshl_b32 s53, s87, 8
    s_add_u32 s53, s53, s52
    s_waitcnt lgkmcnt(9)
    v_pk_fma_f32 v[80:81], v[244:245], v[40:41], v[80:81]
    v_pk_fma_f32 v[82:83], v[246:247], v[42:43], v[82:83]
    s_waitcnt lgkmcnt(8)
    v_pk_fma_f32 v[84:85], v[248:249], v[44:45], v[84:85]
    v_pk_fma_f32 v[86:87], v[250:251], v[46:47], v[86:87]
    s_waitcnt lgkmcnt(7)
    v_pk_fma_f32 v[88:89], v[140:141], v[48:49], v[88:89]
    v_pk_fma_f32 v[90:91], v[142:143], v[50:51], v[90:91]
    s_waitcnt lgkmcnt(6)
    v_pk_fma_f32 v[92:93], v[20:21], v[52:53], v[92:93]
    v_pk_fma_f32 v[94:95], v[22:23], v[54:55], v[94:95]
    s_waitcnt lgkmcnt(5)
    v_pk_fma_f32 v[96:97], v[36:37], v[56:57], v[96:97]
    v_pk_fma_f32 v[98:99], v[38:39], v[58:59], v[98:99]
    v_cvt_pk_bf16_f32 v144, v80, v81
    v_cvt_pk_bf16_f32 v145, v82, v83
    v_cvt_pk_bf16_f32 v146, v84, v85
    v_cvt_pk_bf16_f32 v147, v86, v87
    v_cvt_pk_bf16_f32 v148, v88, v89
    v_cvt_pk_bf16_f32 v149, v90, v91
    v_cvt_pk_bf16_f32 v150, v92, v93
    v_cvt_pk_bf16_f32 v151, v94, v95
    v_cvt_pk_bf16_f32 v152, v96, v97
    v_cvt_pk_bf16_f32 v153, v98, v99
    v_lshlrev_b32 v80, 16, v144
    v_and_b32 v81, s84, v144
    v_lshlrev_b32 v82, 16, v145
    v_and_b32 v83, s84, v145
    v_lshlrev_b32 v84, 16, v146
    v_and_b32 v85, s84, v146
    v_lshlrev_b32 v86, 16, v147
    v_and_b32 v87, s84, v147
    v_lshlrev_b32 v88, 16, v148
    v_and_b32 v89, s84, v148
    v_lshlrev_b32 v90, 16, v149
    v_and_b32 v91, s84, v149
    v_lshlrev_b32 v92, 16, v150
    v_and_b32 v93, s84, v150
    v_lshlrev_b32 v94, 16, v151
    v_and_b32 v95, s84, v151
    v_lshlrev_b32 v96, 16, v152
    v_and_b32 v97, s84, v152
    v_lshlrev_b32 v98, 16, v153
    v_and_b32 v99, s84, v153
    v_pk_add_f32 v[156:157], v[80:81], v[82:83]
    v_pk_mul_f32 v[158:159], v[80:81], v[80:81]
    s_waitcnt lgkmcnt(4)
    v_pk_mul_f32 v[160:161], v[80:81], v[224:225]
    v_pk_fma_f32 v[158:159], v[82:83], v[82:83], v[158:159]
    v_pk_fma_f32 v[160:161], v[82:83], v[226:227], v[160:161]
    v_pk_add_f32 v[156:157], v[156:157], v[84:85]
    v_pk_fma_f32 v[158:159], v[84:85], v[84:85], v[158:159]
    s_waitcnt lgkmcnt(3)
    v_pk_fma_f32 v[160:161], v[84:85], v[228:229], v[160:161]
    v_pk_add_f32 v[156:157], v[156:157], v[86:87]
    v_pk_fma_f32 v[158:159], v[86:87], v[86:87], v[158:159]
    v_pk_fma_f32 v[160:161], v[86:87], v[230:231], v[160:161]
    v_pk_add_f32 v[156:157], v[156:157], v[88:89]
    v_pk_fma_f32 v[158:159], v[88:89], v[88:89], v[158:159]
    s_waitcnt lgkmcnt(2)
    v_pk_fma_f32 v[160:161], v[88:89], v[232:233], v[160:161]
    v_pk_add_f32 v[156:157], v[156:157], v[90:91]
    v_pk_fma_f32 v[158:159], v[90:91], v[90:91], v[158:159]
    v_pk_fma_f32 v[160:161], v[90:91], v[234:235], v[160:161]
    v_pk_add_f32 v[156:157], v[156:157], v[92:93]
    v_pk_fma_f32 v[158:159], v[92:93], v[92:93], v[158:159]
    s_waitcnt lgkmcnt(1)
    v_pk_fma_f32 v[160:161], v[92:93], v[236:237], v[160:161]
    v_pk_add_f32 v[156:157], v[156:157], v[94:95]
    v_pk_fma_f32 v[158:159], v[94:95], v[94:95], v[158:159]
    v_pk_fma_f32 v[160:161], v[94:95], v[238:239], v[160:161]
    v_pk_add_f32 v[156:157], v[156:157], v[96:97]
    v_pk_fma_f32 v[158:159], v[96:97], v[96:97], v[158:159]
    s_waitcnt lgkmcnt(0)
    v_pk_fma_f32 v[160:161], v[96:97], v[240:241], v[160:161]
    v_pk_add_f32 v[156:157], v[156:157], v[98:99]
    v_pk_fma_f32 v[158:159], v[98:99], v[98:99], v[158:159]
    v_pk_fma_f32 v[160:161], v[98:99], v[242:243], v[160:161]
    v_add_f32 v164, v156, v157
    v_add_f32 v165, v158, v159
    v_add_f32 v166, v160, v161
    v_mov_b32 v167, s6
    v_mov_b32 v168, v164
    v_mov_b32 v169, v165
    v_mov_b32 v170, v166
    v_permlane16_swap_b32 v164, v168
    v_permlane16_swap_b32 v165, v169
    v_permlane16_swap_b32 v166, v170
    v_add_f32 v164, v164, v168
    v_add_f32 v165, v165, v169
    v_add_f32 v166, v166, v170
    v_mov_b32 v168, v164
    v_mov_b32 v169, v165
    v_mov_b32 v170, v166
    v_permlane32_swap_b32 v164, v168
    v_permlane32_swap_b32 v165, v169
    v_permlane32_swap_b32 v166, v170
    v_add_f32 v164, v164, v168
    v_add_f32 v165, v165, v169
    v_add_f32 v166, v166, v170
    s_mov_b64 exec, 0xffff
    s_cmp_eq_u32 s88, 0
    s_cbranch_scc1 L_gs_23
    buffer_store_dwordx4 v[164:167], v2, s[24:27], s53 offen
    s_branch L_ge_24
L_gs_23:
    buffer_store_dwordx4 v[164:167], v2, s[24:27], s53 offen sc0 sc1
L_ge_24:
    s_nop 1
    s_mov_b64 exec, -1
    ds_read_b128 v[60:63], v3 offset:320
    ds_read_b128 v[64:67], v3 offset:384
    ds_read_b128 v[68:71], v3 offset:448
    ds_read_b128 v[72:75], v3 offset:512
    ds_read_b128 v[76:79], v3 offset:576
    ds_read_b128 v[100:103], v3 offset:640
    ds_read_b128 v[104:107], v3 offset:704
    ds_read_b128 v[108:111], v3 offset:768
    ds_read_b128 v[112:115], v3 offset:832
    ds_read_b128 v[116:119], v3 offset:896
    ds_read_b128 v[120:123], v3 offset:960
    ds_read_b128 v[124:127], v3 offset:1024
    ds_read_b128 v[128:131], v3 offset:1088
    ds_read_b128 v[132:135], v3 offset:1152
    ds_read_b128 v[136:139], v3 offset:1216
    v_lshlrev_b32 v20, 4, v0
    v_lshrrev_b32 v21, 2, v14
    v_lshl_add_u32 v21, v15, 3, v21
    v_and_b32 v22, 3, v1
    s_lshl_b32 s54, s3, 5
    v_lshl_add_u32 v22, v22, 3, s54
    v_lshl_add_u32 v23, v21, 7, v22
    v_mul_u32_u24 v21, 160, v21
    v_add_u32 v22, v21, v22
    v_subrev_u32 v21, s54, v22
    v_add_u32 v36, 0, v0
    v_mul_u32_u24 v32, 205, v36
    v_lshrrev_b32 v32, 11, v32
    v_mul_u32_u24 v32, 1120, v32
    v_lshl_add_u32 v36, v36, 4, v32
    v_add_u32 v37, 256, v0
    v_mul_u32_u24 v32, 205, v37
    v_lshrrev_b32 v32, 11, v32
    v_mul_u32_u24 v32, 1120, v32
    v_lshl_add_u32 v37, v37, 4, v32
    v_add_u32 v38, 512, v0
    v_min_u32 v38, 639, v38
    v_mul_u32_u24 v32, 205, v38
    v_lshrrev_b32 v32, 11, v32
    v_mul_u32_u24 v32, 1120, v32
    v_lshl_add_u32 v38, v38, 4, v32
    s_lshl_b32 s62, s3, 2
    s_add_u32 s62, s62, 108544
    v_mov_b32 v24, s62
    v_mov_b32 v25, 108544
    s_lshl_b32 s62, s86, 5
    s_add_u32 s62, s62, 0x50000
    v_mov_b32 v173, 0x3727c5ac
    s_movk_i32 s63, 0x7ff
    s_mov_b32 s90, 0
L_poll_25:
    s_nop 1
    buffer_load_dwordx4 v[16:19], v12, s[24:27], s61 offen offset:16 sc1
    buffer_load_dwordx4 v[164:167], v2, s[24:27], s52 offen sc1
    buffer_load_dwordx4 v[168:171], v2, s[24:27], s52 offen offset:1024 sc1
    s_waitcnt vmcnt(0)
    v_cmp_ne_u32 vcc, s6, v17
    v_cmp_ne_u32 s[98:99], s6, v19
    s_nop 0
    s_or_b64 vcc, vcc, s[98:99]
    v_cmp_ne_u32 s[98:99], s6, v167
    s_nop 0
    s_or_b64 vcc, vcc, s[98:99]
    v_cmp_ne_u32 s[98:99], s6, v171
    s_nop 0
    s_or_b64 vcc, vcc, s[98:99]
    s_nop 4
    s_cbranch_vccz L_done_26
    s_add_u32 s90, s90, 1
    s_cmp_lt_u32 s90, 40000
    s_cbranch_scc1 L_poll_25
L_done_26:
    s_nop 1
    v_add_f32_dpp v16, v16, v16 quad_perm:[1,0,3,2] row_mask:0xf bank_mask:0xf
    v_add_f32_dpp v18, v18, v18 quad_perm:[1,0,3,2] row_mask:0xf bank_mask:0xf
    s_nop 0
    v_add_f32_dpp v16, v16, v16 quad_perm:[2,3,0,1] row_mask:0xf bank_mask:0xf
    v_add_f32_dpp v18, v18, v18 quad_perm:[2,3,0,1] row_mask:0xf bank_mask:0xf
    s_nop 0
    v_add_f32_dpp v16, v16, v16 row_ror:4 row_mask:0xf bank_mask:0xf
    v_add_f32_dpp v18, v18, v18 row_ror:4 row_mask:0xf bank_mask:0xf
    buffer_load_dwordx4 a[24:27], v36, s[32:35], s89 offen
    buffer_load_dwordx4 a[28:31], v37, s[32:35], s89 offen
    buffer_load_dwordx4 a[32:35], v38, s[32:35], s89 offen
    v_add_f32 v164, v164, v168
    v_add_f32 v165, v165, v169
    v_add_f32 v166, v166, v170
    v_mov_b32 v168, v164
    v_mov_b32 v169, v165
    v_mov_b32 v170, v166
    v_permlane16_swap_b32 v164, v168
    v_permlane16_swap_b32 v165, v169
    v_permlane16_swap_b32 v166, v170
    v_add_f32 v164, v164, v168
    v_add_f32 v165, v165, v169
    v_add_f32 v166, v166, v170
    v_mov_b32 v168, v164
    v_mov_b32 v169, v165
    v_mov_b32 v170, v166
    v_permlane32_swap_b32 v164, v168
    v_permlane32_swap_b32 v165, v169
    v_permlane32_swap_b32 v166, v170
    v_add_f32 v164, v164, v168
    v_add_f32 v165, v165, v169
    v_add_f32 v166, v166, v170
    v_mul_f32 v168, 0x3acccccd, v164
    v_fmac_f32 v173, 0x3acccccd, v165
    v_fma_f32 v169, -v168, v168, v173
    v_max_f32 v169, 0x3727c5ac, v169
    v_rsq_f32 v170, v169
    v_fma_f32 v171, -v168, v18, v166
    v_fma_f32 v171, v171, v170, v16
    v_ashrrev_i32 v172, 31, v171
    v_or_b32 v172, 0x80000000, v172
    v_xor_b32 v172, v172, v171
    v_bfi_b32 v172, s63, v35, v172
    v_mov_b32 v174, v172
    s_nop 1
    v_max_u32_dpp v174, v174, v174 quad_perm:[1,0,3,2] row_mask:0xf bank_mask:0xf
    s_nop 1
    v_max_u32_dpp v174, v174, v174 quad_perm:[2,3,0,1] row_mask:0xf bank_mask:0xf
    s_nop 1
    v_max_u32_dpp v174, v174, v174 row_ror:4 row_mask:0xf bank_mask:0xf
    s_nop 1
    v_max_u32_dpp v174, v174, v174 row_ror:8 row_mask:0xf bank_mask:0xf
    s_cmp_lg_u32 s87, 0
    s_cbranch_scc1 L_skip_27
    ds_write_b32 v24, v174
    s_waitcnt lgkmcnt(0)
    s_barrier
    s_cmp_lg_u32 s3, 0
    s_cbranch_scc1 L_skip_28
    ds_read_b128 v[6:9], v25
    s_mov_b64 exec, 1
    s_waitcnt lgkmcnt(0)
    v_max3_u32 v6, v6, v7, v8
    v_mov_b32 v7, s6
    v_max_u32 v6, v6, v9
    buffer_store_dwordx2 v[6:7], off, s[24:27], s62 sc0 sc1
    s_mov_b64 exec, -1
L_skip_28:
    s_nop 1
L_skip_27:
    s_nop 1
    v_cmp_eq_u32 s[56:57], v172, v174
    v_mul_f32 v172, v168, v170
    v_sub_f32 v172, 0, v172
    v_pk_fma_f32 v[176:177], v[80:81], v[170:171], v[172:173] op_sel_hi:[1,0,0]
    v_pk_fma_f32 v[178:179], v[82:83], v[170:171], v[172:173] op_sel_hi:[1,0,0]
    v_pk_fma_f32 v[180:181], v[84:85], v[170:171], v[172:173] op_sel_hi:[1,0,0]
    v_pk_fma_f32 v[182:183], v[86:87], v[170:171], v[172:173] op_sel_hi:[1,0,0]
    v_pk_fma_f32 v[184:185], v[88:89], v[170:171], v[172:173] op_sel_hi:[1,0,0]
    v_pk_fma_f32 v[186:187], v[90:91], v[170:171], v[172:173] op_sel_hi:[1,0,0]
    v_pk_fma_f32 v[188:189], v[92:93], v[170:171], v[172:173] op_sel_hi:[1,0,0]
    v_pk_fma_f32 v[190:191], v[94:95], v[170:171], v[172:173] op_sel_hi:[1,0,0]
    v_pk_fma_f32 v[192:193], v[96:97], v[170:171], v[172:173] op_sel_hi:[1,0,0]
    v_pk_fma_f32 v[194:195], v[98:99], v[170:171], v[172:173] op_sel_hi:[1,0,0]
    s_waitcnt lgkmcnt(9)
    v_pk_fma_f32 v[176:177], v[176:177], v[100:101], v[60:61]
    v_pk_fma_f32 v[178:179], v[178:179], v[102:103], v[62:63]
    s_waitcnt lgkmcnt(8)
    v_pk_fma_f32 v[180:181], v[180:181], v[104:105], v[64:65]
    v_pk_fma_f32 v[182:183], v[182:183], v[106:107], v[66:67]
    s_waitcnt lgkmcnt(7)
    v_pk_fma_f32 v[184:185], v[184:185], v[108:109], v[68:69]
    v_pk_fma_f32 v[186:187], v[186:187], v[110:111], v[70:71]
    s_waitcnt lgkmcnt(6)
    v_pk_fma_f32 v[188:189], v[188:189], v[112:113], v[72:73]
    v_pk_fma_f32 v[190:191], v[190:191], v[114:115], v[74:75]
    s_waitcnt lgkmcnt(5)
    v_pk_fma_f32 v[192:193], v[192:193], v[116:117], v[76:77]
    v_pk_fma_f32 v[194:195], v[194:195], v[118:119], v[78:79]
    v_cvt_pk_bf16_f32 v196, v176, v177
    v_cvt_pk_bf16_f32 v197, v178, v179
    v_cvt_pk_bf16_f32 v198, v180, v181
    v_cvt_pk_bf16_f32 v199, v182, v183
    v_cvt_pk_bf16_f32 v200, v184, v185
    v_cvt_pk_bf16_f32 v201, v186, v187
    v_cvt_pk_bf16_f32 v202, v188, v189
    v_cvt_pk_bf16_f32 v203, v190, v191
    v_cvt_pk_bf16_f32 v204, v192, v193
    v_cvt_pk_bf16_f32 v205, v194, v195
    v_min_u32 v196, -2, v196
    v_min_u32 v197, -2, v197
    v_min_u32 v198, -2, v198
    v_min_u32 v199, -2, v199
    v_min_u32 v200, -2, v200
    v_min_u32 v201, -2, v201
    v_min_u32 v202, -2, v202
    v_min_u32 v203, -2, v203
    v_min_u32 v204, -2, v204
    v_min_u32 v205, -2, v205
    v_lshlrev_b32 v3, 3, v15
    s_mov_b64 exec, s[56:57]
    buffer_store_dwordx2 v[196:197], v3, s[24:27], s92 offen offset:0 sc0 sc1
    buffer_store_dwordx2 v[198:199], v3, s[24:27], s92 offen offset:32 sc0 sc1
    buffer_store_dwordx2 v[200:201], v3, s[24:27], s92 offen offset:64 sc0 sc1
    buffer_store_dwordx2 v[202:203], v3, s[24:27], s92 offen offset:96 sc0 sc1
    buffer_store_dwordx2 v[204:205], v3, s[24:27], s92 offen offset:128 sc0 sc1
    s_mov_b64 exec, -1
    v_min_u32 v144, -2, v144
    v_min_u32 v145, -2, v145
    v_min_u32 v146, -2, v146
    v_min_u32 v147, -2, v147
    v_min_u32 v148, -2, v148
    v_min_u32 v149, -2, v149
    v_min_u32 v150, -2, v150
    v_min_u32 v151, -2, v151
    v_min_u32 v152, -2, v152
    v_min_u32 v153, -2, v153
    s_add_u32 s54, s92, 0x30000
    s_mov_b64 exec, s[56:57]
    buffer_store_dwordx2 v[144:145], v3, s[24:27], s54 offen offset:0 sc0 sc1
    buffer_store_dwordx2 v[146:147], v3, s[24:27], s54 offen offset:32 sc0 sc1
    buffer_store_dwordx2 v[148:149], v3, s[24:27], s54 offen offset:64 sc0 sc1
    buffer_store_dwordx2 v[150:151], v3, s[24:27], s54 offen offset:96 sc0 sc1
    buffer_store_dwordx2 v[152:153], v3, s[24:27], s54 offen offset:128 sc0 sc1
    s_mov_b64 exec, -1
    s_mov_b32 s52, 0x50000
    v_lshlrev_b32 v4, 7, v11
    v_lshlrev_b32 v176, 16, v196
    v_and_b32 v177, s84, v196
    v_lshlrev_b32 v178, 16, v197
    v_and_b32 v179, s84, v197
    v_lshlrev_b32 v180, 16, v198
    v_and_b32 v181, s84, v198
    v_lshlrev_b32 v182, 16, v199
    v_and_b32 v183, s84, v199
    v_lshlrev_b32 v184, 16, v200
    v_and_b32 v185, s84, v200
    v_lshlrev_b32 v186, 16, v201
    v_and_b32 v187, s84, v201
    v_lshlrev_b32 v188, 16, v202
    v_and_b32 v189, s84, v202
    v_lshlrev_b32 v190, 16, v203
    v_and_b32 v191, s84, v203
    v_lshlrev_b32 v192, 16, v204
    v_and_b32 v193, s84, v204
    v_lshlrev_b32 v194, 16, v205
    v_and_b32 v195, s84, v205
    s_waitcnt lgkmcnt(4)
    v_pk_fma_f32 v[176:177], v[176:177], v[120:121], v[80:81]
    v_pk_fma_f32 v[178:179], v[178:179], v[122:123], v[82:83]
    s_waitcnt lgkmcnt(3)
    v_pk_fma_f32 v[180:181], v[180:181], v[124:125], v[84:85]
    v_pk_fma_f32 v[182:183], v[182:183], v[126:127], v[86:87]
    s_waitcnt lgkmcnt(2)
    v_pk_fma_f32 v[184:185], v[184:185], v[128:129], v[88:89]
    v_pk_fma_f32 v[186:187], v[186:187], v[130:131], v[90:91]
    s_waitcnt lgkmcnt(1)
    v_pk_fma_f32 v[188:189], v[188:189], v[132:133], v[92:93]
    v_pk_fma_f32 v[190:191], v[190:191], v[134:135], v[94:95]
    s_waitcnt lgkmcnt(0)
    v_pk_fma_f32 v[192:193], v[192:193], v[136:137], v[96:97]
    v_pk_fma_f32 v[194:195], v[194:195], v[138:139], v[98:99]
    v_cvt_pk_bf16_f32 v206, v176, v177
    v_cvt_pk_bf16_f32 v207, v178, v179
    v_cvt_pk_bf16_f32 v208, v180, v181
    v_cvt_pk_bf16_f32 v209, v182, v183
    v_cvt_pk_bf16_f32 v210, v184, v185
    v_cvt_pk_bf16_f32 v211, v186, v187
    v_cvt_pk_bf16_f32 v212, v188, v189
    v_cvt_pk_bf16_f32 v213, v190, v191
    v_cvt_pk_bf16_f32 v214, v192, v193
    v_cvt_pk_bf16_f32 v215, v194, v195
    v_lshlrev_b32 v5, 4, v15
    v_min_u32 v6, 16, v5
    s_mov_b32 s58, s94
    s_mov_b32 s59, s95
    s_mul_i32 s63, s58, 160
    s_add_u32 s63, s63, 0x60000
    s_lshl_b32 s64, s59, 13
    s_add_u32 s64, s64, 0x680000
    s_lshl_b32 s65, s58, 10
    s_lshl_b32 s66, s3, 8
    s_add_u32 s65, s65, s66
    s_add_u32 s65, s65, s64
    s_lshl_b32 s66, s3, 11
    s_add_u32 s64, s64, s66
    v_mov_b32 v58, s6
    v_mov_b32 v59, s6
    ds_write_b128 v20, a[0:3] offset:0
    ds_write_b128 v20, a[4:7] offset:4096
    ds_write_b128 v20, a[8:11] offset:8192
    ds_write_b128 v20, a[12:15] offset:12288
    ds_write_b128 v20, a[16:19] offset:16384
    ds_write_b128 v20, a[20:23] offset:20480
    s_waitcnt lgkmcnt(0)
    s_barrier
    ds_read_b64_tr_b16 a[56:57], v23 offset:0
    ds_read_b64_tr_b16 a[58:59], v23 offset:512
    ds_read_b64_tr_b16 a[60:61], v23 offset:4096
    ds_read_b64_tr_b16 a[62:63], v23 offset:4608
    ds_read_b64_tr_b16 a[64:65], v23 offset:8192
    ds_read_b64_tr_b16 a[66:67], v23 offset:8704
    ds_read_b64_tr_b16 a[68:69], v23 offset:12288
    ds_read_b64_tr_b16 a[70:71], v23 offset:12800
    ds_read_b64_tr_b16 a[72:73], v23 offset:16384
    ds_read_b64_tr_b16 a[74:75], v23 offset:16896
    ds_read_b64_tr_b16 a[76:77], v23 offset:20480
    ds_read_b64_tr_b16 a[78:79], v23 offset:20992
    s_mov_b32 s90, 0
L_poll_29:
    s_nop 1
    buffer_load_dwordx2 v[40:41], v4, s[24:27], s52 offen sc1
    s_waitcnt vmcnt(0)
    v_cmp_ne_u32 vcc, s6, v41
    s_nop 4
    s_cbranch_vccz L_done_30
    s_add_u32 s90, s90, 1
    s_cmp_lt_u32 s90, 40000
    s_cbranch_scc1 L_poll_29
L_done_30:
    s_nop 1
    v_max_u32_dpp v40, v40, v40 quad_perm:[1,0,3,2] row_mask:0xf bank_mask:0xf
    s_nop 1
    v_max_u32_dpp v40, v40, v40 quad_perm:[2,3,0,1] row_mask:0xf bank_mask:0xf
    s_nop 1
    v_max_u32_dpp v40, v40, v40 row_ror:4 row_mask:0xf bank_mask:0xf
    s_nop 1
    v_max_u32_dpp v40, v40, v40 row_ror:8 row_mask:0xf bank_mask:0xf
    v_mov_b32 v41, v40
    s_nop 1
    v_permlane16_swap_b32 v40, v41
    v_max_u32 v40, v40, v41
    s_nop 0
    v_readfirstlane_b32 s60, v40
    s_nop 0
    s_and_b32 s61, s60, 0x7ff
    s_lshr_b32 s62, s61, 5
    s_lshl_b32 s62, s62, 1
    s_and_b32 s55, s61, 1
    s_add_u32 s62, s62, s55
    s_mul_i32 s62, s62, 1280
    s_cmp_ge_u32 s93, 216
    s_cbranch_scc1 L_F_31
    s_add_u32 s63, s63, s62
    s_mov_b32 s90, 0
L_poll_33:
    s_nop 1
    buffer_load_dwordx4 v[44:47], v5, s[24:27], s63 offen sc1
    buffer_load_dwordx4 v[48:51], v5, s[24:27], s63 offen offset:64 sc1
    buffer_load_dwordx4 v[52:55], v6, s[24:27], s63 offen offset:128 sc1
    s_waitcnt vmcnt(0)
    v_max3_u32 v9, v44, v45, v46
    v_max3_u32 v9, v9, v47, v48
    v_max3_u32 v9, v9, v49, v50
    v_max3_u32 v9, v9, v51, v52
    v_max3_u32 v9, v9, v53, v54
    v_max_u32 v9, v9, v55
    v_cmp_eq_u32 vcc, -1, v9
    s_nop 4
    s_cbranch_vccz L_done_34
    s_add_u32 s90, s90, 1
    s_cmp_lt_u32 s90, 40000
    s_cbranch_scc1 L_poll_33
L_done_34:
    s_nop 1
    s_waitcnt lgkmcnt(10)
    v_mfma_f32_16x16x32_bf16 v[60:63], v[44:47], a[56:59], 0
    s_waitcnt lgkmcnt(4)
    v_mfma_f32_16x16x32_bf16 v[64:67], v[44:47], a[68:71], 0
    v_mfma_f32_16x16x32_bf16 v[60:63], v[48:51], a[60:63], v[60:63]
    s_waitcnt lgkmcnt(2)
    v_mfma_f32_16x16x32_bf16 v[64:67], v[48:51], a[72:75], v[64:67]
    v_mfma_f32_16x16x32_bf16 v[60:63], v[52:55], a[64:67], v[60:63]
    s_waitcnt lgkmcnt(0)
    v_mfma_f32_16x16x32_bf16 v[64:67], v[52:55], a[76:79], v[64:67]
    s_lshl_b32 s54, s3, 9
    s_add_u32 s54, s54, 109568
    v_lshl_add_u32 v7, v1, 3, s54
    v_lshlrev_b32 v8, 3, v1
    v_add_u32 v8, 109568, v8
    s_lshl_b32 s54, s3, 7
    s_add_u32 s54, s54, 111616
    v_mov_b32 v56, v60
    v_mov_b32 v57, v64
    s_mov_b64 exec, 0xffff
    s_cmp_eq_u32 s88, 0
    s_cbranch_scc1 L_gs_35
    buffer_store_dwordx4 v[56:59], v2, s[24:27], s65 offen
    s_branch L_ge_36
L_gs_35:
    buffer_store_dwordx4 v[56:59], v2, s[24:27], s65 offen sc0 sc1
L_ge_36:
    s_nop 1
    s_mov_b64 exec, -1
    ds_write_b128 v20, a[24:27] offset:24576
    ds_write_b128 v20, a[28:31] offset:28672
    ds_write_b128 v20, a[32:35] offset:32768
    s_waitcnt lgkmcnt(0)
    s_barrier
    ds_read_b64_tr_b16 a[80:81], v22 offset:24576
    ds_read_b64_tr_b16 a[82:83], v22 offset:25216
    ds_read_b64_tr_b16 a[84:85], v22 offset:29696
    ds_read_b64_tr_b16 a[86:87], v22 offset:30336
    ds_read_b64_tr_b16 a[88:89], v21 offset:24704
    ds_read_b64_tr_b16 a[90:91], v21 offset:25344
    ds_read_b64_tr_b16 a[92:93], v21 offset:29824
    ds_read_b64_tr_b16 a[94:95], v21 offset:30464
    v_lshl_add_u32 v12, v1, 1, s54
    v_add_u32 v13, s54, v5
    s_mul_i32 s66, s58, 20480
    s_lshl_b32 s67, s59, 7
    s_add_u32 s66, s66, s67
    s_add_u32 s66, s66, 0x6c0000
    s_lshl_b32 s67, s3, 12
    s_add_u32 s67, s67, s66
    s_add_u32 s66, s66, 16384
    v_lshlrev_b32 v3, 3, v14
    s_mov_b32 s90, 0
L_poll_37:
    s_nop 1
    buffer_load_dwordx4 v[44:47], v2, s[24:27], s64 offen sc1
    buffer_load_dwordx4 v[48:51], v2, s[24:27], s64 offen offset:1024 sc1
    s_waitcnt vmcnt(0)
    v_cmp_ne_u32 vcc, s6, v46
    v_cmp_ne_u32 s[98:99], s6, v50
    s_nop 0
    s_or_b64 vcc, vcc, s[98:99]
    s_nop 4
    s_cbranch_vccz L_done_38
    s_add_u32 s90, s90, 1
    s_cmp_lt_u32 s90, 40000
    s_cbranch_scc1 L_poll_37
L_done_38:
    s_nop 1
    v_pk_add_f32 v[44:45], v[44:45], v[48:49]
    ds_write_b64 v7, v[44:45]
    s_waitcnt lgkmcnt(0)
    s_barrier
    ds_read_b64 v[44:45], v8 offset:0
    ds_read_b64 v[46:47], v8 offset:512
    ds_read_b64 v[48:49], v8 offset:1024
    ds_read_b64 v[50:51], v8 offset:1536
    s_waitcnt lgkmcnt(2)
    v_pk_add_f32 v[44:45], v[44:45], v[46:47]
    s_waitcnt lgkmcnt(0)
    v_pk_add_f32 v[48:49], v[48:49], v[50:51]
    v_pk_add_f32 v[44:45], v[44:45], v[48:49]
    v_cvt_pk_bf16_f32 v44, v44, v45
    v_lshlrev_b32 v46, 16, v44
    v_and_b32 v47, s84, v44
    v_mul_f32 v48, 0xbfb8aa3b, v46
    v_exp_f32 v48, v48
    s_nop 0
    v_add_f32 v48, 1.0, v48
    v_rcp_f32 v48, v48
    s_nop 0
    v_mul_f32 v48, v48, v46
    v_cvt_pk_bf16_f32 v48, v48, v48
    v_lshlrev_b32 v48, 16, v48
    v_mul_f32 v48, v48, v47
    v_cvt_pk_bf16_f32 v48, v48, v48
    ds_write_b16 v12, v48
    ds_read_b128 v[44:47], v13
    ds_read_b128 v[48:51], v13 offset:64
    s_waitcnt lgkmcnt(1)
    v_mfma_f32_16x16x32_bf16 v[60:63], v[44:47], a[80:83], 0
    v_mfma_f32_16x16x32_bf16 v[64:67], v[44:47], a[88:91], 0
    s_waitcnt lgkmcnt(0)
    v_mfma_f32_16x16x32_bf16 v[60:63], v[48:51], a[84:87], v[60:63]
    v_mfma_f32_16x16x32_bf16 v[64:67], v[48:51], a[92:95], v[64:67]
    s_nop 6
    v_mov_b32 v61, s6
    v_mov_b32 v65, s6
    s_mov_b64 exec, 0xffff
    buffer_store_dwordx2 v[60:61], v3, s[24:27], s67 offen sc0 sc1
    s_cmp_lg_u32 s3, 0
    s_cbranch_scc1 L_skip_39
    buffer_store_dwordx2 v[64:65], v3, s[24:27], s66 offen sc0 sc1
    s_cmp_lg_u32 s93, 0
    s_cbranch_scc1 L_skip_40
    s_mov_b64 exec, 1
    buffer_store_dword v61, off, s[24:27], 0 sc0 sc1
L_skip_40:
    s_nop 1
L_skip_39:
    s_nop 1
    s_mov_b64 exec, -1
    v_cmp_ne_u32 vcc, s61, v35
    s_nop 0
    s_mov_b64 exec, vcc
    s_cbranch_execz L_no_41
    buffer_store_dwordx2 v[206:207], v30, s[28:31], 0 offen offset:0
    buffer_store_dwordx2 v[208:209], v30, s[28:31], 0 offen offset:32
    buffer_store_dwordx2 v[210:211], v30, s[28:31], 0 offen offset:64
    buffer_store_dwordx2 v[212:213], v30, s[28:31], 0 offen offset:96
    buffer_store_dwordx2 v[214:215], v30, s[28:31], 0 offen offset:128
L_no_41:
    s_mov_b64 exec, -1
    s_branch L_fin_32
L_F_31:
    s_nop 0
    v_cmp_ne_u32 vcc, s61, v35
    s_nop 0
    s_mov_b64 exec, vcc
    s_cbranch_execz L_no_42
    buffer_store_dwordx2 v[206:207], v30, s[28:31], 0 offen offset:0
    buffer_store_dwordx2 v[208:209], v30, s[28:31], 0 offen offset:32
    buffer_store_dwordx2 v[210:211], v30, s[28:31], 0 offen offset:64
    buffer_store_dwordx2 v[212:213], v30, s[28:31], 0 offen offset:96
    buffer_store_dwordx2 v[214:215], v30, s[28:31], 0 offen offset:128
L_no_42:
    s_mov_b64 exec, -1
    s_cmp_lg_u32 s3, 0
    s_cbranch_scc1 L_fin_32
    s_sub_u32 s58, s93, 216
    v_and_b32 v4, 7, v1
    s_lshl_b32 s54, s58, 5
    v_lshl_add_u32 v5, v4, 2, s54
    s_add_u32 s62, s62, 0x60000
    s_add_u32 s63, s62, 0x30000
    s_lshl_b32 s55, s58, 4
    s_add_u32 s55, s55, 3200
    v_lshl_add_u32 v6, v4, 1, s55
    v_lshrrev_b32 v7, 6, v6
    v_and_b32 v6, 63, v6
    v_lshlrev_b32 v6, 3, v6
    v_lshl_add_u32 v6, v7, 11, v6
    s_mov_b32 s90, 0
L_poll_43:
    s_nop 1
    buffer_load_dword v100, v5, s[24:27], s62 offen sc1
    buffer_load_dword v101, v5, s[24:27], s63 offen sc1
    buffer_load_dwordx4 v[104:107], v6, s[24:27], s70 offen offset:0 sc1
    buffer_load_dwordx4 v[108:111], v6, s[24:27], s70 offen offset:512 sc1
    buffer_load_dwordx4 v[112:115], v6, s[24:27], s70 offen offset:1024 sc1
    buffer_load_dwordx4 v[116:119], v6, s[24:27], s70 offen offset:1536 sc1
    s_waitcnt vmcnt(0)
    v_max_u32 v9, v100, v101
    v_cmp_eq_u32 vcc, -1, v9
    v_cmp_ne_u32 s[98:99], s6, v105
    s_nop 0
    s_or_b64 vcc, vcc, s[98:99]
    v_cmp_ne_u32 s[98:99], s6, v107
    s_nop 0
    s_or_b64 vcc, vcc, s[98:99]
    v_cmp_ne_u32 s[98:99], s6, v109
    s_nop 0
    s_or_b64 vcc, vcc, s[98:99]
    v_cmp_ne_u32 s[98:99], s6, v111
    s_nop 0
    s_or_b64 vcc, vcc, s[98:99]
    v_cmp_ne_u32 s[98:99], s6, v113
    s_nop 0
    s_or_b64 vcc, vcc, s[98:99]
    v_cmp_ne_u32 s[98:99], s6, v115
    s_nop 0
    s_or_b64 vcc, vcc, s[98:99]
    v_cmp_ne_u32 s[98:99], s6, v117
    s_nop 0
    s_or_b64 vcc, vcc, s[98:99]
    v_cmp_ne_u32 s[98:99], s6, v119
    s_nop 0
    s_or_b64 vcc, vcc, s[98:99]
    s_nop 4
    s_cbranch_vccz L_done_44
    s_add_u32 s90, s90, 1
    s_cmp_lt_u32 s90, 40000
    s_cbranch_scc1 L_poll_43
L_done_44:
    s_nop 1
    v_add_f32 v104, v104, v108
    v_add_f32 v112, v112, v116
    v_add_f32 v106, v106, v110
    v_add_f32 v114, v114, v118
    v_add_f32 v104, v104, v112
    v_add_f32 v106, v106, v114
    v_cvt_pk_bf16_f32 v102, v104, v106
    v_lshlrev_b32 v104, 16, v100
    v_and_b32 v105, s84, v100
    v_lshlrev_b32 v106, 16, v101
    v_and_b32 v107, s84, v101
    v_lshlrev_b32 v108, 16, v102
    v_and_b32 v109, s84, v102
    s_andn2_b32 s64, s60, 0x7ff
    s_ashr_i32 s65, s64, 31
    s_not_b32 s65, s65
    s_or_b32 s65, s65, 0x80000000
    s_xor_b32 s64, s64, s65
    v_mov_b32 v110, s64
    v_cvt_pk_bf16_f32 v110, v110, v110
    v_lshlrev_b32 v110, 16, v110
    v_mul_f32 v110, 0xbfb8aa3b, v110
    v_exp_f32 v110, v110
    s_nop 0
    v_add_f32 v110, 1.0, v110
    v_rcp_f32 v110, v110
    s_nop 0
    v_cvt_pk_bf16_f32 v110, v110, v110
    v_lshlrev_b32 v110, 16, v110
    s_lshl_b32 s55, s58, 12
    s_add_u32 s55, s55, 0x6c0000
    v_min_u32 v7, 368, v2
    v_cmp_gt_u32 s[56:57], 24, v1
    s_mul_i32 s61, s61, 1280
    s_mov_b32 s90, 0
L_poll_45:
    s_nop 1
    buffer_load_dwordx4 v[44:47], v2, s[24:27], s55 offen offset:0 sc1
    buffer_load_dwordx4 v[48:51], v2, s[24:27], s55 offen offset:1024 sc1
    buffer_load_dwordx4 v[52:55], v2, s[24:27], s55 offen offset:2048 sc1
    buffer_load_dwordx4 v[56:59], v7, s[24:27], s55 offen offset:3072 sc1
    s_waitcnt vmcnt(0)
    v_cmp_ne_u32 vcc, s6, v45
    v_cmp_ne_u32 s[98:99], s6, v47
    s_nop 0
    s_or_b64 vcc, vcc, s[98:99]
    v_cmp_ne_u32 s[98:99], s6, v49
    s_nop 0
    s_or_b64 vcc, vcc, s[98:99]
    v_cmp_ne_u32 s[98:99], s6, v51
    s_nop 0
    s_or_b64 vcc, vcc, s[98:99]
    v_cmp_ne_u32 s[98:99], s6, v53
    s_nop 0
    s_or_b64 vcc, vcc, s[98:99]
    v_cmp_ne_u32 s[98:99], s6, v55
    s_nop 0
    s_or_b64 vcc, vcc, s[98:99]
    v_cmp_ne_u32 s[98:99], s6, v57
    s_nop 0
    s_or_b64 vcc, vcc, s[98:99]
    v_cmp_ne_u32 s[98:99], s6, v59
    s_nop 0
    s_or_b64 vcc, vcc, s[98:99]
    s_nop 4
    s_cbranch_vccz L_done_46
    s_add_u32 s90, s90, 1
    s_cmp_lt_u32 s90, 40000
    s_cbranch_scc1 L_poll_45
L_done_46:
    s_nop 1
    v_cndmask_b32 v56, 0, v56, s[56:57]
    v_cndmask_b32 v58, 0, v58, s[56:57]
    v_add_f32 v44, v44, v48
    v_add_f32 v52, v52, v56
    v_add_f32 v46, v46, v50
    v_add_f32 v54, v54, v58
    v_add_f32 v44, v44, v52
    v_add_f32 v45, v46, v54
    s_nop 0
    v_add_f32_dpp v44, v44, v44 row_ror:8 row_mask:0xf bank_mask:0xf
    v_add_f32_dpp v45, v45, v45 row_ror:8 row_mask:0xf bank_mask:0xf
    v_mov_b32 v46, v44
    v_mov_b32 v47, v45
    s_nop 0
    v_permlane16_swap_b32 v44, v46
    v_permlane16_swap_b32 v45, v47
    v_add_f32 v44, v44, v46
    v_add_f32 v45, v45, v47
    v_mov_b32 v46, v44
    v_mov_b32 v47, v45
    s_nop 0
    v_permlane32_swap_b32 v44, v46
    v_permlane32_swap_b32 v45, v47
    v_add_f32 v44, v44, v46
    v_add_f32 v45, v45, v47
    v_cvt_pk_bf16_f32 v46, v44, v45
    v_lshlrev_b32 v44, 16, v46
    v_and_b32 v45, s84, v46
    v_pk_mul_f32 v[44:45], v[44:45], v[110:111] op_sel_hi:[1,0]
    v_cvt_pk_bf16_f32 v46, v44, v45
    v_lshlrev_b32 v44, 16, v46
    v_and_b32 v45, s84, v46
    v_pk_add_f32 v[44:45], v[44:45], v[104:105]
    v_cvt_pk_bf16_f32 v46, v44, v45
    v_lshlrev_b32 v44, 16, v46
    v_and_b32 v45, s84, v46
    v_pk_mul_f32 v[44:45], v[44:45], v[108:109]
    v_cvt_pk_bf16_f32 v46, v44, v45
    v_lshlrev_b32 v44, 16, v46
    v_and_b32 v45, s84, v46
    v_pk_add_f32 v[44:45], v[44:45], v[106:107]
    v_cvt_pk_bf16_f32 v46, v44, v45
    s_mov_b64 exec, 0xff
    buffer_store_dword v46, v5, s[28:31], s61 offen
L_fin_32:
    s_nop 0
    s_endpgm
L_exit:
    s_endpgm
L_code_end:
.section .rodata,"a"
.p2align 6
.amdhsa_kernel adaLN_cond__sliding_local_dilated__moe_arch_mod__prompt_kernel
  .amdhsa_next_free_vgpr 512
  .amdhsa_next_free_sgpr 102
  .amdhsa_accum_offset 256
  .amdhsa_group_segment_fixed_size 0
  .amdhsa_kernarg_size 104
  .amdhsa_user_sgpr_count 2
  .amdhsa_user_sgpr_kernarg_segment_ptr 1
  .amdhsa_system_sgpr_workgroup_id_x 1
.end_amdhsa_kernel
```

```asm
; @launch grid=(256,1,1) block=(256,1,1) lds=163840
.amdgcn_target "amdgcn-amd-amdhsa--gfx950"
.text
.globl adaLN_cond__sliding_local_dilated__moe_arch_mod__prompt_kernel
.p2align 8
.type adaLN_cond__sliding_local_dilated__moe_arch_mod__prompt_kernel,@function
adaLN_cond__sliding_local_dilated__moe_arch_mod__prompt_kernel:
    s_cmp_ge_u32 s2, 256
    s_cbranch_scc1 L_exit
    s_load_dwordx8 s[64:71], s[0:1], 64
    s_load_dwordx2 s[72:73], s[0:1], 96
    s_load_dwordx16 s[48:63], s[0:1], 0
    s_getpc_b64 s[74:75]
L_pc:
    s_and_b32 s94, s2, 7
    s_lshr_b32 s95, s2, 3
    s_sub_u32 s96, s95, 24
    s_lshl_b32 s96, s96, 13
    v_lshl_add_u32 v2, v0, 7, s96
    v_cmp_gt_u32 vcc, 64, v0
    s_mov_b32 s97, L_code_end-L_pc-4
    v_cmp_gt_u32 s[98:99], s97, v2
    v_lshrrev_b32 v3, 6, v0
    s_and_b64 exec, vcc, s[98:99]
    s_cbranch_execz L_nopf
    global_load_dword v253, v2, s[74:75]
L_nopf:
    s_mov_b64 exec, -1
    v_readfirstlane_b32 s3, v3
    s_and_b32 s96, s94, 3
    s_mov_b32 s85, s2
    v_lshrrev_b32 v6, 3, v0
    v_and_b32 v7, 7, v0
    v_mul_u32_u24 v40, 7680, v6
    v_lshl_add_u32 v40, v7, 4, v40
    v_lshlrev_b32 v44, 1, v0
    s_lshr_b32 s97, s85, 2
    s_min_u32 s97, s97, 59
    s_lshl_b32 s82, s97, 7
    s_mul_i32 s83, s96, 320
    s_mul_i32 s96, s96, 1228800
    s_add_u32 s82, s82, s96
    s_lshl_b32 s78, s3, 10
    s_add_u32 m0, s78, 110592
    s_mov_b32 s22, 0x4b0000
    s_mov_b32 s23, 0x20000
    s_mov_b32 s34, 0x500
    s_mov_b32 s35, 0x20000
    s_waitcnt lgkmcnt(0)
    s_mov_b64 s[32:33], s[64:65]
    s_mov_b64 s[20:21], s[66:67]
    buffer_load_ushort v60, v44, s[32:35], s83 offen
    buffer_load_dwordx4 v40, s[20:23], s82 offen lds
    s_add_u32 m0, m0, 4096
    s_add_u32 s82, s82, 245760
    buffer_load_dwordx4 v40, s[20:23], s82 offen lds
    s_add_u32 m0, m0, 4096
    s_add_u32 s82, s82, 245760
    buffer_load_dwordx4 v40, s[20:23], s82 offen lds
    s_add_u32 m0, m0, 4096
    s_add_u32 s82, s82, 245760
    buffer_load_dwordx4 v40, s[20:23], s82 offen lds
    s_add_u32 m0, m0, 4096
    s_add_u32 s82, s82, 245760
    buffer_load_dwordx4 v40, s[20:23], s82 offen lds
    s_load_dword s6, s[72:73], 0
    v_and_b32 v1, 63, v0
    s_lshr_b32 s96, s94, 0
    s_lshl_b32 s4, s96, 1
    s_lshr_b32 s96, s95, 4
    s_add_u32 s4, s4, s96
    s_and_b32 s5, s95, 15
    s_lshr_b32 s88, s5, 3
    s_and_b32 s87, s5, 7
    s_mov_b64 s[8:9], s[48:49]
    s_mov_b32 s10, 0x280000
    s_mov_b32 s11, 0x20000
    s_lshl_b32 s48, s4, 7
    v_lshrrev_b32 v10, 5, v1
    v_and_b32 v11, 31, v1
    s_lshl_b32 s96, s5, 3
    s_add_u32 s96, s96, s48
    s_lshl_b32 s97, s3, 1
    s_add_u32 s96, s96, s97
    v_add_u32 v62, s96, v10
    v_mul_u32_u24 v53, 1280, v62
    v_lshl_add_u32 v2, v11, 3, v53
    v_lshl_add_u32 v53, v11, 4, v53
    buffer_load_dwordx4 v[160:163], v53, s[8:11], 0 offen offset:0
    buffer_load_dwordx4 v[164:167], v53, s[8:11], 0 offen offset:512
    buffer_load_dwordx2 v[168:169], v2, s[8:11], 0 offen offset:1024
    v_mul_u32_u24 v3, 13, v1
    v_lshrrev_b32 v3, 6, v3
    v_mul_u32_u24 v4, 5, v3
    v_sub_u32 v4, v1, v4
    s_mul_i32 s96, s3, 1280
    s_mul_i32 s97, s5, 80
    s_add_u32 s96, s96, s97
    s_lshl_b32 s97, s87, 1
    s_add_u32 s97, s97, s88
    s_mul_i32 s97, s97, 80
    s_movk_i32 s98, 3840
    s_mov_b32 s18, 2457600
    s_cmp_eq_u32 s3, 3
    s_cselect_b32 s98, 1280, s98
    s_cselect_b32 s96, s97, s96
    s_cselect_b64 s[16:17], s[52:53], s[50:51]
    s_cselect_b32 s18, 819200, s18
    s_cselect_b32 s13, 0xffff, -1
    s_mov_b32 s19, 0x20000
    s_mul_i32 s97, s98, 40
    s_mul_i32 s97, s97, s4
    s_add_u32 s96, s96, s97
    s_mul_i32 s99, s98, 10
    v_mul_lo_u32 v3, v3, s98
    v_lshl_add_u32 v55, v4, 4, v3
    s_mov_b32 s86, s96
    s_mov_b32 s89, s99
    v_lshlrev_b32 v62, 4, v62
    v_and_b32 v14, 15, v1
    v_lshrrev_b32 v15, 4, v1
    v_xor_b32 v19, v14, v15
    v_lshlrev_b32 v19, 4, v19
    v_mul_u32_u24 v2, 1280, v15
    v_add_u32 v236, v2, v19
    v_add_u32 v3, 4096, v2
    v_xad_u32 v237, v19, 64, v3
    v_add_u32 v3, 8192, v2
    s_movk_i32 s96, 128
    v_xad_u32 v238, v19, s96, v3
    v_add_u32 v3, 12288, v2
    s_movk_i32 s96, 192
    v_xad_u32 v239, v19, s96, v3
    s_lshl_b32 s96, s3, 5
    s_add_u32 s96, s96, s48
    s_mul_i32 s79, s96, 1280
    s_lshl_b32 s96, s3, 2
    s_add_u32 s96, s96, s48
    s_sub_u32 s96, s96, 16
    v_add_u32 v3, s96, v15
    v_max_i32 v3, 0, v3
    v_mul_u32_u24 v3, 1280, v3
    s_lshl_b32 s96, s3, 6
    v_xad_u32 v240, v19, s96, v3
    s_mul_i32 s76, s5, 5
    s_lshr_b32 s76, s76, 4
    s_lshl_b32 s77, s76, 8
    s_lshl_b32 s49, s3, 13
    s_lshl_b32 s96, s95, 2
    s_add_u32 s96, s96, s3
    s_lshl_b32 s96, s96, 8
    s_min_u32 s96, s96, L_code_end-L_pc-132
    s_add_u32 s0, s74, s96
    s_addc_u32 s1, s75, 0
    s_mov_b64 s[24:25], s[72:73]
    s_mov_b32 s26, 0xc00000
    s_mov_b32 s27, 0x20000
    s_mov_b64 s[36:37], s[56:57]
    s_mov_b32 s38, 0x500
    s_mov_b32 s39, 0x20000
    s_mov_b64 s[28:29], s[68:69]
    s_mov_b32 s30, 0x280000
    s_mov_b32 s31, 0x20000
    s_mov_b64 s[40:41], s[58:59]
    s_mov_b32 s42, 0x21c000
    s_mov_b32 s43, 0x20000
    s_mov_b64 s[44:45], s[60:61]
    s_mov_b32 s46, 0x21c000
    s_mov_b32 s47, 0x20000
    s_mov_b64 s[32:33], s[62:63]
    s_mov_b32 s34, 2211840
    s_mov_b32 s84, 0xffff0000
    s_mov_b32 s94, s87
    s_lshl_b32 s95, s4, 1
    s_add_u32 s95, s95, s88
    s_lshl_b32 s93, s95, 3
    s_add_u32 s93, s93, s94
    s_mov_b32 s70, 0xd0000
    s_mov_b32 s65, 0x8000
    v_lshrrev_b32 v2, 2, v14
    v_and_b32 v3, 3, v14
    v_lshlrev_b32 v3, 3, v3
    s_lshl_b32 s52, s3, 5
    s_add_u32 s52, s52, 110592
    v_lshl_add_u32 v4, v15, 3, v2
    v_lshlrev_b32 v4, 7, v4
    v_add3_u32 v42, v4, v3, s52
    s_mov_b32 s52, 160512
    v_lshl_add_u32 v41, v15, 4, s52
    v_add_u32 v44, s52, v44
    v_lshlrev_b32 v43, 3, v14
    s_lshl_b32 s83, s85, 9
    s_lshl_b32 s52, s3, 7
    s_add_u32 s83, s83, s52
    s_add_u32 s83, s83, 0xd0000
    s_lshl_b32 s52, s3, 2
    v_add_u32 v4, s52, v15
    v_mul_u32_u24 v5, 13, v4
    v_lshrrev_b32 v5, 6, v5
    v_mul_u32_u24 v6, 5, v5
    v_sub_u32 v6, v4, v6
    v_mul_u32_u24 v2, 80, v2
    s_mov_b32 s52, 147456
    v_add3_u32 v2, v2, v3, s52
    v_mul_u32_u24 v4, 640, v4
    v_add_u32 v45, v4, v2
    v_mul_u32_u24 v4, 320, v6
    v_lshl_add_u32 v4, v5, 5, v4
    v_add_u32 v46, v4, v2
    v_mul_u32_u24 v7, 40, v5
    v_add_u32 v7, v7, v14
    v_lshrrev_b32 v8, 4, v7
    v_mul_u32_u24 v8, 768, v8
    v_lshl_add_u32 v8, v7, 4, v8
    s_mul_i32 s53, s4, 5
    v_add_u32 v9, s53, v6
    v_lshl_add_u32 v8, v9, 8, v8
    v_lshrrev_b32 v4, 2, v9
    v_mul_u32_u24 v4, 7168, v4
    v_add_u32 v47, v4, v8
    s_mul_i32 s75, s5, 167936
    s_add_u32 s75, s75, 0x800000
    v_lshlrev_b32 v7, 3, v7
    v_lshl_add_u32 v7, v6, 10, v7
    v_add_u32 v51, s52, v7
    v_and_b32 v4, 7, v14
    v_lshl_add_u32 v4, v9, 3, v4
    v_cmp_gt_u32 vcc, 8, v14
    v_add_u32 v7, 640, v4
    s_mov_b32 s12, -1
    v_cndmask_b32 v4, v4, v7, vcc
    v_cndmask_b32 v50, 0, 1.0, vcc
    s_and_b64 s[14:15], s[12:13], vcc
    v_lshrrev_b32 v7, 6, v4
    v_mul_u32_u24 v7, 1536, v7
    v_lshl_add_u32 v49, v4, 3, v7
    v_lshl_add_u32 v4, v5, 4, v14
    v_mul_u32_u24 v7, 1280, v6
    v_lshl_add_u32 v7, v4, 4, v7
    s_mul_i32 s53, s4, -3840
    s_add_u32 s53, s53, 76800
    v_cmp_eq_u32 vcc, 4, v6
    v_add_u32 v8, s53, v7
    v_mov_b32 v9, 0x7ff00000
    v_cndmask_b32 v7, v7, v8, vcc
    v_cmp_gt_u32 vcc, 40, v4
    s_mul_i32 s53, s87, 102400
    s_mul_i32 s54, s4, 5120
    v_cndmask_b32 v48, v9, v7, vcc
    s_add_u32 s60, s53, 0x700000
    s_add_u32 s53, s60, s54
    s_mul_i32 s54, s88, 640
    s_add_u32 s81, s53, s54
    s_lshl_b32 s52, s5, 11
    s_add_u32 s51, s52, 0x3c0000
    s_lshl_b32 s52, s4, 7
    s_add_u32 s50, s52, s51
    v_lshlrev_b32 v52, 7, v14
    s_lshl_b32 s52, s87, 12
    s_add_u32 s69, s52, 0xc0000
    s_lshl_b32 s53, s95, 7
    s_add_u32 s68, s69, s53
    s_lshl_b32 s52, s4, 4
    s_add_u32 s52, s52, s5
    s_lshl_b32 s52, s52, 7
    s_add_u32 s52, s52, 0x8000
    s_cmp_eq_u32 s3, 1
    s_cselect_b32 s52, s68, s52
    s_cmp_eq_u32 s3, 0
    s_cselect_b32 s52, s50, s52
    s_sub_u32 s52, s52, 128
    v_mov_b32 v2, s83
    v_mov_b32 v3, s52
    v_cndmask_b32 v2, v3, v2, s[14:15]
    s_lshl_b32 s52, s5, 4
    s_add_u32 s52, s52, s4
    s_lshl_b32 s52, s52, 10
    s_add_u32 s74, s52, 0x380000
    s_lshl_b32 s52, s3, 8
    s_add_u32 s52, s52, s74
    v_cmp_gt_u32 vcc, 16, v1
    v_mov_b32 v3, s52
    s_nop 0
    v_cndmask_b32 v2, v3, v2, vcc
    v_lshl_add_u32 v63, v14, 4, v2
    v_lshlrev_b32 v26, 4, v1
    v_lshlrev_b32 v2, 8, v14
    v_add_u32 v2, 73728, v2
    v_add_u32 v20, v2, v19
    v_xad_u32 v21, v19, 64, v2
    s_movk_i32 s52, 128
    v_xad_u32 v22, v19, s52, v2
    s_movk_i32 s52, 192
    v_xad_u32 v23, v19, s52, v2
    s_cmp_eq_u32 s3, 3
    s_cselect_b32 s52, 0x80, 0
    v_and_b32 v2, s52, v26
    v_lshl_add_u32 v29, v2, 23, v26
    s_lshl_b32 s52, s3, 11
    s_add_u32 s80, s75, s52
    s_lshl_b32 s52, s76, 15
    s_add_u32 s72, s80, s52
    s_add_u32 s73, s80, 163840
    s_waitcnt vmcnt(8)
    v_lshlrev_b32 v60, 16, v60
    v_mul_f32 v2, 0xbfb8aa3b, v60
    v_exp_f32 v2, v2
    s_nop 0
    v_add_f32 v2, 1.0, v2
    v_rcp_f32 v2, v2
    s_nop 0
    v_mul_f32 v2, v2, v60
    v_cvt_pk_bf16_f32 v2, v2, v2
    ds_write_b16 v44, v2
    s_waitcnt lgkmcnt(0)
    s_add_u32 s6, s6, 0x9e3779b9
    v_mov_b32 v39, s6
    v_not_b32 v56, v39
    v_not_b32 v57, v39
    v_not_b32 v58, v39
    v_not_b32 v59, v39
    s_cmp_ge_u32 s3, 2
    s_cselect_b32 exec_lo, 0xffff00ff, -1
    s_mov_b32 exec_hi, 0
    buffer_store_dwordx4 v[56:59], v63, s[24:27], 0 offen sc0 sc1
    s_mov_b64 exec, -1
    s_mul_i32 s97, s3, 3200
    s_add_u32 m0, s97, 147456
    s_mov_b32 exec_hi, 0x3ffff
    buffer_load_dwordx4 v55, s[16:19], s86 offen lds
    s_add_u32 m0, m0, 800
    s_add_u32 s86, s86, s89
    buffer_load_dwordx4 v55, s[16:19], s86 offen lds
    s_add_u32 m0, m0, 800
    s_add_u32 s86, s86, s89
    buffer_load_dwordx4 v55, s[16:19], s86 offen lds
    s_add_u32 m0, m0, 800
    s_add_u32 s86, s86, s89
    buffer_load_dwordx4 v55, s[16:19], s86 offen lds
    s_mov_b32 exec_hi, -1
    s_waitcnt vmcnt(8)
    s_barrier
    ds_read_b128 v[112:115], v41 offset:0
    ds_read_b64_tr_b16 v[132:133], v42 offset:0
    ds_read_b64_tr_b16 v[134:135], v42 offset:512
    ds_read_b128 v[116:119], v41 offset:64
    ds_read_b64_tr_b16 v[136:137], v42 offset:4096
    ds_read_b64_tr_b16 v[138:139], v42 offset:4608
    ds_read_b128 v[120:123], v41 offset:128
    ds_read_b64_tr_b16 v[140:141], v42 offset:8192
    ds_read_b64_tr_b16 v[142:143], v42 offset:8704
    ds_read_b128 v[124:127], v41 offset:192
    ds_read_b64_tr_b16 v[144:145], v42 offset:12288
    ds_read_b64_tr_b16 v[146:147], v42 offset:12800
    ds_read_b128 v[128:131], v41 offset:256
    ds_read_b64_tr_b16 v[148:149], v42 offset:16384
    ds_read_b64_tr_b16 v[150:151], v42 offset:16896
    s_waitcnt lgkmcnt(12)
    v_mfma_f32_16x16x32_bf16 v[152:155], v[112:115], v[132:135], 0
    s_waitcnt lgkmcnt(9)
    v_mfma_f32_16x16x32_bf16 v[152:155], v[116:119], v[136:139], v[152:155]
    s_waitcnt lgkmcnt(6)
    v_mfma_f32_16x16x32_bf16 v[152:155], v[120:123], v[140:143], v[152:155]
    s_waitcnt lgkmcnt(3)
    v_mfma_f32_16x16x32_bf16 v[152:155], v[124:127], v[144:147], v[152:155]
    s_waitcnt lgkmcnt(0)
    v_mfma_f32_16x16x32_bf16 v[152:155], v[128:131], v[148:151], v[152:155]
    s_mov_b64 exec, 0xffff
    s_nop 6
    v_mov_b32 v153, s6
    buffer_store_dwordx2 v[152:153], v43, s[24:27], s83 offen sc0 sc1
    s_mov_b64 exec, -1
    s_mov_b32 s52, 0x3f803f80
    s_waitcnt vmcnt(8)
    v_dot2_f32_bf16 v170, v160, s52, 0
    v_dot2_f32_bf16 v171, v160, v160, 0
    v_dot2_f32_bf16 v170, v161, s52, v170
    v_dot2_f32_bf16 v171, v161, v161, v171
    v_dot2_f32_bf16 v170, v162, s52, v170
    v_dot2_f32_bf16 v171, v162, v162, v171
    v_dot2_f32_bf16 v170, v163, s52, v170
    v_dot2_f32_bf16 v171, v163, v163, v171
    s_waitcnt vmcnt(7)
    v_dot2_f32_bf16 v170, v164, s52, v170
    v_dot2_f32_bf16 v171, v164, v164, v171
    v_dot2_f32_bf16 v170, v165, s52, v170
    v_dot2_f32_bf16 v171, v165, v165, v171
    v_dot2_f32_bf16 v170, v166, s52, v170
    v_dot2_f32_bf16 v171, v166, v166, v171
    v_dot2_f32_bf16 v170, v167, s52, v170
    v_dot2_f32_bf16 v171, v167, v167, v171
    s_waitcnt vmcnt(6)
    v_dot2_f32_bf16 v170, v168, s52, v170
    v_dot2_f32_bf16 v171, v168, v168, v171
    v_dot2_f32_bf16 v170, v169, s52, v170
    v_dot2_f32_bf16 v171, v169, v169, v171
    s_nop 1
    v_add_f32_dpp v170, v170, v170 quad_perm:[1,0,3,2] row_mask:0xf bank_mask:0xf
    v_add_f32_dpp v171, v171, v171 quad_perm:[1,0,3,2] row_mask:0xf bank_mask:0xf
    s_nop 0
    v_add_f32_dpp v170, v170, v170 quad_perm:[2,3,0,1] row_mask:0xf bank_mask:0xf
    v_add_f32_dpp v171, v171, v171 quad_perm:[2,3,0,1] row_mask:0xf bank_mask:0xf
    s_nop 0
    v_add_f32_dpp v170, v170, v170 row_ror:4 row_mask:0xf bank_mask:0xf
    v_add_f32_dpp v171, v171, v171 row_ror:4 row_mask:0xf bank_mask:0xf
    s_nop 0
    v_add_f32_dpp v170, v170, v170 row_ror:8 row_mask:0xf bank_mask:0xf
    v_add_f32_dpp v171, v171, v171 row_ror:8 row_mask:0xf bank_mask:0xf
    v_mov_b32 v160, v170
    v_mov_b32 v161, v171
    s_nop 0
    v_permlane16_swap_b32 v170, v160
    v_permlane16_swap_b32 v171, v161
    v_add_f32 v170, v170, v160
    v_add_f32 v171, v171, v161
    v_mul_f32 v36, 0xbacccccd, v170
    v_mov_b32 v38, 0x3727c5ac
    v_fmac_f32 v38, 0x3acccccd, v171
    v_fma_f32 v38, -v36, v36, v38
    v_max_f32 v38, 0x3727c5ac, v38
    v_rsq_f32 v38, v38
    s_getreg_b32 s88, hwreg(HW_REG_XCC_ID, 0, 4)
    v_mul_f32 v36, v36, v38
    v_mov_b32 v37, s88
    v_and_b32 v2, 0x70, v62
    v_add_u32 v2, 161024, v2
    ds_write_b128 v2, v[36:39]
    s_add_u32 m0, s49, 77824
    s_add_u32 s7, s79, s77
    buffer_load_dwordx4 v236, s[8:11], s7 offen offset:0 lds
    buffer_load_dwordx4 v237, s[8:11], s7 offen offset:1024 lds
    buffer_load_dwordx4 v238, s[8:11], s7 offen offset:2048 lds
    buffer_load_dwordx4 v239, s[8:11], s7 offen offset:3072 lds
    s_add_u32 m0, m0, 4096
    s_add_u32 s7, s7, 20480
    buffer_load_dwordx4 v236, s[8:11], s7 offen offset:0 lds
    buffer_load_dwordx4 v237, s[8:11], s7 offen offset:1024 lds
    buffer_load_dwordx4 v238, s[8:11], s7 offen offset:2048 lds
    buffer_load_dwordx4 v239, s[8:11], s7 offen offset:3072 lds
    s_add_u32 m0, s78, 73728
    s_nop 0
    buffer_load_dwordx4 v240, s[8:11], s77 offen lds
    s_add_u32 s77, s77, 256
    s_cmp_eq_u32 s77, 1280
    s_cselect_b32 s77, 0, s77
    s_mov_b64 s[20:21], 0xffff
    s_bitset0_b32 s20, s4
    s_lshl_b32 s86, s95, 2
    s_add_u32 s86, s86, s3
    s_mul_i32 s52, s86, 1280
    s_mul_i32 s53, s87, 160
    s_add_u32 s52, s52, s53
    s_add_u32 s92, s52, 0x60000
    v_lshrrev_b32 v4, 3, v0
    v_and_b32 v5, 7, v0
    s_mul_i32 s56, s94, 80
    v_add_u32 v6, s56, v4
    v_mul_u32_u24 v6, 3456, v6
    v_lshl_add_u32 v6, v5, 4, v6
    s_lshl_b32 s56, s95, 7
    s_mul_i32 s89, s95, 81920
    s_mul_i32 s55, s94, 160
    s_add_u32 s89, s89, s55
    s_cmp_ge_u32 s93, 216
    s_cselect_b32 s56, 0x7ff00000, s56
    s_cselect_b32 s89, 0, s89
    v_add_u32 v31, s56, v6
    v_mov_b32 v7, 0x7ff00000
    v_cmp_gt_u32 vcc, 16, v4
    s_mov_b32 s16, 110592
    s_mov_b32 s17, 221184
    v_cndmask_b32 v32, v7, v31, vcc
    s_waitcnt vmcnt(10)
    s_waitcnt lgkmcnt(0)
    s_barrier
    ds_read_b64_tr_b16 v[76:77], v46 offset:9600
    ds_read_b64_tr_b16 v[78:79], v46 offset:11200
    ds_read_b64_tr_b16 v[64:65], v45 offset:0
    ds_read_b64_tr_b16 v[66:67], v45 offset:320
    ds_read_b64_tr_b16 v[68:69], v45 offset:32
    ds_read_b64_tr_b16 v[70:71], v45 offset:352
    ds_read_b64_tr_b16 v[72:73], v45 offset:64
    ds_read_b64_tr_b16 v[74:75], v45 offset:384
    buffer_load_dwordx2 v[104:105], v49, s[24:27], s70 offen offset:0 sc1
    buffer_load_dwordx2 v[106:107], v49, s[24:27], s70 offen offset:512 sc1
    buffer_load_dwordx2 v[108:109], v49, s[24:27], s70 offen offset:1024 sc1
    buffer_load_dwordx2 v[110:111], v49, s[24:27], s70 offen offset:1536 sc1
    s_waitcnt lgkmcnt(6)
    buffer_store_dwordx4 v[76:79], v48, s[24:27], s81 offen sc0 sc1
    s_cmp_lg_u32 s3, 2
    s_cbranch_scc1 L_skip_1
    v_add_u32 v2, 161024, v26
    ds_read_b128 v[112:115], v2
    v_and_b32 v3, 0x7f80, v62
    v_add_u32 v3, v3, v26
    s_mov_b64 exec, 0xff
    s_waitcnt lgkmcnt(0)
    buffer_store_dwordx4 v[112:115], v3, s[24:27], s65 offen sc0 sc1
    s_mov_b64 exec, -1
L_skip_1:
    s_nop 1
    s_waitcnt lgkmcnt(5)
    v_lshlrev_b32 v80, 16, v64
    v_and_b32 v81, s84, v64
    v_lshlrev_b32 v82, 16, v65
    v_and_b32 v83, s84, v65
    s_waitcnt lgkmcnt(4)
    v_lshlrev_b32 v84, 16, v66
    v_and_b32 v85, s84, v66
    v_lshlrev_b32 v86, 16, v67
    v_and_b32 v87, s84, v67
    s_waitcnt lgkmcnt(3)
    v_lshlrev_b32 v88, 16, v68
    v_and_b32 v89, s84, v68
    v_lshlrev_b32 v90, 16, v69
    v_and_b32 v91, s84, v69
    s_waitcnt lgkmcnt(2)
    v_lshlrev_b32 v92, 16, v70
    v_and_b32 v93, s84, v70
    v_lshlrev_b32 v94, 16, v71
    v_and_b32 v95, s84, v71
    s_waitcnt lgkmcnt(1)
    v_lshlrev_b32 v96, 16, v72
    v_and_b32 v97, s84, v72
    v_lshlrev_b32 v98, 16, v73
    v_and_b32 v99, s84, v73
    s_waitcnt lgkmcnt(0)
    v_lshlrev_b32 v100, 16, v74
    v_and_b32 v101, s84, v74
    v_lshlrev_b32 v102, 16, v75
    v_and_b32 v103, s84, v75
    s_barrier
    s_waitcnt vmcnt(4)
    v_xor_b32 v2, s6, v105
    s_waitcnt vmcnt(3)
    v_bitop3_b32 v2, v2, v107, s6 bitop3:0xf6
    s_waitcnt vmcnt(2)
    v_bitop3_b32 v2, v2, v109, s6 bitop3:0xf6
    s_waitcnt vmcnt(1)
    v_bitop3_b32 v2, v2, v111, s6 bitop3:0xf6
    v_cmp_ne_u32 vcc, 0, v2
    s_nop 0
    s_cbranch_vccz L_done_3
    s_mov_b32 s90, 0
L_poll_2:
    s_nop 1
    buffer_load_dwordx2 v[104:105], v49, s[24:27], s70 offen offset:0 sc1
    buffer_load_dwordx2 v[106:107], v49, s[24:27], s70 offen offset:512 sc1
    buffer_load_dwordx2 v[108:109], v49, s[24:27], s70 offen offset:1024 sc1
    buffer_load_dwordx2 v[110:111], v49, s[24:27], s70 offen offset:1536 sc1
    s_waitcnt vmcnt(0)
    v_xor_b32 v2, s6, v105
    v_bitop3_b32 v2, v2, v107, s6 bitop3:0xf6
    v_bitop3_b32 v2, v2, v109, s6 bitop3:0xf6
    v_bitop3_b32 v2, v2, v111, s6 bitop3:0xf6
    v_cmp_ne_u32 vcc, 0, v2
    s_nop 0
    s_cbranch_vccz L_done_3
    s_add_u32 s90, s90, 1
    s_cmp_lt_u32 s90, 40000
    s_cbranch_scc1 L_poll_2
L_done_3:
    s_nop 1
    v_add_f32 v104, v104, v106
    v_add_f32 v108, v108, v110
    v_add_f32 v104, v104, v108
    v_cvt_pk_bf16_f32 v104, 0, v104
    v_add_f32 v104, v104, v50
    v_cvt_pk_bf16_f32 v104, 0, v104
    s_nop 1
    v_mul_f32_dpp v112, v104, v80 row_newbcast:0 row_mask:0xf bank_mask:0xf
    v_mul_f32_dpp v113, v104, v81 row_newbcast:1 row_mask:0xf bank_mask:0xf
    v_mul_f32_dpp v114, v104, v82 row_newbcast:2 row_mask:0xf bank_mask:0xf
    v_mul_f32_dpp v115, v104, v83 row_newbcast:3 row_mask:0xf bank_mask:0xf
    v_mul_f32_dpp v116, v104, v84 row_newbcast:4 row_mask:0xf bank_mask:0xf
    v_mul_f32_dpp v117, v104, v85 row_newbcast:5 row_mask:0xf bank_mask:0xf
    v_mul_f32_dpp v118, v104, v86 row_newbcast:6 row_mask:0xf bank_mask:0xf
    v_mul_f32_dpp v119, v104, v87 row_newbcast:7 row_mask:0xf bank_mask:0xf
    v_cvt_pk_bf16_f32 v64, v112, v113
    v_cvt_pk_bf16_f32 v65, v114, v115
    v_cvt_pk_bf16_f32 v66, v116, v117
    v_cvt_pk_bf16_f32 v67, v118, v119
    s_mov_b64 exec, s[12:13]
    buffer_store_dwordx4 v[64:67], v47, s[24:27], s75 offen offset:0 sc0 sc1
    s_mov_b64 exec, -1
    v_mul_f32_dpp v120, v104, v88 row_newbcast:0 row_mask:0xf bank_mask:0xf
    v_mul_f32_dpp v121, v104, v89 row_newbcast:1 row_mask:0xf bank_mask:0xf
    v_mul_f32_dpp v122, v104, v90 row_newbcast:2 row_mask:0xf bank_mask:0xf
    v_mul_f32_dpp v123, v104, v91 row_newbcast:3 row_mask:0xf bank_mask:0xf
    v_mul_f32_dpp v124, v104, v92 row_newbcast:4 row_mask:0xf bank_mask:0xf
    v_mul_f32_dpp v125, v104, v93 row_newbcast:5 row_mask:0xf bank_mask:0xf
    v_mul_f32_dpp v126, v104, v94 row_newbcast:6 row_mask:0xf bank_mask:0xf
    v_mul_f32_dpp v127, v104, v95 row_newbcast:7 row_mask:0xf bank_mask:0xf
    v_cvt_pk_bf16_f32 v68, v120, v121
    v_cvt_pk_bf16_f32 v69, v122, v123
    v_cvt_pk_bf16_f32 v70, v124, v125
    v_cvt_pk_bf16_f32 v71, v126, v127
    s_mov_b64 exec, s[12:13]
    buffer_store_dwordx4 v[68:71], v47, s[24:27], s75 offen offset:1024 sc0 sc1
    s_mov_b64 exec, -1
    v_mul_f32_dpp v128, v104, v96 row_newbcast:0 row_mask:0xf bank_mask:0xf
    v_mul_f32_dpp v129, v104, v97 row_newbcast:1 row_mask:0xf bank_mask:0xf
    v_mul_f32_dpp v130, v104, v98 row_newbcast:2 row_mask:0xf bank_mask:0xf
    v_mul_f32_dpp v131, v104, v99 row_newbcast:3 row_mask:0xf bank_mask:0xf
    v_mul_f32_dpp v132, v104, v100 row_newbcast:4 row_mask:0xf bank_mask:0xf
    v_mul_f32_dpp v133, v104, v101 row_newbcast:5 row_mask:0xf bank_mask:0xf
    v_mul_f32_dpp v134, v104, v102 row_newbcast:6 row_mask:0xf bank_mask:0xf
    v_mul_f32_dpp v135, v104, v103 row_newbcast:7 row_mask:0xf bank_mask:0xf
    v_cvt_pk_bf16_f32 v72, v128, v129
    v_cvt_pk_bf16_f32 v73, v130, v131
    v_cvt_pk_bf16_f32 v74, v132, v133
    v_cvt_pk_bf16_f32 v75, v134, v135
    s_mov_b64 exec, s[14:15]
    buffer_store_dwordx4 v[72:75], v47, s[24:27], s75 offen offset:2048 sc0 sc1
    s_mov_b64 exec, -1
    s_mov_b32 s52, 0x3f803f80
    v_dot2_f32_bf16 v172, v64, s52, 0
    v_dot2_f32_bf16 v174, v68, s52, 0
    v_dot2_f32_bf16 v176, v72, s52, 0
    v_mul_f32_dpp v173, v104, v80 row_newbcast:8 row_mask:0xf bank_mask:0xf
    v_mul_f32_dpp v175, v104, v88 row_newbcast:8 row_mask:0xf bank_mask:0xf
    v_mul_f32_dpp v177, v104, v96 row_newbcast:8 row_mask:0xf bank_mask:0xf
    v_fmac_f32_dpp v173, v104, v81 row_newbcast:9 row_mask:0xf bank_mask:0xf
    v_fmac_f32_dpp v175, v104, v89 row_newbcast:9 row_mask:0xf bank_mask:0xf
    v_fmac_f32_dpp v177, v104, v97 row_newbcast:9 row_mask:0xf bank_mask:0xf
    v_dot2_f32_bf16 v172, v65, s52, v172
    v_dot2_f32_bf16 v174, v69, s52, v174
    v_dot2_f32_bf16 v176, v73, s52, v176
    v_fmac_f32_dpp v173, v104, v82 row_newbcast:10 row_mask:0xf bank_mask:0xf
    v_fmac_f32_dpp v175, v104, v90 row_newbcast:10 row_mask:0xf bank_mask:0xf
    v_fmac_f32_dpp v177, v104, v98 row_newbcast:10 row_mask:0xf bank_mask:0xf
    v_fmac_f32_dpp v173, v104, v83 row_newbcast:11 row_mask:0xf bank_mask:0xf
    v_fmac_f32_dpp v175, v104, v91 row_newbcast:11 row_mask:0xf bank_mask:0xf
    v_fmac_f32_dpp v177, v104, v99 row_newbcast:11 row_mask:0xf bank_mask:0xf
    v_dot2_f32_bf16 v172, v66, s52, v172
    v_dot2_f32_bf16 v174, v70, s52, v174
    v_dot2_f32_bf16 v176, v74, s52, v176
    v_fmac_f32_dpp v173, v104, v84 row_newbcast:12 row_mask:0xf bank_mask:0xf
    v_fmac_f32_dpp v175, v104, v92 row_newbcast:12 row_mask:0xf bank_mask:0xf
    v_fmac_f32_dpp v177, v104, v100 row_newbcast:12 row_mask:0xf bank_mask:0xf
    v_fmac_f32_dpp v173, v104, v85 row_newbcast:13 row_mask:0xf bank_mask:0xf
    v_fmac_f32_dpp v175, v104, v93 row_newbcast:13 row_mask:0xf bank_mask:0xf
    v_fmac_f32_dpp v177, v104, v101 row_newbcast:13 row_mask:0xf bank_mask:0xf
    v_dot2_f32_bf16 v172, v67, s52, v172
    v_dot2_f32_bf16 v174, v71, s52, v174
    v_dot2_f32_bf16 v176, v75, s52, v176
    v_fmac_f32_dpp v173, v104, v86 row_newbcast:14 row_mask:0xf bank_mask:0xf
    v_fmac_f32_dpp v175, v104, v94 row_newbcast:14 row_mask:0xf bank_mask:0xf
    v_fmac_f32_dpp v177, v104, v102 row_newbcast:14 row_mask:0xf bank_mask:0xf
    v_fmac_f32_dpp v173, v104, v87 row_newbcast:15 row_mask:0xf bank_mask:0xf
    v_fmac_f32_dpp v175, v104, v95 row_newbcast:15 row_mask:0xf bank_mask:0xf
    v_fmac_f32_dpp v177, v104, v103 row_newbcast:15 row_mask:0xf bank_mask:0xf
    s_mov_b64 exec, s[12:13]
    ds_write_b64 v51, v[172:173] offset:0
    ds_write_b64 v51, v[174:175] offset:128
    s_mov_b64 exec, s[14:15]
    ds_write_b64 v51, v[176:177] offset:256
    s_mov_b64 exec, -1
    s_waitcnt lgkmcnt(0)
    s_barrier
    s_cmp_lg_u32 s3, 1
    s_cbranch_scc1 L_skip_4
    v_lshlrev_b32 v3, 8, v15
    v_lshl_add_u32 v3, v14, 3, v3
    v_add_u32 v3, 147456, v3
    ds_read_b64 v[112:113], v3 offset:0
    ds_read_b64 v[114:115], v3 offset:128
    ds_read_b64 v[116:117], v3 offset:1024
    ds_read_b64 v[118:119], v3 offset:1152
    ds_read_b64 v[120:121], v3 offset:2048
    ds_read_b64 v[122:123], v3 offset:2176
    ds_read_b64 v[124:125], v3 offset:3072
    ds_read_b64 v[126:127], v3 offset:3200
    ds_read_b64 v[128:129], v3 offset:4096
    ds_read_b64 v[130:131], v3 offset:4224
    s_waitcnt lgkmcnt(7)
    v_pk_add_f32 v[112:113], v[112:113], v[116:117]
    s_waitcnt lgkmcnt(6)
    v_pk_add_f32 v[114:115], v[114:115], v[118:119]
    s_waitcnt lgkmcnt(3)
    v_pk_add_f32 v[120:121], v[120:121], v[124:125]
    s_waitcnt lgkmcnt(2)
    v_pk_add_f32 v[122:123], v[122:123], v[126:127]
    s_waitcnt lgkmcnt(1)
    v_pk_add_f32 v[112:113], v[112:113], v[128:129]
    s_waitcnt lgkmcnt(0)
    v_pk_add_f32 v[114:115], v[114:115], v[130:131]
    v_pk_add_f32 v[112:113], v[112:113], v[120:121]
    v_pk_add_f32 v[114:115], v[114:115], v[122:123]
    buffer_store_dwordx4 v[112:115], v26, s[24:27], s74 offen sc0 sc1
L_skip_4:
    s_nop 1
    s_min_u32 s52, s3, 2
    s_lshl_b32 s67, s52, 10
    s_lshl_b32 s52, s52, 6
    s_add_u32 s52, s52, s48
    s_sub_u32 s52, s52, 16
    v_add_u32 v2, s52, v1
    v_max_i32 v2, 0, v2
    v_lshlrev_b32 v12, 4, v2
    v_lshrrev_b32 v13, 3, v0
    v_lshlrev_b32 v13, 7, v13
    s_mov_b32 s52, 153600
    v_lshl_add_u32 v28, v14, 4, s52
    s_lshl_b32 s66, s5, 14
    s_lshl_b32 s53, s3, 8
    s_add_u32 s66, s66, s53
    s_add_u32 s66, s66, 0x380000
    v_lshlrev_b32 v33, 12, v15
    v_lshl_add_u32 v33, v14, 4, v33
    s_mul_i32 s63, s3, 9216
    s_add_u32 s64, s60, s63
    s_lshl_b32 s52, s4, 3
    s_lshl_b32 s53, s3, 1
    s_add_u32 s52, s52, s53
    s_mul_i32 s52, s52, 20480
    s_add_u32 s91, s52, 0x100000
    s_lshl_b32 s53, s5, 10
    v_lshl_add_u32 v24, v1, 4, s53
    v_mul_u32_u24 v25, 20480, v10
    v_lshl_add_u32 v25, v14, 4, v25
    v_and_b32 v2, 1, v15
    v_lshl_add_u32 v25, v2, 3, v25
    s_lshl_b32 s53, s5, 8
    s_add_u32 s53, s53, 16384
    v_add_u32 v25, s53, v25
    s_add_u32 m0, s49, 4096
    s_add_u32 s7, s79, s77
    buffer_load_dwordx4 v236, s[8:11], s7 offen offset:0 lds
    buffer_load_dwordx4 v237, s[8:11], s7 offen offset:1024 lds
    buffer_load_dwordx4 v238, s[8:11], s7 offen offset:2048 lds
    buffer_load_dwordx4 v239, s[8:11], s7 offen offset:3072 lds
    s_add_u32 m0, m0, 4096
    s_add_u32 s7, s7, 20480
    buffer_load_dwordx4 v236, s[8:11], s7 offen offset:0 lds
    buffer_load_dwordx4 v237, s[8:11], s7 offen offset:1024 lds
    buffer_load_dwordx4 v238, s[8:11], s7 offen offset:2048 lds
    buffer_load_dwordx4 v239, s[8:11], s7 offen offset:3072 lds
    s_add_u32 m0, s78, 0
    s_nop 0
    buffer_load_dwordx4 v240, s[8:11], s77 offen lds
    s_add_u32 s77, s77, 256
    s_cmp_eq_u32 s77, 1280
    s_cselect_b32 s77, 0, s77
    s_waitcnt vmcnt(9)
    s_barrier
    s_cmp_eq_u32 s3, 0
    s_cselect_b32 s52, s50, s68
    s_bitcmp1_b32 s3, 0
    s_cbranch_scc1 L_skip_5
    s_mov_b64 exec, 0xff
    buffer_store_dwordx4 v[36:39], v26, s[24:27], s52 offen sc0 sc1
    s_mov_b64 exec, -1
L_skip_5:
    s_nop 1
    s_add_u32 m0, s49, 40960
    s_add_u32 s7, s79, s77
    buffer_load_dwordx4 v236, s[8:11], s7 offen offset:0 lds
    buffer_load_dwordx4 v237, s[8:11], s7 offen offset:1024 lds
    buffer_load_dwordx4 v238, s[8:11], s7 offen offset:2048 lds
    buffer_load_dwordx4 v239, s[8:11], s7 offen offset:3072 lds
    s_add_u32 m0, m0, 4096
    s_add_u32 s7, s7, 20480
    buffer_load_dwordx4 v236, s[8:11], s7 offen offset:0 lds
    buffer_load_dwordx4 v237, s[8:11], s7 offen offset:1024 lds
    buffer_load_dwordx4 v238, s[8:11], s7 offen offset:2048 lds
    buffer_load_dwordx4 v239, s[8:11], s7 offen offset:3072 lds
    s_add_u32 m0, s78, 36864
    s_nop 0
    buffer_load_dwordx4 v240, s[8:11], s77 offen lds
    s_add_u32 s77, s77, 256
    s_cmp_eq_u32 s77, 1280
    s_cselect_b32 s77, 0, s77
    s_add_u32 m0, s49, 114688
    s_add_u32 s7, s79, s77
    buffer_load_dwordx4 v236, s[8:11], s7 offen offset:0 lds
    buffer_load_dwordx4 v237, s[8:11], s7 offen offset:1024 lds
    buffer_load_dwordx4 v238, s[8:11], s7 offen offset:2048 lds
    buffer_load_dwordx4 v239, s[8:11], s7 offen offset:3072 lds
    s_add_u32 m0, m0, 4096
    s_add_u32 s7, s7, 20480
    buffer_load_dwordx4 v236, s[8:11], s7 offen offset:0 lds
    buffer_load_dwordx4 v237, s[8:11], s7 offen offset:1024 lds
    buffer_load_dwordx4 v238, s[8:11], s7 offen offset:2048 lds
    buffer_load_dwordx4 v239, s[8:11], s7 offen offset:3072 lds
    s_add_u32 m0, s78, 110592
    s_nop 0
    buffer_load_dwordx4 v240, s[8:11], s77 offen lds
    s_add_u32 s77, s77, 256
    s_cmp_eq_u32 s77, 1280
    s_cselect_b32 s77, 0, s77
    s_lshr_b32 s54, s86, 1
    s_lshl_b32 s54, s54, 5
    s_and_b32 s55, s86, 1
    s_add_u32 s54, s54, s55
    v_lshl_add_u32 v35, v14, 1, s54
    v_mul_u32_u24 v30, 1280, v35
    v_lshl_add_u32 v30, v15, 3, v30
    s_mul_i32 s55, s87, 160
    v_add_u32 v30, s55, v30
    s_mul_i32 s71, s54, 1280
    s_add_u32 s71, s71, s55
    s_mul_i32 s53, s3, 640
    s_lshr_b32 s54, s55, 1
    s_add_u32 s53, s53, s54
    s_add_u32 s53, s53, 1280
    v_min_u32 v4, 39, v1
    v_lshl_add_u32 v5, v4, 1, s53
    v_lshrrev_b32 v3, 6, v5
    v_mul_u32_u24 v3, 1536, v3
    v_lshl_add_u32 v27, v5, 3, v3
    v_lshl_add_u32 v10, v4, 2, s55
    s_lshl_b32 s61, s95, 10
    s_add_u32 s61, s61, 0xc8000
    s_mul_i32 s58, s3, 3072
    s_add_u32 s58, s58, 149760
    s_lshl_b32 s59, s4, 2
    s_add_u32 s59, s59, s3
    s_lshl_b32 s59, s59, 4
    s_add_u32 s59, s59, s5
    s_lshl_b32 s59, s59, 7
    s_add_u32 s59, s59, 0x3e0000
    s_lshr_b32 s57, s86, 1
    s_lshl_b32 s57, s57, 11
    s_add_u32 s57, s57, 0x3e0000
    s_add_u32 m0, s67, 153600
    s_nop 0
    buffer_load_dwordx4 v12, s[24:27], s65 offen sc1 lds
    s_mov_b64 exec, 0xffff
    buffer_load_dword v61, v52, s[24:27], s51 offen offset:12 sc1
    s_mov_b64 exec, -1
    ds_read_b128 a[40:43], v20 offset:0
    ds_read_b128 a[44:47], v20 offset:4096
    ds_read_b128 a[48:51], v20 offset:8192
    ds_read_b128 a[52:55], v20 offset:12288
    ds_read_b128 a[56:59], v20 offset:16384
    ds_read_b128 a[60:63], v20 offset:20480
    ds_read_b128 a[64:67], v20 offset:24576
    ds_read_b128 a[68:71], v20 offset:28672
    ds_read_b128 a[72:75], v20 offset:32768
    v_and_b32 v2, 7, v1
    s_lshl_b32 s52, s5, 10
    v_lshl_add_u32 v2, v2, 7, s52
    v_and_b32 v3, 1, v1
    s_lshl_b32 s52, s5, 8
    s_add_u32 s52, s52, 16384
    v_cmp_gt_u32 vcc, 16, v1
    v_lshl_add_u32 v3, v3, 7, s52
    v_bfe_u32 v4, v1, 3, 1
    v_cndmask_b32 v2, v3, v2, vcc
    v_mul_u32_u24 v4, 20480, v4
    v_add3_u32 v34, v2, v4, s91
    v_writelane_b32 v34, s59, 32
    s_lshl_b32 s52, s86, 3
    s_add_u32 s52, s52, s87
    s_lshl_b32 s52, s52, 8
    s_add_u32 s52, s52, 0x10000
    v_writelane_b32 v34, s52, 33
    s_add_u32 s52, s52, 128
    v_writelane_b32 v34, s52, 34
    s_lshl_b32 s52, s93, 2
    s_add_u32 s52, s52, s3
    s_lshl_b32 s52, s52, 8
    s_add_u32 s52, s52, 0x680000
    v_writelane_b32 v34, s52, 35
    s_add_u32 s52, s52, 128
    v_writelane_b32 v34, s52, 36
    s_mul_i32 s52, s95, 4224
    s_add_u32 s52, s52, 0x400000
    v_writelane_b32 v34, s52, 38
    s_lshl_b32 s53, s95, 7
    s_mul_i32 s52, s94, 20480
    s_add_u32 s52, s52, s53
    s_add_u32 s52, s52, 0x6c4000
    v_writelane_b32 v34, s52, 39
    s_lshl_b32 s53, s3, 12
    s_add_u32 s52, s52, s53
    s_sub_u32 s52, s52, 16384
    v_writelane_b32 v34, s52, 37
    s_lshl_b32 s52, s93, 7
    s_add_u32 s52, s52, 0xc8000
    v_writelane_b32 v34, s52, 40
    s_waitcnt vmcnt(0)
    v_cmp_ne_u32 vcc, s6, v61
    s_nop 0
    s_and_b64 vcc, vcc, s[20:21]
    s_cbranch_vccz L_done_7
    s_mov_b32 s90, 0
L_poll_6:
    s_nop 1
    s_add_u32 m0, s67, 153600
    s_nop 0
    buffer_load_dwordx4 v12, s[24:27], s65 offen sc1 lds
    s_mov_b64 exec, 0xffff
    buffer_load_dword v61, v52, s[24:27], s51 offen offset:12 sc1
    s_mov_b64 exec, -1
    s_waitcnt vmcnt(0)
    v_cmp_ne_u32 vcc, s6, v61
    s_nop 0
    s_and_b64 vcc, vcc, s[20:21]
    s_cbranch_vccz L_done_7
    s_add_u32 s90, s90, 1
    s_cmp_lt_u32 s90, 40000
    s_cbranch_scc1 L_poll_6
L_done_7:
    s_nop 1
    buffer_load_dwordx4 a[96:99], v26, s[24:27], s72 offen sc1
    buffer_load_dwordx4 a[100:103], v29, s[24:27], s72 offen offset:1024 sc1
    s_barrier
    s_add_u32 s72, s72, 8192
    buffer_load_dwordx4 a[104:107], v26, s[24:27], s72 offen sc1
    buffer_load_dwordx4 a[108:111], v29, s[24:27], s72 offen offset:1024 sc1
    s_add_u32 s72, s72, 8192
    buffer_load_dwordx4 a[112:115], v26, s[24:27], s72 offen sc1
    buffer_load_dwordx4 a[116:119], v29, s[24:27], s72 offen offset:1024 sc1
    s_add_u32 s72, s72, 8192
    buffer_load_dwordx4 a[120:123], v26, s[24:27], s72 offen sc1
    buffer_load_dwordx4 a[124:127], v29, s[24:27], s72 offen offset:1024 sc1
    s_mov_b64 exec, 3
    global_load_dword a21, v52, s[0:1] sc1
    s_mov_b64 exec, -1
    s_waitcnt vmcnt(8) lgkmcnt(8)
    v_mfma_f32_16x16x32_bf16 v[40:43], a[96:99], a[40:43], 0
    ds_read_b128 v[184:187], v28 offset:0
    s_add_u32 s72, s72, 8192
    s_waitcnt vmcnt(7)
    v_mfma_f32_16x16x32_bf16 v[44:47], a[100:103], a[40:43], 0
    ds_read_b128 a[40:43], v21 offset:0
    s_lshl_b32 s54, s3, 5
    s_waitcnt lgkmcnt(9)
    v_mfma_f32_16x16x32_bf16 v[48:51], a[96:99], a[44:47], 0
    s_cmp_eq_u32 s72, s73
    s_cselect_b32 s72, s80, s72
    s_add_u32 s54, s54, 16
    v_mfma_f32_16x16x32_bf16 v[52:55], a[100:103], a[44:47], 0
    ds_read_b128 a[44:47], v21 offset:4096
    v_lshlrev_b32 v2, 2, v15
    s_waitcnt lgkmcnt(9)
    v_mfma_f32_16x16x32_bf16 v[56:59], a[96:99], a[48:51], 0
    buffer_load_dwordx4 a[128:131], v26, s[24:27], s72 offen sc1
    v_mfma_f32_16x16x32_bf16 v[60:63], a[100:103], a[48:51], 0
    ds_read_b128 a[48:51], v21 offset:8192
    s_waitcnt lgkmcnt(7)
    v_mfma_f32_16x16x32_bf16 v[64:67], a[96:99], a[52:55], 0
    v_sub_u32 v2, v2, v14
    v_mfma_f32_16x16x32_bf16 v[68:71], a[100:103], a[52:55], 0
    ds_read_b128 a[52:55], v21 offset:12288
    v_mfma_f32_16x16x32_bf16 v[72:75], a[96:99], a[56:59], 0
    buffer_load_dwordx4 a[132:135], v29, s[24:27], s72 offen offset:1024 sc1
    v_mfma_f32_16x16x32_bf16 v[76:79], a[100:103], a[56:59], 0
    ds_read_b128 a[56:59], v21 offset:16384
    v_mfma_f32_16x16x32_bf16 v[80:83], a[96:99], a[60:63], 0
    s_waitcnt lgkmcnt(6)
    v_mfma_f32_16x16x32_bf16 v[84:87], a[100:103], a[60:63], 0
    ds_read_b128 a[60:63], v21 offset:20480
    v_mfma_f32_16x16x32_bf16 v[88:91], a[96:99], a[64:67], 0
    ds_read_b128 v[188:191], v28 offset:256
    v_mov_b32 v4, 0xff7fffff
    v_mfma_f32_16x16x32_bf16 v[92:95], a[100:103], a[64:67], 0
    ds_read_b128 a[64:67], v21 offset:24576
    v_mfma_f32_16x16x32_bf16 v[96:99], a[96:99], a[68:71], 0
    s_add_u32 s72, s72, 8192
    s_or_b32 s55, s4, s3
    s_cmp_eq_u32 s55, 0
    s_cselect_b32 s55, 100, 0
    v_mfma_f32_16x16x32_bf16 v[100:103], a[100:103], a[68:71], 0
    ds_read_b128 a[68:71], v21 offset:28672
    v_subrev_u32 v3, s55, v2
    v_mfma_f32_16x16x32_bf16 v[104:107], a[96:99], a[72:75], 0
    s_waitcnt vmcnt(7) lgkmcnt(6)
    v_cmp_le_i32 vcc, 9, v3
    v_mfma_f32_16x16x32_bf16 v[108:111], a[100:103], a[72:75], 0
    ds_read_b128 a[72:75], v21 offset:32768
    v_mfma_f32_16x16x32_bf16 v[40:43], a[104:107], a[40:43], v[40:43]
    buffer_load_dwordx4 a[136:139], v26, s[24:27], s72 offen sc1
    v_mfma_f32_16x16x32_bf16 v[44:47], a[108:111], a[40:43], v[44:47]
    ds_read_b128 a[40:43], v22 offset:0
    v_mfma_f32_16x16x32_bf16 v[48:51], a[104:107], a[44:47], v[48:51]
    ds_read_b128 v[192:195], v28 offset:512
    v_add_u32 v5, 7, v2
    v_mfma_f32_16x16x32_bf16 v[52:55], a[108:111], a[44:47], v[52:55]
    ds_read_b128 a[44:47], v22 offset:4096
    v_cmp_gt_u32 s[98:99], 8, v5
    v_mfma_f32_16x16x32_bf16 v[56:59], a[104:107], a[48:51], v[56:59]
    buffer_load_dwordx4 a[140:143], v29, s[24:27], s72 offen offset:1024 sc1
    v_mfma_f32_16x16x32_bf16 v[60:63], a[108:111], a[48:51], v[60:63]
    ds_read_b128 a[48:51], v22 offset:8192
    s_waitcnt lgkmcnt(8)
    v_mfma_f32_16x16x32_bf16 v[64:67], a[104:107], a[52:55], v[64:67]
    v_cndmask_b32 v6, v4, 0, vcc
    s_mov_b32 s55, 0x05040100
    v_mfma_f32_16x16x32_bf16 v[68:71], a[108:111], a[52:55], v[68:71]
    ds_read_b128 a[52:55], v22 offset:12288
    v_mfma_f32_16x16x32_bf16 v[72:75], a[104:107], a[56:59], v[72:75]
    buffer_load_dwordx4 v[168:171], v33, s[24:27], s66 offen offset:0 sc1
    v_mfma_f32_16x16x32_bf16 v[76:79], a[108:111], a[56:59], v[76:79]
    ds_read_b128 a[56:59], v22 offset:16384
    v_mfma_f32_16x16x32_bf16 v[80:83], a[104:107], a[60:63], v[80:83]
    s_waitcnt lgkmcnt(6)
    v_mfma_f32_16x16x32_bf16 v[84:87], a[108:111], a[60:63], v[84:87]
    ds_read_b128 a[60:63], v22 offset:20480
    v_mfma_f32_16x16x32_bf16 v[88:91], a[104:107], a[64:67], v[88:91]
    buffer_load_dwordx4 v[172:175], v33, s[24:27], s66 offen offset:1024 sc1
    v_mfma_f32_16x16x32_bf16 v[92:95], a[108:111], a[64:67], v[92:95]
    ds_read_b128 a[64:67], v22 offset:24576
    v_mfma_f32_16x16x32_bf16 v[96:99], a[104:107], a[68:71], v[96:99]
    ds_read_b128 v[196:199], v28 offset:768
    v_cndmask_b32 v248, v4, 0, s[98:99]
    v_mfma_f32_16x16x32_bf16 v[100:103], a[108:111], a[68:71], v[100:103]
    ds_read_b128 a[68:71], v22 offset:28672
    v_cmp_le_i32 vcc, 8, v3
    v_mfma_f32_16x16x32_bf16 v[104:107], a[104:107], a[72:75], v[104:107]
    s_waitcnt vmcnt(9) lgkmcnt(6)
    s_add_u32 s72, s72, 8192
    v_add_u32 v5, 8, v2
    v_mfma_f32_16x16x32_bf16 v[108:111], a[108:111], a[72:75], v[108:111]
    ds_read_b128 a[72:75], v22 offset:32768
    v_cmp_gt_u32 s[98:99], 8, v5
    v_mfma_f32_16x16x32_bf16 v[40:43], a[112:115], a[40:43], v[40:43]
    buffer_load_dwordx4 a[144:147], v26, s[24:27], s72 offen sc1
    v_mfma_f32_16x16x32_bf16 v[44:47], a[116:119], a[40:43], v[44:47]
    ds_read_b128 a[40:43], v23 offset:0
    v_add_u32 v20, 0xfffee000, v20
    v_mfma_f32_16x16x32_bf16 v[48:51], a[112:115], a[44:47], v[48:51]
    v_add_u32 v21, 0xfffee000, v21
    v_add_u32 v22, 0xfffee000, v22
    v_mfma_f32_16x16x32_bf16 v[52:55], a[116:119], a[44:47], v[52:55]
    ds_read_b128 a[44:47], v23 offset:4096
    v_mfma_f32_16x16x32_bf16 v[56:59], a[112:115], a[48:51], v[56:59]
    buffer_load_dwordx4 a[148:151], v29, s[24:27], s72 offen offset:1024 sc1
    v_mfma_f32_16x16x32_bf16 v[60:63], a[116:119], a[48:51], v[60:63]
    ds_read_b128 a[48:51], v23 offset:8192
    s_waitcnt lgkmcnt(7)
    v_mfma_f32_16x16x32_bf16 v[64:67], a[112:115], a[52:55], v[64:67]
    ds_read_b128 v[200:203], v28 offset:1024
    v_cndmask_b32 v7, v4, 0, vcc
    v_mfma_f32_16x16x32_bf16 v[68:71], a[116:119], a[52:55], v[68:71]
    ds_read_b128 a[52:55], v23 offset:12288
    s_mov_b32 s55, 0x05040100
    v_mfma_f32_16x16x32_bf16 v[72:75], a[112:115], a[56:59], v[72:75]
    buffer_load_dwordx4 v[176:179], v33, s[24:27], s66 offen offset:2048 sc1
    v_mfma_f32_16x16x32_bf16 v[76:79], a[116:119], a[56:59], v[76:79]
    ds_read_b128 a[56:59], v23 offset:16384
    v_cndmask_b32 v249, v4, 0, s[98:99]
    v_mfma_f32_16x16x32_bf16 v[80:83], a[112:115], a[60:63], v[80:83]
    s_waitcnt lgkmcnt(6)
    v_cmp_le_i32 vcc, 7, v3
    v_mfma_f32_16x16x32_bf16 v[84:87], a[116:119], a[60:63], v[84:87]
    ds_read_b128 a[60:63], v23 offset:20480
    v_mfma_f32_16x16x32_bf16 v[88:91], a[112:115], a[64:67], v[88:91]
    buffer_load_dwordx4 v[180:183], v33, s[24:27], s66 offen offset:3072 sc1
    v_mfma_f32_16x16x32_bf16 v[92:95], a[116:119], a[64:67], v[92:95]
    ds_read_b128 a[64:67], v23 offset:24576
    v_mfma_f32_16x16x32_bf16 v[96:99], a[112:115], a[68:71], v[96:99]
    ds_read_b128 v[204:207], v28 offset:1280
    v_add_u32 v5, 9, v2
    v_mfma_f32_16x16x32_bf16 v[100:103], a[116:119], a[68:71], v[100:103]
    ds_read_b128 a[68:71], v23 offset:28672
    v_cmp_gt_u32 s[98:99], 8, v5
    v_mfma_f32_16x16x32_bf16 v[104:107], a[112:115], a[72:75], v[104:107]
    s_waitcnt vmcnt(11) lgkmcnt(7)
    s_add_u32 s72, s72, 8192
    v_cndmask_b32 v8, v4, 0, vcc
    v_mfma_f32_16x16x32_bf16 v[108:111], a[116:119], a[72:75], v[108:111]
    ds_read_b128 a[72:75], v23 offset:32768
    s_mov_b32 s55, 0x05040100
    v_mfma_f32_16x16x32_bf16 v[40:43], a[120:123], a[40:43], v[40:43]
    buffer_load_dwordx4 a[152:155], v26, s[24:27], s72 offen sc1
    v_mfma_f32_16x16x32_bf16 v[44:47], a[124:127], a[40:43], v[44:47]
    ds_read_b128 a[40:43], v20 offset:0
    v_add_u32 v23, 0xfffee000, v23
    v_mfma_f32_16x16x32_bf16 v[48:51], a[120:123], a[44:47], v[48:51]
    ds_read_b128 v[208:211], v28 offset:1536
    v_cndmask_b32 v250, v4, 0, s[98:99]
    v_mfma_f32_16x16x32_bf16 v[52:55], a[124:127], a[44:47], v[52:55]
    ds_read_b128 a[44:47], v20 offset:4096
    v_cmp_le_i32 vcc, 6, v3
    v_mfma_f32_16x16x32_bf16 v[56:59], a[120:123], a[48:51], v[56:59]
    buffer_load_dwordx4 a[156:159], v29, s[24:27], s72 offen offset:1024 sc1
    v_mfma_f32_16x16x32_bf16 v[60:63], a[124:127], a[48:51], v[60:63]
    ds_read_b128 a[48:51], v20 offset:8192
    s_waitcnt lgkmcnt(8)
    v_mfma_f32_16x16x32_bf16 v[64:67], a[120:123], a[52:55], v[64:67]
    v_add_u32 v5, 10, v2
    v_cmp_gt_u32 s[98:99], 8, v5
    v_mfma_f32_16x16x32_bf16 v[68:71], a[124:127], a[52:55], v[68:71]
    ds_read_b128 a[52:55], v20 offset:12288
    v_mfma_f32_16x16x32_bf16 v[72:75], a[120:123], a[56:59], v[72:75]
    buffer_load_dword v253, v13, s[24:27], s69 offen offset:12 sc1
    v_mfma_f32_16x16x32_bf16 v[76:79], a[124:127], a[56:59], v[76:79]
    ds_read_b128 a[56:59], v20 offset:16384
    v_mfma_f32_16x16x32_bf16 v[80:83], a[120:123], a[60:63], v[80:83]
    s_waitcnt lgkmcnt(6)
    v_mfma_f32_16x16x32_bf16 v[84:87], a[124:127], a[60:63], v[84:87]
    ds_read_b128 a[60:63], v20 offset:20480
    v_mfma_f32_16x16x32_bf16 v[88:91], a[120:123], a[64:67], v[88:91]
    buffer_load_dwordx4 a[0:3], v27, s[24:27], s70 offen offset:0 sc1
    v_mfma_f32_16x16x32_bf16 v[92:95], a[124:127], a[64:67], v[92:95]
    ds_read_b128 a[64:67], v20 offset:24576
    v_mfma_f32_16x16x32_bf16 v[96:99], a[120:123], a[68:71], v[96:99]
    ds_read_b128 v[212:215], v28 offset:1792
    v_cndmask_b32 v9, v4, 0, vcc
    v_mfma_f32_16x16x32_bf16 v[100:103], a[124:127], a[68:71], v[100:103]
    ds_read_b128 a[68:71], v20 offset:28672
    s_mov_b32 s55, 0x05040100
    v_mfma_f32_16x16x32_bf16 v[104:107], a[120:123], a[72:75], v[104:107]
    s_waitcnt vmcnt(12) lgkmcnt(6)
    s_add_u32 s72, s72, 8192
    v_cndmask_b32 v251, v4, 0, s[98:99]
    v_mfma_f32_16x16x32_bf16 v[108:111], a[124:127], a[72:75], v[108:111]
    ds_read_b128 a[72:75], v20 offset:32768
    v_perm_b32 v19, v7, v6, s55
    v_mfma_f32_16x16x32_bf16 v[40:43], a[128:131], a[40:43], v[40:43]
    ds_read_b128 v[216:219], v28 offset:2048
    v_perm_b32 v36, v9, v8, s55
    v_mfma_f32_16x16x32_bf16 v[44:47], a[132:135], a[40:43], v[44:47]
    ds_read_b128 a[40:43], v21 offset:0
    v_perm_b32 v37, v249, v248, s55
    v_mfma_f32_16x16x32_bf16 v[48:51], a[128:131], a[44:47], v[48:51]
    s_cmp_eq_u32 s72, s73
    s_cselect_b32 s72, s80, s72
    v_perm_b32 v254, v251, v250, s55
    v_mfma_f32_16x16x32_bf16 v[52:55], a[132:135], a[44:47], v[52:55]
    ds_read_b128 a[44:47], v21 offset:4096
    s_mov_b32 s55, 110592
    v_mfma_f32_16x16x32_bf16 v[56:59], a[128:131], a[48:51], v[56:59]
    buffer_load_dwordx4 a[160:163], v26, s[24:27], s72 offen sc1
    v_mfma_f32_16x16x32_bf16 v[60:63], a[132:135], a[48:51], v[60:63]
    ds_read_b128 a[48:51], v21 offset:8192
    s_waitcnt lgkmcnt(8)
    v_mfma_f32_16x16x32_bf16 v[64:67], a[128:131], a[52:55], v[64:67]
    v_lshl_add_u32 v2, v14, 1, s54
    v_subrev_u32 v3, 32, v2
    v_mfma_f32_16x16x32_bf16 v[68:71], a[132:135], a[52:55], v[68:71]
    ds_read_b128 a[52:55], v21 offset:12288
    v_mul_u32_u24 v2, 272, v2
    v_mfma_f32_16x16x32_bf16 v[72:75], a[128:131], a[56:59], v[72:75]
    buffer_load_dwordx4 a[164:167], v29, s[24:27], s72 offen offset:1024 sc1
    v_mfma_f32_16x16x32_bf16 v[76:79], a[132:135], a[56:59], v[76:79]
    ds_read_b128 a[56:59], v21 offset:16384
    v_max_i32 v3, 0, v3
    v_mfma_f32_16x16x32_bf16 v[80:83], a[128:131], a[60:63], v[80:83]
    s_waitcnt lgkmcnt(6)
    v_mul_u32_u24 v3, 272, v3
    v_lshl_add_u32 v4, v15, 4, s55
    v_mfma_f32_16x16x32_bf16 v[84:87], a[132:135], a[60:63], v[84:87]
    ds_read_b128 a[60:63], v21 offset:20480
    v_add_u32 v241, v4, v2
    v_mfma_f32_16x16x32_bf16 v[88:91], a[128:131], a[64:67], v[88:91]
    buffer_load_dwordx4 a[4:7], v27, s[24:27], s70 offen offset:512 sc1
    v_mfma_f32_16x16x32_bf16 v[92:95], a[132:135], a[64:67], v[92:95]
    ds_read_b128 a[64:67], v21 offset:24576
    v_add_u32 v242, v4, v3
    v_mfma_f32_16x16x32_bf16 v[96:99], a[128:131], a[68:71], v[96:99]
    s_add_u32 s72, s72, 8192
    v_lshrrev_b32 v5, 2, v1
    v_lshl_add_u32 v2, v5, 1, s54
    v_mfma_f32_16x16x32_bf16 v[100:103], a[132:135], a[68:71], v[100:103]
    ds_read_b128 a[68:71], v21 offset:28672
    v_subrev_u32 v3, 32, v2
    v_mfma_f32_16x16x32_bf16 v[104:107], a[128:131], a[72:75], v[104:107]
    s_waitcnt vmcnt(13) lgkmcnt(5)
    v_mul_u32_u24 v2, 272, v2
    v_max_i32 v3, 0, v3
    v_mfma_f32_16x16x32_bf16 v[108:111], a[132:135], a[72:75], v[108:111]
    ds_read_b128 a[72:75], v21 offset:32768
    v_mul_u32_u24 v3, 272, v3
    v_mfma_f32_16x16x32_bf16 v[40:43], a[136:139], a[40:43], v[40:43]
    buffer_load_dwordx4 a[168:171], v26, s[24:27], s72 offen sc1
    v_mfma_f32_16x16x32_bf16 v[44:47], a[140:143], a[40:43], v[44:47]
    ds_read_b128 a[40:43], v22 offset:0
    v_and_b32 v4, 3, v1
    v_mfma_f32_16x16x32_bf16 v[48:51], a[136:139], a[44:47], v[48:51]
    v_lshl_add_u32 v4, v4, 3, s55
    v_add_u32 v243, v4, v2
    v_mfma_f32_16x16x32_bf16 v[52:55], a[140:143], a[44:47], v[52:55]
    ds_read_b128 a[44:47], v22 offset:4096
    v_add_u32 v244, v4, v3
    v_mfma_f32_16x16x32_bf16 v[56:59], a[136:139], a[48:51], v[56:59]
    buffer_load_dwordx4 a[172:175], v29, s[24:27], s72 offen offset:1024 sc1
    v_mfma_f32_16x16x32_bf16 v[60:63], a[140:143], a[48:51], v[60:63]
    ds_read_b128 a[48:51], v22 offset:8192
    s_waitcnt lgkmcnt(6)
    v_mfma_f32_16x16x32_bf16 v[64:67], a[136:139], a[52:55], v[64:67]
    s_add_u32 s72, s72, 8192
    v_and_b32 v4, 1, v1
    v_mul_u32_u24 v4, 40, v4
    v_mfma_f32_16x16x32_bf16 v[68:71], a[140:143], a[52:55], v[68:71]
    ds_read_b128 a[52:55], v22 offset:12288
    v_add3_u32 v245, v4, v2, s55
    v_mfma_f32_16x16x32_bf16 v[72:75], a[136:139], a[56:59], v[72:75]
    buffer_load_dwordx4 a[176:179], v26, s[24:27], s72 offen sc1
    v_mfma_f32_16x16x32_bf16 v[76:79], a[140:143], a[56:59], v[76:79]
    ds_read_b128 a[56:59], v22 offset:16384
    v_add3_u32 v246, v4, v3, s55
    v_mfma_f32_16x16x32_bf16 v[80:83], a[136:139], a[60:63], v[80:83]
    s_waitcnt lgkmcnt(5)
    s_mov_b32 s50, -1
    s_mov_b32 s51, 0xffff
    v_mfma_f32_16x16x32_bf16 v[84:87], a[140:143], a[60:63], v[84:87]
    ds_read_b128 a[60:63], v22 offset:20480
    s_mov_b32 s12, -1
    v_mfma_f32_16x16x32_bf16 v[88:91], a[136:139], a[64:67], v[88:91]
    buffer_load_dwordx4 a[180:183], v29, s[24:27], s72 offen offset:1024 sc1
    v_mfma_f32_16x16x32_bf16 v[92:95], a[140:143], a[64:67], v[92:95]
    ds_read_b128 a[64:67], v22 offset:24576
    s_mov_b32 s13, 0
    v_mfma_f32_16x16x32_bf16 v[96:99], a[136:139], a[68:71], v[96:99]
    s_mov_b32 s74, 0xffff0000
    s_mov_b32 s75, 0xffff
    v_lshlrev_b32 v247, 7, v14
    v_mfma_f32_16x16x32_bf16 v[100:103], a[140:143], a[68:71], v[100:103]
    ds_read_b128 a[68:71], v22 offset:28672
    v_mul_u32_u24 v38, 272, v14
    v_mfma_f32_16x16x32_bf16 v[104:107], a[136:139], a[72:75], v[104:107]
    buffer_load_dwordx4 a[8:11], v27, s[24:27], s70 offen offset:1024 sc1
    v_mfma_f32_16x16x32_bf16 v[108:111], a[140:143], a[72:75], v[108:111]
    ds_read_b128 a[72:75], v22 offset:32768
    s_waitcnt vmcnt(14) lgkmcnt(6)
    v_mfma_f32_16x16x32_bf16 v[40:43], a[144:147], a[40:43], v[40:43]
    s_add_u32 s72, s72, 8192
    v_add_u32 v20, 0x9000, v20
    v_add_u32 v21, 0x9000, v21
    v_mfma_f32_16x16x32_bf16 v[44:47], a[148:151], a[40:43], v[44:47]
    ds_read_b128 a[40:43], v23 offset:0
    v_add_u32 v22, 0x9000, v22
    v_mfma_f32_16x16x32_bf16 v[48:51], a[144:147], a[44:47], v[48:51]
    buffer_load_dwordx4 a[184:187], v26, s[24:27], s72 offen sc1
    v_mfma_f32_16x16x32_bf16 v[52:55], a[148:151], a[44:47], v[52:55]
    ds_read_b128 a[44:47], v23 offset:4096
    s_lshl_b32 s55, s3, 6
    v_mfma_f32_16x16x32_bf16 v[56:59], a[144:147], a[48:51], v[56:59]
    s_waitcnt lgkmcnt(5)
    s_add_u32 s55, s55, 110592
    v_lshl_add_u32 v38, v15, 3, v38
    v_mfma_f32_16x16x32_bf16 v[60:63], a[148:151], a[48:51], v[60:63]
    ds_read_b128 a[48:51], v23 offset:8192
    v_add_u32 v38, s55, v38
    v_mfma_f32_16x16x32_bf16 v[64:67], a[144:147], a[52:55], v[64:67]
    buffer_load_dwordx4 a[188:191], v29, s[24:27], s72 offen offset:1024 sc1
    v_mfma_f32_16x16x32_bf16 v[68:71], a[148:151], a[52:55], v[68:71]
    ds_read_b128 a[52:55], v23 offset:12288
    v_add_u32 v2, 0, v1
    v_mfma_f32_16x16x32_bf16 v[72:75], a[144:147], a[56:59], v[72:75]
    v_mul_u32_u24 v3, 205, v2
    v_lshrrev_b32 v3, 11, v3
    v_mfma_f32_16x16x32_bf16 v[76:79], a[148:151], a[56:59], v[76:79]
    ds_read_b128 a[56:59], v23 offset:16384
    v_mul_u32_u24 v3, 2400, v3
    v_mfma_f32_16x16x32_bf16 v[80:83], a[144:147], a[60:63], v[80:83]
    s_waitcnt lgkmcnt(5)
    v_lshl_add_u32 v16, v2, 4, v3
    v_add_u32 v2, 64, v1
    v_mfma_f32_16x16x32_bf16 v[84:87], a[148:151], a[60:63], v[84:87]
    ds_read_b128 a[60:63], v23 offset:20480
    v_mul_u32_u24 v3, 205, v2
    v_mfma_f32_16x16x32_bf16 v[88:91], a[144:147], a[64:67], v[88:91]
    buffer_load_dwordx4 a[12:15], v27, s[24:27], s70 offen offset:1536 sc1
    v_mfma_f32_16x16x32_bf16 v[92:95], a[148:151], a[64:67], v[92:95]
    ds_read_b128 a[64:67], v23 offset:24576
    v_lshrrev_b32 v3, 11, v3
    v_mfma_f32_16x16x32_bf16 v[96:99], a[144:147], a[68:71], v[96:99]
    s_add_u32 s72, s72, 8192
    v_mul_u32_u24 v3, 2400, v3
    v_lshl_add_u32 v17, v2, 4, v3
    v_mfma_f32_16x16x32_bf16 v[100:103], a[148:151], a[68:71], v[100:103]
    ds_read_b128 a[68:71], v23 offset:28672
    v_add_u32 v2, 128, v1
    v_mfma_f32_16x16x32_bf16 v[104:107], a[144:147], a[72:75], v[104:107]
    s_waitcnt vmcnt(13) lgkmcnt(5)
    s_cmp_eq_u32 s72, s73
    s_cselect_b32 s72, s80, s72
    v_mfma_f32_16x16x32_bf16 v[108:111], a[148:151], a[72:75], v[108:111]
    ds_read_b128 a[72:75], v23 offset:32768
    v_min_u32 v2, 159, v2
    v_mfma_f32_16x16x32_bf16 v[40:43], a[152:155], a[40:43], v[40:43]
    buffer_load_dwordx4 a[192:195], v26, s[24:27], s72 offen sc1
    v_mfma_f32_16x16x32_bf16 v[44:47], a[156:159], a[40:43], v[44:47]
    ds_read_b128 a[40:43], v20 offset:0
    v_add_u32 v23, 0x9000, v23
    v_mfma_f32_16x16x32_bf16 v[48:51], a[152:155], a[44:47], v[48:51]
    v_mul_u32_u24 v3, 205, v2
    v_lshrrev_b32 v3, 11, v3
    v_mfma_f32_16x16x32_bf16 v[52:55], a[156:159], a[44:47], v[52:55]
    ds_read_b128 a[44:47], v20 offset:4096
    v_mul_u32_u24 v3, 2400, v3
    v_mfma_f32_16x16x32_bf16 v[56:59], a[152:155], a[48:51], v[56:59]
    s_waitcnt lgkmcnt(5)
    v_lshl_add_u32 v18, v2, 4, v3
    v_xor_b32 v2, s6, v187
    v_mfma_f32_16x16x32_bf16 v[60:63], a[156:159], a[48:51], v[60:63]
    ds_read_b128 a[48:51], v20 offset:8192
    v_bitop3_b32 v2, v2, v191, s6 bitop3:0xf6
    v_mfma_f32_16x16x32_bf16 v[64:67], a[152:155], a[52:55], v[64:67]
    v_bitop3_b32 v2, v2, v195, s6 bitop3:0xf6
    v_bitop3_b32 v2, v2, v199, s6 bitop3:0xf6
    v_mfma_f32_16x16x32_bf16 v[68:71], a[156:159], a[52:55], v[68:71]
    ds_read_b128 a[52:55], v20 offset:12288
    v_bitop3_b32 v2, v2, v203, s6 bitop3:0xf6
    v_mfma_f32_16x16x32_bf16 v[72:75], a[152:155], a[56:59], v[72:75]
    buffer_load_dwordx4 a[196:199], v29, s[24:27], s72 offen offset:1024 sc1
    v_mfma_f32_16x16x32_bf16 v[76:79], a[156:159], a[56:59], v[76:79]
    ds_read_b128 a[56:59], v20 offset:16384
    v_bitop3_b32 v2, v2, v207, s6 bitop3:0xf6
    v_mfma_f32_16x16x32_bf16 v[80:83], a[152:155], a[60:63], v[80:83]
    s_waitcnt lgkmcnt(5)
    v_bitop3_b32 v2, v2, v211, s6 bitop3:0xf6
    v_bitop3_b32 v2, v2, v215, s6 bitop3:0xf6
    v_mfma_f32_16x16x32_bf16 v[84:87], a[156:159], a[60:63], v[84:87]
    ds_read_b128 a[60:63], v20 offset:20480
    v_bitop3_b32 v2, v2, v219, s6 bitop3:0xf6
    v_mfma_f32_16x16x32_bf16 v[88:91], a[152:155], a[64:67], v[88:91]
    s_waitcnt vmcnt(14)
    v_bitop3_b32 v2, v2, v253, s6 bitop3:0xf6
    v_cmp_ne_u32 vcc, 0, v2
    v_mfma_f32_16x16x32_bf16 v[92:95], a[156:159], a[64:67], v[92:95]
    ds_read_b128 a[64:67], v20 offset:24576
    s_lshl_b32 s52, s3, 8
    v_mfma_f32_16x16x32_bf16 v[96:99], a[152:155], a[68:71], v[96:99]
    s_add_u32 s72, s72, 8192
    s_add_u32 s52, s52, 150016
    v_lshl_add_u32 v12, v14, 4, s52
    v_mfma_f32_16x16x32_bf16 v[100:103], a[156:159], a[68:71], v[100:103]
    ds_read_b128 a[68:71], v20 offset:28672
    v_lshl_add_u32 v5, v15, 6, s52
    v_mfma_f32_16x16x32_bf16 v[104:107], a[152:155], a[72:75], v[104:107]
    s_waitcnt vmcnt(11) lgkmcnt(5)
    s_cbranch_vccnz L_slow
L_slow_back:
    v_add_f32 v168, v168, v172
    v_mfma_f32_16x16x32_bf16 v[108:111], a[156:159], a[72:75], v[108:111]
    ds_read_b128 a[72:75], v20 offset:32768
    v_add_f32 v169, v169, v173
    s_barrier
    v_mfma_f32_16x16x32_bf16 v[40:43], a[160:163], a[40:43], v[40:43]
    buffer_load_dwordx4 a[200:203], v26, s[24:27], s72 offen sc1
    v_mfma_f32_16x16x32_bf16 v[44:47], a[164:167], a[40:43], v[44:47]
    ds_read_b128 a[40:43], v21 offset:0
    v_add_f32 v170, v170, v174
    v_mfma_f32_16x16x32_bf16 v[48:51], a[160:163], a[44:47], v[48:51]
    v_add_f32 v171, v171, v175
    v_add_f32 v176, v176, v180
    v_mfma_f32_16x16x32_bf16 v[52:55], a[164:167], a[44:47], v[52:55]
    ds_read_b128 a[44:47], v21 offset:4096
    v_add_f32 v177, v177, v181
    v_mfma_f32_16x16x32_bf16 v[56:59], a[160:163], a[48:51], v[56:59]
    buffer_load_dwordx4 a[204:207], v29, s[24:27], s72 offen offset:1024 sc1
    v_mfma_f32_16x16x32_bf16 v[60:63], a[164:167], a[48:51], v[60:63]
    ds_read_b128 a[48:51], v21 offset:8192
    s_waitcnt lgkmcnt(6)
    v_mfma_f32_16x16x32_bf16 v[64:67], a[160:163], a[52:55], v[64:67]
    s_add_u32 m0, s49, 77824
    s_add_u32 s7, s79, s77
    v_add_f32 v178, v178, v182
    v_mfma_f32_16x16x32_bf16 v[68:71], a[164:167], a[52:55], v[68:71]
    ds_read_b128 a[52:55], v21 offset:12288
    v_add_f32 v179, v179, v183
    v_mfma_f32_16x16x32_bf16 v[72:75], a[160:163], a[56:59], v[72:75]
    buffer_load_dwordx4 v236, s[8:11], s7 offen offset:0 lds
    v_mfma_f32_16x16x32_bf16 v[76:79], a[164:167], a[56:59], v[76:79]
    ds_read_b128 a[56:59], v21 offset:16384
    v_add_f32 v168, v168, v176
    v_mfma_f32_16x16x32_bf16 v[80:83], a[160:163], a[60:63], v[80:83]
    s_waitcnt lgkmcnt(5)
    v_add_f32 v169, v169, v177
    v_add_f32 v170, v170, v178
    v_mfma_f32_16x16x32_bf16 v[84:87], a[164:167], a[60:63], v[84:87]
    ds_read_b128 a[60:63], v21 offset:20480
    v_add_f32 v171, v171, v179
    v_mfma_f32_16x16x32_bf16 v[88:91], a[160:163], a[64:67], v[88:91]
    buffer_load_dwordx4 v237, s[8:11], s7 offen offset:1024 lds
    v_mfma_f32_16x16x32_bf16 v[92:95], a[164:167], a[64:67], v[92:95]
    ds_read_b128 a[64:67], v21 offset:24576
    v_lshl_add_u32 v12, v15, 2, v12
    v_mfma_f32_16x16x32_bf16 v[96:99], a[160:163], a[68:71], v[96:99]
    s_add_u32 s72, s72, 8192
    v_xor_b32 v3, s88, v189
    v_mfma_f32_16x16x32_bf16 v[100:103], a[164:167], a[68:71], v[100:103]
    ds_read_b128 a[68:71], v21 offset:28672
    v_mfma_f32_16x16x32_bf16 v[104:107], a[160:163], a[72:75], v[104:107]
    s_waitcnt vmcnt(12) lgkmcnt(5)
    v_permlane32_swap_b32 v168, v170
    v_mfma_f32_16x16x32_bf16 v[108:111], a[164:167], a[72:75], v[108:111]
    ds_read_b128 a[72:75], v21 offset:32768
    v_bitop3_b32 v3, v3, v193, s88 bitop3:0xf6
    v_mfma_f32_16x16x32_bf16 v[40:43], a[168:171], a[40:43], v[40:43]
    buffer_load_dwordx4 a[208:211], v26, s[24:27], s72 offen sc1
    v_mfma_f32_16x16x32_bf16 v[44:47], a[172:175], a[40:43], v[44:47]
    ds_read_b128 a[40:43], v22 offset:0
    v_mfma_f32_16x16x32_bf16 v[48:51], a[168:171], a[44:47], v[48:51]
    v_permlane32_swap_b32 v169, v171
    v_mfma_f32_16x16x32_bf16 v[52:55], a[172:175], a[44:47], v[52:55]
    ds_read_b128 a[44:47], v22 offset:4096
    v_add_f32 v168, v168, v170
    v_mfma_f32_16x16x32_bf16 v[56:59], a[168:171], a[48:51], v[56:59]
    buffer_load_dwordx4 a[212:215], v29, s[24:27], s72 offen offset:1024 sc1
    v_mfma_f32_16x16x32_bf16 v[60:63], a[172:175], a[48:51], v[60:63]
    ds_read_b128 a[48:51], v22 offset:8192
    s_waitcnt lgkmcnt(6)
    v_mfma_f32_16x16x32_bf16 v[64:67], a[168:171], a[52:55], v[64:67]
    s_add_u32 s72, s72, 8192
    v_add_f32 v169, v169, v171
    v_bitop3_b32 v3, v3, v197, s88 bitop3:0xf6
    v_mfma_f32_16x16x32_bf16 v[68:71], a[172:175], a[52:55], v[68:71]
    ds_read_b128 a[52:55], v22 offset:12288
    v_bitop3_b32 v3, v3, v201, s88 bitop3:0xf6
    v_mfma_f32_16x16x32_bf16 v[72:75], a[168:171], a[56:59], v[72:75]
    buffer_load_dwordx4 a[216:219], v26, s[24:27], s72 offen sc1
    v_mfma_f32_16x16x32_bf16 v[76:79], a[172:175], a[56:59], v[76:79]
    ds_read_b128 a[56:59], v22 offset:16384
    v_mfma_f32_16x16x32_bf16 v[80:83], a[168:171], a[60:63], v[80:83]
    s_waitcnt lgkmcnt(5)
    v_permlane16_swap_b32 v168, v169
    v_mfma_f32_16x16x32_bf16 v[84:87], a[172:175], a[60:63], v[84:87]
    ds_read_b128 a[60:63], v22 offset:20480
    v_add_f32 v168, v168, v169
    v_mfma_f32_16x16x32_bf16 v[88:91], a[168:171], a[64:67], v[88:91]
    buffer_load_dwordx4 a[220:223], v29, s[24:27], s72 offen offset:1024 sc1
    v_mfma_f32_16x16x32_bf16 v[92:95], a[172:175], a[64:67], v[92:95]
    ds_read_b128 a[64:67], v22 offset:24576
    v_mfma_f32_16x16x32_bf16 v[96:99], a[168:171], a[68:71], v[96:99]
    ds_write_b32 v12, v168
    v_mfma_f32_16x16x32_bf16 v[100:103], a[172:175], a[68:71], v[100:103]
    ds_read_b128 a[68:71], v22 offset:28672
    v_bitop3_b32 v3, v3, v205, s88 bitop3:0xf6
    v_mfma_f32_16x16x32_bf16 v[104:107], a[168:171], a[72:75], v[104:107]
    buffer_load_dwordx4 v238, s[8:11], s7 offen offset:2048 lds
    v_mfma_f32_16x16x32_bf16 v[108:111], a[172:175], a[72:75], v[108:111]
    ds_read_b128 a[72:75], v22 offset:32768
    s_waitcnt vmcnt(15) lgkmcnt(7)
    v_mfma_f32_16x16x32_bf16 v[40:43], a[176:179], a[40:43], v[40:43]
    v_add_u32 v20, 0x12000, v20
    v_add_u32 v21, 0x12000, v21
    v_mfma_f32_16x16x32_bf16 v[44:47], a[180:183], a[40:43], v[44:47]
    ds_read_b128 a[40:43], v23 offset:0
    v_add_u32 v22, 0x12000, v22
    v_mfma_f32_16x16x32_bf16 v[48:51], a[176:179], a[44:47], v[48:51]
    buffer_load_dwordx4 v239, s[8:11], s7 offen offset:3072 lds
    v_mfma_f32_16x16x32_bf16 v[52:55], a[180:183], a[44:47], v[52:55]
    ds_read_b128 a[44:47], v23 offset:4096
    s_add_u32 s72, s72, 8192
    v_mfma_f32_16x16x32_bf16 v[56:59], a[176:179], a[48:51], v[56:59]
    s_waitcnt lgkmcnt(6)
    s_cmp_eq_u32 s72, s73
    s_cselect_b32 s72, s80, s72
    v_mfma_f32_16x16x32_bf16 v[60:63], a[180:183], a[48:51], v[60:63]
    ds_read_b128 a[48:51], v23 offset:8192
    v_mfma_f32_16x16x32_bf16 v[64:67], a[176:179], a[52:55], v[64:67]
    buffer_load_dwordx4 a[224:227], v26, s[24:27], s72 offen sc1
    v_mfma_f32_16x16x32_bf16 v[68:71], a[180:183], a[52:55], v[68:71]
    ds_read_b128 a[52:55], v23 offset:12288
    v_mfma_f32_16x16x32_bf16 v[72:75], a[176:179], a[56:59], v[72:75]
    ds_read_b128 v[220:223], v5 offset:0
    v_bitop3_b32 v3, v3, v209, s88 bitop3:0xf6
    v_mfma_f32_16x16x32_bf16 v[76:79], a[180:183], a[56:59], v[76:79]
    ds_read_b128 a[56:59], v23 offset:16384
    v_mfma_f32_16x16x32_bf16 v[80:83], a[176:179], a[60:63], v[80:83]
    buffer_load_dwordx4 a[228:231], v29, s[24:27], s72 offen offset:1024 sc1
    v_mfma_f32_16x16x32_bf16 v[84:87], a[180:183], a[60:63], v[84:87]
    ds_read_b128 a[60:63], v23 offset:20480
    s_waitcnt lgkmcnt(7)
    v_mfma_f32_16x16x32_bf16 v[88:91], a[176:179], a[64:67], v[88:91]
    ds_read_b128 v[224:227], v5 offset:16
    s_add_u32 m0, m0, 4096
    v_mfma_f32_16x16x32_bf16 v[92:95], a[180:183], a[64:67], v[92:95]
    ds_read_b128 a[64:67], v23 offset:24576
    s_add_u32 s7, s7, 20480
    v_mfma_f32_16x16x32_bf16 v[96:99], a[176:179], a[68:71], v[96:99]
    buffer_load_dwordx4 v236, s[8:11], s7 offen offset:0 lds
    v_mfma_f32_16x16x32_bf16 v[100:103], a[180:183], a[68:71], v[100:103]
    ds_read_b128 a[68:71], v23 offset:28672
    v_bitop3_b32 v3, v3, v213, s88 bitop3:0xf6
    v_mfma_f32_16x16x32_bf16 v[104:107], a[176:179], a[72:75], v[104:107]
    s_waitcnt vmcnt(16) lgkmcnt(7)
    v_mfma_f32_16x16x32_bf16 v[108:111], a[180:183], a[72:75], v[108:111]
    ds_read_b128 a[72:75], v23 offset:32768
    v_mfma_f32_16x16x32_bf16 v[40:43], a[184:187], a[40:43], v[40:43]
    buffer_load_dwordx4 v237, s[8:11], s7 offen offset:1024 lds
    v_mfma_f32_16x16x32_bf16 v[44:47], a[188:191], a[40:43], v[44:47]
    ds_read_b128 a[40:43], v20 offset:0
    s_add_u32 s72, s72, 8192
    v_mfma_f32_16x16x32_bf16 v[48:51], a[184:187], a[44:47], v[48:51]
    v_add_u32 v23, 0x12000, v23
    v_mfma_f32_16x16x32_bf16 v[52:55], a[188:191], a[44:47], v[52:55]
    ds_read_b128 a[44:47], v20 offset:4096
    v_mfma_f32_16x16x32_bf16 v[56:59], a[184:187], a[48:51], v[56:59]
    buffer_load_dwordx4 a[232:235], v26, s[24:27], s72 offen sc1
    v_mfma_f32_16x16x32_bf16 v[60:63], a[188:191], a[48:51], v[60:63]
    ds_read_b128 a[48:51], v20 offset:8192
    s_waitcnt lgkmcnt(7)
    v_mfma_f32_16x16x32_bf16 v[64:67], a[184:187], a[52:55], v[64:67]
    ds_read_b128 v[228:231], v5 offset:32
    v_bitop3_b32 v3, v3, v217, s88 bitop3:0xf6
    v_mfma_f32_16x16x32_bf16 v[68:71], a[188:191], a[52:55], v[68:71]
    ds_read_b128 a[52:55], v20 offset:12288
    v_mfma_f32_16x16x32_bf16 v[72:75], a[184:187], a[56:59], v[72:75]
    buffer_load_dwordx4 a[236:239], v29, s[24:27], s72 offen offset:1024 sc1
    v_mfma_f32_16x16x32_bf16 v[76:79], a[188:191], a[56:59], v[76:79]
    ds_read_b128 a[56:59], v20 offset:16384
    v_mfma_f32_16x16x32_bf16 v[80:83], a[184:187], a[60:63], v[80:83]
    s_waitcnt lgkmcnt(6)
    v_mfma_f32_16x16x32_bf16 v[84:87], a[188:191], a[60:63], v[84:87]
    ds_read_b128 a[60:63], v20 offset:20480
    v_mfma_f32_16x16x32_bf16 v[88:91], a[184:187], a[64:67], v[88:91]
    buffer_load_dwordx4 v238, s[8:11], s7 offen offset:2048 lds
    v_mfma_f32_16x16x32_bf16 v[92:95], a[188:191], a[64:67], v[92:95]
    ds_read_b128 a[64:67], v20 offset:24576
    v_mfma_f32_16x16x32_bf16 v[96:99], a[184:187], a[68:71], v[96:99]
    ds_read_b128 v[232:235], v5 offset:48
    v_cmp_ne_u32 vcc, 0, v3
    v_mfma_f32_16x16x32_bf16 v[100:103], a[188:191], a[68:71], v[100:103]
    ds_read_b128 a[68:71], v20 offset:28672
    v_mfma_f32_16x16x32_bf16 v[104:107], a[184:187], a[72:75], v[104:107]
    buffer_load_dwordx4 v239, s[8:11], s7 offen offset:3072 lds
    v_mfma_f32_16x16x32_bf16 v[108:111], a[188:191], a[72:75], v[108:111]
    ds_read_b128 a[72:75], v20 offset:32768
    s_waitcnt vmcnt(18) lgkmcnt(8)
    v_mfma_f32_16x16x32_bf16 v[40:43], a[192:195], a[40:43], v[40:43]
    s_add_u32 s72, s72, 8192
    s_cmp_eq_u64 vcc, 0
    s_cselect_b32 s88, 1, 0
    v_mfma_f32_16x16x32_bf16 v[44:47], a[196:199], a[40:43], v[44:47]
    ds_read_b128 a[40:43], v21 offset:0
    v_mul_u32_u24 v13, 0x30000, v15
    v_mfma_f32_16x16x32_bf16 v[48:51], a[192:195], a[44:47], v[48:51]
    buffer_load_dwordx4 a[240:243], v26, s[24:27], s72 offen sc1
    v_mfma_f32_16x16x32_bf16 v[52:55], a[196:199], a[44:47], v[52:55]
    ds_read_b128 a[44:47], v21 offset:4096
    v_lshl_add_u32 v13, v14, 4, v13
    v_mfma_f32_16x16x32_bf16 v[56:59], a[192:195], a[48:51], v[56:59]
    s_waitcnt lgkmcnt(6)
    v_accvgpr_write_b32 a80, -1
    v_accvgpr_write_b32 a81, -1
    v_mfma_f32_16x16x32_bf16 v[60:63], a[196:199], a[48:51], v[60:63]
    ds_read_b128 a[48:51], v21 offset:8192
    v_accvgpr_write_b32 a82, -1
    v_mfma_f32_16x16x32_bf16 v[64:67], a[192:195], a[52:55], v[64:67]
    buffer_load_dwordx4 a[244:247], v29, s[24:27], s72 offen offset:1024 sc1
    v_mfma_f32_16x16x32_bf16 v[68:71], a[196:199], a[52:55], v[68:71]
    ds_read_b128 a[52:55], v21 offset:12288
    s_add_u32 m0, s78, 73728
    v_mfma_f32_16x16x32_bf16 v[72:75], a[192:195], a[56:59], v[72:75]
    v_accvgpr_write_b32 a83, -1
    v_fma_f32 v112, v184, v220, v221
    v_mfma_f32_16x16x32_bf16 v[76:79], a[196:199], a[56:59], v[76:79]
    ds_read_b128 a[56:59], v21 offset:16384
    v_fma_f32 v113, v184, v224, v225
    v_mfma_f32_16x16x32_bf16 v[80:83], a[192:195], a[60:63], v[80:83]
    buffer_load_dwordx4 v240, s[8:11], s77 offen lds
    v_mfma_f32_16x16x32_bf16 v[84:87], a[196:199], a[60:63], v[84:87]
    ds_read_b128 a[60:63], v21 offset:20480
    s_waitcnt lgkmcnt(6)
    v_mfma_f32_16x16x32_bf16 v[88:91], a[192:195], a[64:67], v[88:91]
    v_fma_f32 v114, v184, v228, v229
    v_fma_f32 v115, v184, v232, v233
    v_mfma_f32_16x16x32_bf16 v[92:95], a[196:199], a[64:67], v[92:95]
    ds_read_b128 a[64:67], v21 offset:24576
    v_fma_f32 v116, v184, v222, v223
    v_mfma_f32_16x16x32_bf16 v[96:99], a[192:195], a[68:71], v[96:99]
    s_mov_b64 exec, 3
    global_load_dword a21, v247, s[0:1] sc1
    s_mov_b64 exec, -1
    v_mfma_f32_16x16x32_bf16 v[100:103], a[196:199], a[68:71], v[100:103]
    ds_read_b128 a[68:71], v21 offset:28672
    v_fma_f32 v117, v184, v226, v227
    v_mfma_f32_16x16x32_bf16 v[104:107], a[192:195], a[72:75], v[104:107]
    s_waitcnt vmcnt(20) lgkmcnt(5)
    s_add_u32 s72, s72, 8192
    v_fma_f32 v118, v184, v230, v231
    v_mfma_f32_16x16x32_bf16 v[108:111], a[196:199], a[72:75], v[108:111]
    ds_read_b128 a[72:75], v21 offset:32768
    v_fma_f32 v119, v184, v234, v235
    v_mfma_f32_16x16x32_bf16 v[40:43], a[200:203], a[40:43], v[40:43]
    buffer_load_dwordx4 a[248:251], v26, s[24:27], s72 offen sc1
    v_mfma_f32_16x16x32_bf16 v[44:47], a[204:207], a[40:43], v[44:47]
    ds_read_b128 a[40:43], v22 offset:0
    v_fma_f32 v120, v188, v220, v221
    v_mfma_f32_16x16x32_bf16 v[48:51], a[200:203], a[44:47], v[48:51]
    v_fma_f32 v121, v188, v224, v225
    v_fma_f32 v122, v188, v228, v229
    v_mfma_f32_16x16x32_bf16 v[52:55], a[204:207], a[44:47], v[52:55]
    ds_read_b128 a[44:47], v22 offset:4096
    v_fma_f32 v123, v188, v232, v233
    v_mfma_f32_16x16x32_bf16 v[56:59], a[200:203], a[48:51], v[56:59]
    buffer_load_dwordx4 a[252:255], v29, s[24:27], s72 offen offset:1024 sc1
    v_mfma_f32_16x16x32_bf16 v[60:63], a[204:207], a[48:51], v[60:63]
    ds_read_b128 a[48:51], v22 offset:8192
    s_waitcnt lgkmcnt(6)
    v_mfma_f32_16x16x32_bf16 v[64:67], a[200:203], a[52:55], v[64:67]
    s_add_u32 m0, s63, 0
    s_add_u32 s7, s64, 0
    v_fma_f32 v124, v188, v222, v223
    v_mfma_f32_16x16x32_bf16 v[68:71], a[204:207], a[52:55], v[68:71]
    ds_read_b128 a[52:55], v22 offset:12288
    v_fma_f32 v125, v188, v226, v227
    v_mfma_f32_16x16x32_bf16 v[72:75], a[200:203], a[56:59], v[72:75]
    buffer_load_dwordx4 v26, s[24:27], s7 offen offset:0 sc1 lds
    v_mfma_f32_16x16x32_bf16 v[76:79], a[204:207], a[56:59], v[76:79]
    ds_read_b128 a[56:59], v22 offset:16384
    v_fma_f32 v126, v188, v230, v231
    v_mfma_f32_16x16x32_bf16 v[80:83], a[200:203], a[60:63], v[80:83]
    s_waitcnt lgkmcnt(5)
    v_fma_f32 v127, v188, v234, v235
    v_fma_f32 v128, v192, v220, v221
    v_mfma_f32_16x16x32_bf16 v[84:87], a[204:207], a[60:63], v[84:87]
    ds_read_b128 a[60:63], v22 offset:20480
    v_fma_f32 v129, v192, v224, v225
    v_mfma_f32_16x16x32_bf16 v[88:91], a[200:203], a[64:67], v[88:91]
    buffer_load_dwordx4 v26, s[24:27], s7 offen offset:1024 sc1 lds
    v_mfma_f32_16x16x32_bf16 v[92:95], a[204:207], a[64:67], v[92:95]
    ds_read_b128 a[64:67], v22 offset:24576
    v_fma_f32 v130, v192, v228, v229
    v_mfma_f32_16x16x32_bf16 v[96:99], a[200:203], a[68:71], v[96:99]
    v_fma_f32 v131, v192, v232, v233
    v_fma_f32 v132, v192, v222, v223
    v_mfma_f32_16x16x32_bf16 v[100:103], a[204:207], a[68:71], v[100:103]
    ds_read_b128 a[68:71], v22 offset:28672
    v_fma_f32 v133, v192, v226, v227
    v_mfma_f32_16x16x32_bf16 v[104:107], a[200:203], a[72:75], v[104:107]
    buffer_load_dwordx4 v26, s[24:27], s7 offen offset:2048 sc1 lds
    v_mfma_f32_16x16x32_bf16 v[108:111], a[204:207], a[72:75], v[108:111]
    ds_read_b128 a[72:75], v22 offset:32768
    s_waitcnt vmcnt(21) lgkmcnt(6)
    v_mfma_f32_16x16x32_bf16 v[40:43], a[208:211], a[40:43], v[40:43]
    v_add_u32 v20, 0xffff7000, v20
    v_add_u32 v21, 0xffff7000, v21
    v_mfma_f32_16x16x32_bf16 v[44:47], a[212:215], a[40:43], v[44:47]
    ds_read_b128 a[40:43], v23 offset:0
    v_add_u32 v22, 0xffff7000, v22
    v_mfma_f32_16x16x32_bf16 v[48:51], a[208:211], a[44:47], v[48:51]
    buffer_load_dwordx4 v26, s[24:27], s7 offen offset:3072 sc1 lds
    v_mfma_f32_16x16x32_bf16 v[52:55], a[212:215], a[44:47], v[52:55]
    ds_read_b128 a[44:47], v23 offset:4096
    v_fma_f32 v134, v192, v230, v231
    v_mfma_f32_16x16x32_bf16 v[56:59], a[208:211], a[48:51], v[56:59]
    s_waitcnt lgkmcnt(5)
    s_add_u32 m0, s63, 4096
    s_add_u32 s7, s64, 4096
    v_mfma_f32_16x16x32_bf16 v[60:63], a[212:215], a[48:51], v[60:63]
    ds_read_b128 a[48:51], v23 offset:8192
    v_fma_f32 v135, v192, v234, v235
    v_mfma_f32_16x16x32_bf16 v[64:67], a[208:211], a[52:55], v[64:67]
    buffer_load_dwordx4 v26, s[24:27], s7 offen offset:0 sc1 lds
    v_mfma_f32_16x16x32_bf16 v[68:71], a[212:215], a[52:55], v[68:71]
    ds_read_b128 a[52:55], v23 offset:12288
    v_fma_f32 v136, v196, v220, v221
    v_mfma_f32_16x16x32_bf16 v[72:75], a[208:211], a[56:59], v[72:75]
    v_fma_f32 v137, v196, v224, v225
    v_fma_f32 v138, v196, v228, v229
    v_mfma_f32_16x16x32_bf16 v[76:79], a[212:215], a[56:59], v[76:79]
    ds_read_b128 a[56:59], v23 offset:16384
    v_fma_f32 v139, v196, v232, v233
    v_mfma_f32_16x16x32_bf16 v[80:83], a[208:211], a[60:63], v[80:83]
    s_waitcnt lgkmcnt(5)
    v_fma_f32 v140, v196, v222, v223
    v_fma_f32 v141, v196, v226, v227
    v_mfma_f32_16x16x32_bf16 v[84:87], a[212:215], a[60:63], v[84:87]
    ds_read_b128 a[60:63], v23 offset:20480
    v_fma_f32 v142, v196, v230, v231
    v_mfma_f32_16x16x32_bf16 v[88:91], a[208:211], a[64:67], v[88:91]
    buffer_load_dwordx4 v26, s[24:27], s7 offen offset:1024 sc1 lds
    v_mfma_f32_16x16x32_bf16 v[92:95], a[212:215], a[64:67], v[92:95]
    ds_read_b128 a[64:67], v23 offset:24576
    v_fma_f32 v143, v196, v234, v235
    v_mfma_f32_16x16x32_bf16 v[96:99], a[208:211], a[68:71], v[96:99]
    v_fma_f32 v144, v200, v220, v221
    v_fma_f32 v145, v200, v224, v225
    v_mfma_f32_16x16x32_bf16 v[100:103], a[212:215], a[68:71], v[100:103]
    ds_read_b128 a[68:71], v23 offset:28672
    v_fma_f32 v146, v200, v228, v229
    v_mfma_f32_16x16x32_bf16 v[104:107], a[208:211], a[72:75], v[104:107]
    s_waitcnt vmcnt(22) lgkmcnt(5)
    v_fma_f32 v147, v200, v232, v233
    v_fma_f32 v148, v200, v222, v223
    v_mfma_f32_16x16x32_bf16 v[108:111], a[212:215], a[72:75], v[108:111]
    ds_read_b128 a[72:75], v23 offset:32768
    v_fma_f32 v149, v200, v226, v227
    v_mfma_f32_16x16x32_bf16 v[40:43], a[216:219], a[40:43], v[40:43]
    buffer_load_dwordx4 v26, s[24:27], s7 offen offset:2048 sc1 lds
    v_mfma_f32_16x16x32_bf16 v[44:47], a[220:223], a[40:43], v[44:47]
    v_add_u32 v23, 0xffff7000, v23
    v_fma_f32 v150, v200, v230, v231
    v_mfma_f32_16x16x32_bf16 v[48:51], a[216:219], a[44:47], v[48:51]
    v_fma_f32 v151, v200, v234, v235
    v_fma_f32 v152, v204, v220, v221
    v_mfma_f32_16x16x32_bf16 v[52:55], a[220:223], a[44:47], v[52:55]
    v_fma_f32 v153, v204, v224, v225
    v_fma_f32 v154, v204, v228, v229
    v_mfma_f32_16x16x32_bf16 v[56:59], a[216:219], a[48:51], v[56:59]
    s_waitcnt lgkmcnt(3)
    v_fma_f32 v155, v204, v232, v233
    v_fma_f32 v156, v204, v222, v223
    v_mfma_f32_16x16x32_bf16 v[60:63], a[220:223], a[48:51], v[60:63]
    v_fma_f32 v157, v204, v226, v227
    v_fma_f32 v158, v204, v230, v231
    v_mfma_f32_16x16x32_bf16 v[64:67], a[216:219], a[52:55], v[64:67]
    buffer_load_dwordx4 v26, s[24:27], s7 offen offset:3072 sc1 lds
    v_mfma_f32_16x16x32_bf16 v[68:71], a[220:223], a[52:55], v[68:71]
    s_waitcnt vmcnt(11)
    s_waitcnt lgkmcnt(0)
    s_barrier
    ds_read_b128 a[40:43], v20 offset:0
    ds_read_b128 a[44:47], v21 offset:0
    ds_read_b128 a[48:51], v22 offset:0
    ds_read_b128 a[52:55], v23 offset:0
    v_mfma_f32_16x16x32_bf16 v[72:75], a[216:219], a[56:59], v[72:75]
    s_add_u32 m0, s63, 8192
    v_fma_f32 v159, v204, v234, v235
    v_fma_f32 v160, v208, v220, v221
    v_mfma_f32_16x16x32_bf16 v[76:79], a[220:223], a[56:59], v[76:79]
    ds_read_b128 a[56:59], v20 offset:4096
    v_fma_f32 v161, v208, v224, v225
    v_mfma_f32_16x16x32_bf16 v[80:83], a[216:219], a[60:63], v[80:83]
    s_add_u32 s7, s64, 8192
    v_fma_f32 v162, v208, v228, v229
    v_fma_f32 v163, v208, v232, v233
    v_mfma_f32_16x16x32_bf16 v[84:87], a[220:223], a[60:63], v[84:87]
    ds_read_b128 a[60:63], v21 offset:4096
    v_fma_f32 v164, v208, v222, v223
    v_mfma_f32_16x16x32_bf16 v[88:91], a[216:219], a[64:67], v[88:91]
    buffer_load_dwordx4 v26, s[24:27], s7 offen offset:0 sc1 lds
    v_mfma_f32_16x16x32_bf16 v[92:95], a[220:223], a[64:67], v[92:95]
    ds_read_b128 a[64:67], v22 offset:4096
    v_fma_f32 v165, v208, v226, v227
    v_mfma_f32_16x16x32_bf16 v[96:99], a[216:219], a[68:71], v[96:99]
    v_fma_f32 v166, v208, v230, v231
    v_fma_f32 v167, v208, v234, v235
    v_mfma_f32_16x16x32_bf16 v[100:103], a[220:223], a[68:71], v[100:103]
    ds_read_b128 a[68:71], v23 offset:4096
    v_fma_f32 v168, v212, v220, v221
    v_mfma_f32_16x16x32_bf16 v[104:107], a[216:219], a[72:75], v[104:107]
    s_waitcnt lgkmcnt(5)
    v_fma_f32 v169, v212, v224, v225
    v_fma_f32 v170, v212, v228, v229
    v_mfma_f32_16x16x32_bf16 v[108:111], a[220:223], a[72:75], v[108:111]
    ds_read_b128 a[72:75], v20 offset:8192
    v_fma_f32 v171, v212, v232, v233
    v_mfma_f32_16x16x32_bf16 v[40:43], a[224:227], a[40:43], v[40:43]
    s_mov_b64 exec, 0x03ff03ff
    buffer_store_dwordx4 a[80:83], v13, s[24:27], s92 offen sc0 sc1
    s_mov_b64 exec, -1
    v_mfma_f32_16x16x32_bf16 v[44:47], a[228:231], a[40:43], v[44:47]
    ds_read_b128 a[40:43], v21 offset:8192
    v_fma_f32 v172, v212, v222, v223
    v_mfma_f32_16x16x32_bf16 v[40:43], a[232:235], a[44:47], v[40:43]
    v_fma_f32 v173, v212, v226, v227
    v_fma_f32 v174, v212, v230, v231
    v_mfma_f32_16x16x32_bf16 v[44:47], a[236:239], a[44:47], v[44:47]
    ds_read_b128 a[44:47], v22 offset:8192
    v_fma_f32 v175, v212, v234, v235
    v_mfma_f32_16x16x32_bf16 v[40:43], a[240:243], a[48:51], v[40:43]
    s_waitcnt vmcnt(10) lgkmcnt(5)
    v_fma_f32 v176, v216, v220, v221
    v_fma_f32 v177, v216, v224, v225
    v_mfma_f32_16x16x32_bf16 v[44:47], a[244:247], a[48:51], v[44:47]
    ds_read_b128 a[48:51], v23 offset:8192
    v_fma_f32 v178, v216, v228, v229
    v_mfma_f32_16x16x32_bf16 v[40:43], a[248:251], a[52:55], v[40:43]
    v_fma_f32 v179, v216, v232, v233
    v_fma_f32 v180, v216, v222, v223
    v_mfma_f32_16x16x32_bf16 v[44:47], a[252:255], a[52:55], v[44:47]
    ds_read_b128 a[52:55], v20 offset:12288
    v_fma_f32 v181, v216, v226, v227
    v_mfma_f32_16x16x32_bf16 v[48:51], a[224:227], a[56:59], v[48:51]
    buffer_load_dword a16, v10, s[36:39], 0 offen
    v_mfma_f32_16x16x32_bf16 v[52:55], a[228:231], a[56:59], v[52:55]
    ds_read_b128 a[56:59], v21 offset:12288
    v_fma_f32 v182, v216, v230, v231
    v_mfma_f32_16x16x32_bf16 v[48:51], a[232:235], a[60:63], v[48:51]
    s_waitcnt lgkmcnt(5)
    v_fma_f32 v40, v40, v186, v112
    v_fma_f32 v41, v41, v186, v113
    v_fma_f32 v42, v42, v186, v114
    v_mfma_f32_16x16x32_bf16 v[52:55], a[236:239], a[60:63], v[52:55]
    ds_read_b128 a[60:63], v22 offset:12288
    v_fma_f32 v43, v43, v186, v115
    v_mfma_f32_16x16x32_bf16 v[48:51], a[240:243], a[64:67], v[48:51]
    v_fma_f32 v44, v44, v186, v116
    v_fma_f32 v45, v45, v186, v117
    v_mfma_f32_16x16x32_bf16 v[52:55], a[244:247], a[64:67], v[52:55]
    ds_read_b128 a[64:67], v23 offset:12288
    v_fma_f32 v46, v46, v186, v118
    v_mfma_f32_16x16x32_bf16 v[48:51], a[248:251], a[68:71], v[48:51]
    v_fma_f32 v47, v47, v186, v119
    v_cvt_pk_bf16_f32 v40, v40, v41
    v_mfma_f32_16x16x32_bf16 v[52:55], a[252:255], a[68:71], v[52:55]
    ds_read_b128 a[68:71], v20 offset:16384
    v_cvt_pk_bf16_f32 v41, v42, v43
    v_mfma_f32_16x16x32_bf16 v[56:59], a[224:227], a[72:75], v[56:59]
    s_waitcnt lgkmcnt(5)
    v_cvt_pk_bf16_f32 v42, v44, v45
    v_cvt_pk_bf16_f32 v43, v46, v47
    v_mfma_f32_16x16x32_bf16 v[60:63], a[228:231], a[72:75], v[60:63]
    ds_read_b128 a[72:75], v21 offset:16384
    v_fma_f32 v183, v216, v234, v235
    v_mfma_f32_16x16x32_bf16 v[56:59], a[232:235], a[40:43], v[56:59]
    s_mov_b64 exec, 3
    global_load_dword a21, v247, s[0:1] sc1
    s_mov_b64 exec, -1
    v_fma_f32 v48, v48, v190, v120
    v_mfma_f32_16x16x32_bf16 v[60:63], a[236:239], a[40:43], v[60:63]
    ds_read_b128 a[40:43], v22 offset:16384
    v_fma_f32 v49, v49, v190, v121
    v_fma_f32 v50, v50, v190, v122
    v_mfma_f32_16x16x32_bf16 v[56:59], a[240:243], a[44:47], v[56:59]
    ds_write_b64 v38, v[40:41] offset:0
    v_fma_f32 v51, v51, v190, v123
    v_mfma_f32_16x16x32_bf16 v[60:63], a[244:247], a[44:47], v[60:63]
    ds_read_b128 a[44:47], v23 offset:16384
    v_fma_f32 v52, v52, v190, v124
    v_mfma_f32_16x16x32_bf16 v[56:59], a[248:251], a[48:51], v[56:59]
    ds_write_b64 v38, v[42:43] offset:32
    v_mfma_f32_16x16x32_bf16 v[60:63], a[252:255], a[48:51], v[60:63]
    ds_read_b128 a[48:51], v20 offset:20480
    s_waitcnt lgkmcnt(8)
    v_mfma_f32_16x16x32_bf16 v[64:67], a[224:227], a[52:55], v[64:67]
    v_fma_f32 v53, v53, v190, v125
    v_fma_f32 v54, v54, v190, v126
    v_mfma_f32_16x16x32_bf16 v[68:71], a[228:231], a[52:55], v[68:71]
    ds_read_b128 a[52:55], v21 offset:20480
    v_fma_f32 v55, v55, v190, v127
    v_mfma_f32_16x16x32_bf16 v[64:67], a[232:235], a[56:59], v[64:67]
    v_cvt_pk_bf16_f32 v48, v48, v49
    v_cvt_pk_bf16_f32 v49, v50, v51
    v_cvt_pk_bf16_f32 v50, v52, v53
    v_mfma_f32_16x16x32_bf16 v[68:71], a[236:239], a[56:59], v[68:71]
    ds_read_b128 a[56:59], v22 offset:20480
    v_cvt_pk_bf16_f32 v51, v54, v55
    v_mfma_f32_16x16x32_bf16 v[64:67], a[240:243], a[60:63], v[64:67]
    ds_write_b64 v38, v[48:49] offset:4352
    v_fma_f32 v56, v56, v194, v128
    v_mfma_f32_16x16x32_bf16 v[68:71], a[244:247], a[60:63], v[68:71]
    ds_read_b128 a[60:63], v23 offset:20480
    s_waitcnt lgkmcnt(9)
    v_fma_f32 v57, v57, v194, v129
    v_mfma_f32_16x16x32_bf16 v[64:67], a[248:251], a[64:67], v[64:67]
    ds_write_b64 v38, v[50:51] offset:4384
    v_fma_f32 v58, v58, v194, v130
    v_mfma_f32_16x16x32_bf16 v[68:71], a[252:255], a[64:67], v[68:71]
    ds_read_b128 a[64:67], v20 offset:24576
    v_fma_f32 v59, v59, v194, v131
    v_mfma_f32_16x16x32_bf16 v[72:75], a[224:227], a[68:71], v[72:75]
    v_fma_f32 v60, v60, v194, v132
    v_fma_f32 v61, v61, v194, v133
    v_mfma_f32_16x16x32_bf16 v[76:79], a[228:231], a[68:71], v[76:79]
    ds_read_b128 a[68:71], v21 offset:24576
    v_fma_f32 v62, v62, v194, v134
    v_mfma_f32_16x16x32_bf16 v[72:75], a[232:235], a[72:75], v[72:75]
    s_waitcnt lgkmcnt(7)
    v_fma_f32 v63, v63, v194, v135
    v_cvt_pk_bf16_f32 v56, v56, v57
    v_cvt_pk_bf16_f32 v57, v58, v59
    v_mfma_f32_16x16x32_bf16 v[76:79], a[236:239], a[72:75], v[76:79]
    ds_read_b128 a[72:75], v22 offset:24576
    v_cvt_pk_bf16_f32 v58, v60, v61
    v_cvt_pk_bf16_f32 v59, v62, v63
    v_mfma_f32_16x16x32_bf16 v[72:75], a[240:243], a[40:43], v[72:75]
    s_mov_b32 exec_hi, 0x1ff
    buffer_load_dword a20, v34, s[24:27], 0 offen
    s_mov_b64 exec, -1
    v_fma_f32 v64, v64, v198, v136
    v_mfma_f32_16x16x32_bf16 v[76:79], a[244:247], a[40:43], v[76:79]
    ds_read_b128 a[40:43], v23 offset:24576
    v_fma_f32 v65, v65, v198, v137
    v_fma_f32 v66, v66, v198, v138
    v_mfma_f32_16x16x32_bf16 v[72:75], a[248:251], a[44:47], v[72:75]
    ds_write_b64 v38, v[56:57] offset:8704
    v_fma_f32 v67, v67, v198, v139
    v_mfma_f32_16x16x32_bf16 v[76:79], a[252:255], a[44:47], v[76:79]
    ds_read_b128 a[44:47], v20 offset:28672
    v_fma_f32 v68, v68, v198, v140
    v_mfma_f32_16x16x32_bf16 v[80:83], a[224:227], a[48:51], v[80:83]
    ds_write_b64 v38, v[58:59] offset:8736
    v_mfma_f32_16x16x32_bf16 v[84:87], a[228:231], a[48:51], v[84:87]
    ds_read_b128 a[48:51], v21 offset:28672
    s_waitcnt lgkmcnt(9)
    v_mfma_f32_16x16x32_bf16 v[80:83], a[232:235], a[52:55], v[80:83]
    v_fma_f32 v69, v69, v198, v141
    v_fma_f32 v70, v70, v198, v142
    v_fma_f32 v71, v71, v198, v143
    v_mfma_f32_16x16x32_bf16 v[84:87], a[236:239], a[52:55], v[84:87]
    ds_read_b128 a[52:55], v22 offset:28672
    v_cvt_pk_bf16_f32 v64, v64, v65
    v_cvt_pk_bf16_f32 v65, v66, v67
    v_mfma_f32_16x16x32_bf16 v[80:83], a[240:243], a[56:59], v[80:83]
    v_cvt_pk_bf16_f32 v66, v68, v69
    v_cvt_pk_bf16_f32 v67, v70, v71
    v_mfma_f32_16x16x32_bf16 v[84:87], a[244:247], a[56:59], v[84:87]
    ds_read_b128 a[56:59], v23 offset:28672
    v_fma_f32 v72, v72, v202, v144
    v_fma_f32 v73, v73, v202, v145
    v_mfma_f32_16x16x32_bf16 v[80:83], a[248:251], a[60:63], v[80:83]
    ds_write_b64 v38, v[64:65] offset:13056
    v_fma_f32 v74, v74, v202, v146
    v_mfma_f32_16x16x32_bf16 v[84:87], a[252:255], a[60:63], v[84:87]
    ds_read_b128 a[60:63], v20 offset:32768
    s_waitcnt lgkmcnt(9)
    v_fma_f32 v75, v75, v202, v147
    v_mfma_f32_16x16x32_bf16 v[88:91], a[224:227], a[64:67], v[88:91]
    ds_write_b64 v38, v[66:67] offset:13088
    v_mfma_f32_16x16x32_bf16 v[92:95], a[228:231], a[64:67], v[92:95]
    ds_read_b128 a[64:67], v21 offset:32768
    v_fma_f32 v76, v76, v202, v148
    v_mfma_f32_16x16x32_bf16 v[88:91], a[232:235], a[68:71], v[88:91]
    s_add_u32 m0, s58, 0
    v_fma_f32 v77, v77, v202, v149
    v_fma_f32 v78, v78, v202, v150
    v_fma_f32 v79, v79, v202, v151
    v_mfma_f32_16x16x32_bf16 v[92:95], a[236:239], a[68:71], v[92:95]
    ds_read_b128 a[68:71], v22 offset:32768
    v_cvt_pk_bf16_f32 v72, v72, v73
    v_cvt_pk_bf16_f32 v73, v74, v75
    v_mfma_f32_16x16x32_bf16 v[88:91], a[240:243], a[72:75], v[88:91]
    s_waitcnt lgkmcnt(7)
    v_cvt_pk_bf16_f32 v74, v76, v77
    v_cvt_pk_bf16_f32 v75, v78, v79
    v_mfma_f32_16x16x32_bf16 v[92:95], a[244:247], a[72:75], v[92:95]
    ds_read_b128 a[72:75], v23 offset:32768
    v_fma_f32 v80, v80, v206, v152
    v_fma_f32 v81, v81, v206, v153
    v_mfma_f32_16x16x32_bf16 v[88:91], a[248:251], a[40:43], v[88:91]
    buffer_load_dwordx4 v16, s[8:11], s71 offen lds
    v_fma_f32 v82, v82, v206, v154
    v_mfma_f32_16x16x32_bf16 v[92:95], a[252:255], a[40:43], v[92:95]
    ds_write_b64 v38, v[72:73] offset:17408
    v_fma_f32 v83, v83, v206, v155
    v_mfma_f32_16x16x32_bf16 v[96:99], a[224:227], a[44:47], v[96:99]
    ds_write_b64 v38, v[74:75] offset:17440
    v_mfma_f32_16x16x32_bf16 v[100:103], a[228:231], a[44:47], v[100:103]
    v_fma_f32 v84, v84, v206, v156
    v_fma_f32 v85, v85, v206, v157
    v_mfma_f32_16x16x32_bf16 v[96:99], a[232:235], a[48:51], v[96:99]
    s_waitcnt lgkmcnt(6)
    v_fma_f32 v86, v86, v206, v158
    v_fma_f32 v87, v87, v206, v159
    v_cvt_pk_bf16_f32 v80, v80, v81
    v_mfma_f32_16x16x32_bf16 v[100:103], a[236:239], a[48:51], v[100:103]
    v_cvt_pk_bf16_f32 v81, v82, v83
    v_cvt_pk_bf16_f32 v82, v84, v85
    v_cvt_pk_bf16_f32 v83, v86, v87
    v_mfma_f32_16x16x32_bf16 v[96:99], a[240:243], a[52:55], v[96:99]
    ds_write_b64 v38, v[80:81] offset:21760
    v_fma_f32 v88, v88, v210, v160
    v_mfma_f32_16x16x32_bf16 v[100:103], a[244:247], a[52:55], v[100:103]
    ds_write_b64 v38, v[82:83] offset:21792
    v_fma_f32 v89, v89, v210, v161
    v_mfma_f32_16x16x32_bf16 v[96:99], a[248:251], a[56:59], v[96:99]
    v_fma_f32 v90, v90, v210, v162
    v_fma_f32 v91, v91, v210, v163
    v_mfma_f32_16x16x32_bf16 v[100:103], a[252:255], a[56:59], v[100:103]
    v_fma_f32 v92, v92, v210, v164
    v_fma_f32 v93, v93, v210, v165
    v_mfma_f32_16x16x32_bf16 v[104:107], a[224:227], a[60:63], v[104:107]
    s_waitcnt lgkmcnt(4)
    v_fma_f32 v94, v94, v210, v166
    v_fma_f32 v95, v95, v210, v167
    v_mfma_f32_16x16x32_bf16 v[108:111], a[228:231], a[60:63], v[108:111]
    v_cvt_pk_bf16_f32 v88, v88, v89
    v_cvt_pk_bf16_f32 v89, v90, v91
    v_mfma_f32_16x16x32_bf16 v[104:107], a[232:235], a[64:67], v[104:107]
    v_cvt_pk_bf16_f32 v90, v92, v93
    v_cvt_pk_bf16_f32 v91, v94, v95
    v_mfma_f32_16x16x32_bf16 v[108:111], a[236:239], a[64:67], v[108:111]
    ds_write_b64 v38, v[88:89] offset:26112
    v_fma_f32 v96, v96, v214, v168
    v_mfma_f32_16x16x32_bf16 v[104:107], a[240:243], a[68:71], v[104:107]
    ds_write_b64 v38, v[90:91] offset:26144
    v_fma_f32 v97, v97, v214, v169
    v_mfma_f32_16x16x32_bf16 v[108:111], a[244:247], a[68:71], v[108:111]
    v_fma_f32 v98, v98, v214, v170
    v_fma_f32 v99, v99, v214, v171
    v_mfma_f32_16x16x32_bf16 v[104:107], a[248:251], a[72:75], v[104:107]
    v_fma_f32 v100, v100, v214, v172
    v_fma_f32 v101, v101, v214, v173
    v_mfma_f32_16x16x32_bf16 v[108:111], a[252:255], a[72:75], v[108:111]
    v_fma_f32 v102, v102, v214, v174
    v_fma_f32 v103, v103, v214, v175
    v_cvt_pk_bf16_f32 v96, v96, v97
    v_cvt_pk_bf16_f32 v97, v98, v99
    v_cvt_pk_bf16_f32 v98, v100, v101
    v_cvt_pk_bf16_f32 v99, v102, v103
    ds_write_b64 v38, v[96:97] offset:30464
    ds_write_b64 v38, v[98:99] offset:30496
    v_pk_fma_f32 v[104:105], v[104:105], v[218:219], v[176:177] op_sel_hi:[1,0,1]
    v_pk_fma_f32 v[106:107], v[106:107], v[218:219], v[178:179] op_sel_hi:[1,0,1]
    v_pk_fma_f32 v[108:109], v[108:109], v[218:219], v[180:181] op_sel_hi:[1,0,1]
    v_pk_fma_f32 v[110:111], v[110:111], v[218:219], v[182:183] op_sel_hi:[1,0,1]
    v_cvt_pk_bf16_f32 v104, v104, v105
    v_cvt_pk_bf16_f32 v105, v106, v107
    v_cvt_pk_bf16_f32 v106, v108, v109
    v_cvt_pk_bf16_f32 v107, v110, v111
    ds_write_b64 v38, v[104:105] offset:34816
    ds_write_b64 v38, v[106:107] offset:34848
    s_add_u32 m0, s58, 1024
    s_nop 0
    buffer_load_dwordx4 v17, s[8:11], s71 offen lds
    s_waitcnt vmcnt(6)
    s_waitcnt lgkmcnt(0)
    s_barrier
    ds_read_b128 v[40:43], v241 offset:0
    ds_read_b128 v[56:59], v242 offset:80
    ds_read_b128 v[72:75], v241 offset:80
    ds_read_b128 v[44:47], v241 offset:32
    ds_read_b128 v[60:63], v242 offset:112
    ds_read_b128 v[76:79], v241 offset:112
    ds_read_b128 v[48:51], v241 offset:272
    ds_read_b128 v[64:67], v242 offset:352
    ds_read_b128 v[80:83], v241 offset:352
    ds_read_b128 v[52:55], v241 offset:304
    ds_read_b128 v[68:71], v242 offset:384
    ds_read_b128 v[84:87], v241 offset:384
    s_add_u32 m0, s58, 2048
    s_nop 0
    buffer_load_dwordx4 v18, s[8:11], s71 offen lds
    s_add_u32 m0, s63, 36864
    s_add_u32 s7, s64, 36864
    buffer_load_dwordx4 v26, s[24:27], s7 offen offset:0 sc1 lds
    v_mov_b32 v184, 0x3f803f80
    v_mov_b32 v185, 0x3f803f80
    v_mov_b32 v186, 0x3f803f80
    v_mov_b32 v187, 0x3f803f80
    s_waitcnt lgkmcnt(11)
    v_cndmask_b32 v40, 0, v40, s[50:51]
    v_cndmask_b32 v41, 0, v41, s[50:51]
    v_cndmask_b32 v42, 0, v42, s[12:13]
    v_cndmask_b32 v43, 0, v43, s[12:13]
    s_waitcnt lgkmcnt(8)
    v_cndmask_b32 v44, 0, v44, s[74:75]
    v_cndmask_b32 v45, 0, v45, s[74:75]
    v_cndmask_b32 v46, 0, v46, s[50:51]
    v_cndmask_b32 v47, 0, v47, s[50:51]
    buffer_load_dwordx4 v26, s[24:27], s7 offen offset:1024 sc1 lds
    s_waitcnt lgkmcnt(5)
    v_cndmask_b32 v48, 0, v48, s[50:51]
    v_cndmask_b32 v49, 0, v49, s[50:51]
    v_cndmask_b32 v50, 0, v50, s[12:13]
    v_cndmask_b32 v51, 0, v51, s[12:13]
    s_waitcnt lgkmcnt(2)
    v_cndmask_b32 v52, 0, v52, s[74:75]
    v_cndmask_b32 v53, 0, v53, s[74:75]
    v_cndmask_b32 v54, 0, v54, s[50:51]
    v_cndmask_b32 v55, 0, v55, s[50:51]
    v_mfma_f32_16x16x32_bf16 v[144:147], v[56:59], v[40:43], v[6:9]
    v_mfma_f32_16x16x32_bf16 v[160:163], v[72:75], v[40:43], v[248:251]
    v_mfma_f32_16x16x32_bf16 v[148:151], v[60:63], v[44:47], v[6:9]
    v_mfma_f32_16x16x32_bf16 v[164:167], v[76:79], v[44:47], v[248:251]
    buffer_load_dwordx4 v26, s[24:27], s7 offen offset:2048 sc1 lds
    v_mfma_f32_16x16x32_bf16 v[152:155], v[64:67], v[48:51], v[6:9]
    v_mfma_f32_16x16x32_bf16 v[168:171], v[80:83], v[48:51], v[248:251]
    s_waitcnt lgkmcnt(1)
    v_mfma_f32_16x16x32_bf16 v[156:159], v[68:71], v[52:55], v[6:9]
    s_waitcnt lgkmcnt(0)
    v_mfma_f32_16x16x32_bf16 v[172:175], v[84:87], v[52:55], v[248:251]
    ds_read_b64_tr_b16 v[88:89], v244 offset:160
    ds_read_b64_tr_b16 v[90:91], v243 offset:160
    ds_read_b64_tr_b16 v[92:93], v244 offset:200
    ds_read_b64_tr_b16 v[94:95], v243 offset:200
    ds_read_b64_tr_b16 v[104:105], v246 offset:192
    ds_read_b64_tr_b16 v[106:107], v245 offset:192
    ds_read_b64_tr_b16 v[96:97], v244 offset:432
    ds_read_b64_tr_b16 v[98:99], v243 offset:432
    buffer_load_dwordx4 v26, s[24:27], s7 offen offset:3072 sc1 lds
    ds_read_b64_tr_b16 v[100:101], v244 offset:472
    ds_read_b64_tr_b16 v[102:103], v243 offset:472
    ds_read_b64_tr_b16 v[108:109], v246 offset:464
    ds_read_b64_tr_b16 v[110:111], v245 offset:464
    v_mul_u32_u24 v4, 1280, v15
    v_lshl_add_u32 v4, v14, 4, v4
    v_add_u32 v6, 61440, v4
    v_max_f32 v144, v144, v160
    v_max_f32 v145, v145, v161
    v_max_f32 v146, v146, v162
    v_max_f32 v147, v147, v163
    v_max_f32 v148, v148, v164
    s_add_u32 m0, s63, 40960
    s_add_u32 s7, s64, 40960
    buffer_load_dwordx4 v26, s[24:27], s7 offen offset:0 sc1 lds
    v_max_f32 v149, v149, v165
    v_max_f32 v150, v150, v166
    v_max_f32 v151, v151, v167
    v_max_f32 v152, v152, v168
    v_max_f32 v153, v153, v169
    v_max_f32 v154, v154, v170
    v_max_f32 v155, v155, v171
    v_max_f32 v156, v156, v172
    v_max_f32 v157, v157, v173
    v_max_f32 v158, v158, v174
    v_max_f32 v159, v159, v175
    v_max3_f32 v176, v144, v145, v146
    buffer_load_dwordx4 v26, s[24:27], s7 offen offset:1024 sc1 lds
    v_max3_f32 v177, v148, v149, v150
    v_max3_f32 v178, v152, v153, v154
    v_max3_f32 v179, v156, v157, v158
    v_max_f32 v176, v176, v147
    v_max_f32 v177, v177, v151
    v_max_f32 v178, v178, v155
    v_max_f32 v179, v179, v159
    v_mov_b32 v180, v176
    v_mov_b32 v181, v177
    v_mov_b32 v182, v178
    v_mov_b32 v183, v179
    v_permlane16_swap_b32 v176, v180
    buffer_load_dwordx4 v26, s[24:27], s7 offen offset:2048 sc1 lds
    v_permlane16_swap_b32 v177, v181
    v_permlane16_swap_b32 v178, v182
    v_permlane16_swap_b32 v179, v183
    v_max_f32 v176, v176, v180
    v_max_f32 v177, v177, v181
    v_max_f32 v178, v178, v182
    v_max_f32 v179, v179, v183
    v_mov_b32 v180, v176
    v_mov_b32 v181, v177
    v_mov_b32 v182, v178
    v_mov_b32 v183, v179
    v_permlane32_swap_b32 v176, v180
    buffer_load_dwordx4 v26, s[24:27], s7 offen offset:3072 sc1 lds
    v_permlane32_swap_b32 v177, v181
    v_permlane32_swap_b32 v178, v182
    v_permlane32_swap_b32 v179, v183
    v_max_f32 v176, v176, v180
    v_max_f32 v177, v177, v181
    v_max_f32 v178, v178, v182
    v_max_f32 v179, v179, v183
    s_mov_b32 s55, 0x3ea52b5c
    v_mul_f32 v176, s55, v176
    v_mul_f32 v177, s55, v177
    v_mul_f32 v178, s55, v178
    v_mul_f32 v179, s55, v179
    s_add_u32 m0, s63, 45056
    s_add_u32 s7, s64, 45056
    buffer_load_dwordx4 v26, s[24:27], s7 offen offset:0 sc1 lds
    v_fma_f32 v144, v144, s55, -v176
    v_fma_f32 v145, v145, s55, -v176
    v_fma_f32 v146, v146, s55, -v176
    v_fma_f32 v147, v147, s55, -v176
    v_fma_f32 v148, v148, s55, -v177
    v_fma_f32 v149, v149, s55, -v177
    v_fma_f32 v150, v150, s55, -v177
    v_fma_f32 v151, v151, s55, -v177
    v_fma_f32 v152, v152, s55, -v178
    v_fma_f32 v153, v153, s55, -v178
    v_fma_f32 v154, v154, s55, -v178
    v_fma_f32 v155, v155, s55, -v178
    s_mul_i32 s63, s3, 7168
    s_add_u32 s64, s60, s63
    s_add_u32 m0, s63, 73728
    s_add_u32 s7, s64, 73728
    buffer_load_dwordx4 v26, s[24:27], s7 offen offset:0 sc1 lds
    v_fma_f32 v156, v156, s55, -v179
    v_fma_f32 v157, v157, s55, -v179
    v_fma_f32 v158, v158, s55, -v179
    v_fma_f32 v159, v159, s55, -v179
    v_exp_f32 v144, v144
    v_exp_f32 v145, v145
    v_exp_f32 v146, v146
    v_exp_f32 v147, v147
    v_exp_f32 v148, v148
    v_exp_f32 v149, v149
    v_exp_f32 v150, v150
    v_exp_f32 v151, v151
    buffer_load_dwordx4 v26, s[24:27], s7 offen offset:1024 sc1 lds
    v_exp_f32 v152, v152
    v_exp_f32 v153, v153
    v_exp_f32 v154, v154
    v_exp_f32 v155, v155
    v_exp_f32 v156, v156
    v_exp_f32 v157, v157
    v_exp_f32 v158, v158
    v_exp_f32 v159, v159
    v_cvt_pk_bf16_f32 v144, v144, v145
    v_cvt_pk_bf16_f32 v145, v146, v147
    v_cvt_pk_bf16_f32 v148, v148, v149
    v_cvt_pk_bf16_f32 v149, v150, v151
    buffer_load_dwordx4 v26, s[24:27], s7 offen offset:2048 sc1 lds
    v_cvt_pk_bf16_f32 v152, v152, v153
    v_cvt_pk_bf16_f32 v153, v154, v155
    v_cvt_pk_bf16_f32 v156, v156, v157
    v_cvt_pk_bf16_f32 v157, v158, v159
    v_bfi_b32 v160, v19, 0, v144
    v_bfi_b32 v161, v36, 0, v145
    v_bfi_b32 v162, v37, 0, v144
    v_bfi_b32 v163, v254, 0, v145
    v_bfi_b32 v164, v19, 0, v148
    v_bfi_b32 v165, v36, 0, v149
    v_bfi_b32 v166, v37, 0, v148
    v_bfi_b32 v167, v254, 0, v149
    buffer_load_dwordx4 v26, s[24:27], s7 offen offset:3072 sc1 lds
    v_bfi_b32 v168, v19, 0, v152
    v_bfi_b32 v169, v36, 0, v153
    v_bfi_b32 v170, v37, 0, v152
    v_bfi_b32 v171, v254, 0, v153
    v_bfi_b32 v172, v19, 0, v156
    v_bfi_b32 v173, v36, 0, v157
    v_bfi_b32 v174, v37, 0, v156
    v_bfi_b32 v175, v254, 0, v157
    v_mfma_f32_16x16x32_bf16 v[72:75], v[184:187], v[160:163], 0
    ds_read_b128 a[36:39], v4 offset:0
    v_mfma_f32_16x16x32_bf16 v[76:79], v[184:187], v[164:167], 0
    ds_read_b128 a[40:43], v4 offset:256
    v_mfma_f32_16x16x32_bf16 v[80:83], v[184:187], v[168:171], 0
    ds_read_b128 a[44:47], v4 offset:512
    v_mfma_f32_16x16x32_bf16 v[84:87], v[184:187], v[172:175], 0
    s_add_u32 m0, s63, 77824
    s_add_u32 s7, s64, 77824
    buffer_load_dwordx4 v26, s[24:27], s7 offen offset:0 sc1 lds
    ds_read_b128 a[48:51], v4 offset:768
    s_waitcnt lgkmcnt(14)
    v_mfma_f32_16x16x32_bf16 v[40:43], v[88:91], v[160:163], 0
    ds_read_b128 a[52:55], v4 offset:1024
    s_waitcnt lgkmcnt(13)
    v_mfma_f32_16x16x32_bf16 v[44:47], v[92:95], v[164:167], 0
    ds_read_b128 a[56:59], v4 offset:5120
    s_waitcnt lgkmcnt(10)
    v_mfma_f32_16x16x32_bf16 v[48:51], v[96:99], v[168:171], 0
    ds_read_b128 a[60:63], v4 offset:5376
    s_waitcnt lgkmcnt(9)
    v_mfma_f32_16x16x32_bf16 v[52:55], v[100:103], v[172:175], 0
    ds_read_b128 a[64:67], v4 offset:5632
    v_mfma_f32_16x16x32_bf16 v[56:59], v[104:107], v[160:163], 0
    ds_read_b128 a[68:71], v4 offset:5888
    v_mfma_f32_16x16x32_bf16 v[60:63], v[104:107], v[164:167], 0
    ds_read_b128 a[72:75], v4 offset:6144
    s_waitcnt lgkmcnt(10)
    v_mfma_f32_16x16x32_bf16 v[64:67], v[108:111], v[168:171], 0
    ds_read_b128 a[76:79], v4 offset:10240
    v_mfma_f32_16x16x32_bf16 v[68:71], v[108:111], v[172:175], 0
    ds_read_b128 a[80:83], v4 offset:10496
    v_rcp_f32 v72, v72
    v_rcp_f32 v76, v76
    v_rcp_f32 v80, v80
    v_rcp_f32 v84, v84
    buffer_load_dwordx4 v26, s[24:27], s7 offen offset:1024 sc1 lds
    v_pk_mul_f32 v[40:41], v[40:41], v[72:73] op_sel_hi:[1,0]
    v_pk_mul_f32 v[42:43], v[42:43], v[72:73] op_sel_hi:[1,0]
    v_pk_mul_f32 v[44:45], v[44:45], v[76:77] op_sel_hi:[1,0]
    v_pk_mul_f32 v[46:47], v[46:47], v[76:77] op_sel_hi:[1,0]
    v_pk_mul_f32 v[48:49], v[48:49], v[80:81] op_sel_hi:[1,0]
    v_pk_mul_f32 v[50:51], v[50:51], v[80:81] op_sel_hi:[1,0]
    v_pk_mul_f32 v[52:53], v[52:53], v[84:85] op_sel_hi:[1,0]
    v_pk_mul_f32 v[54:55], v[54:55], v[84:85] op_sel_hi:[1,0]
    v_cvt_pk_bf16_f32 v144, v40, v41
    v_cvt_pk_bf16_f32 v145, v42, v43
    v_cvt_pk_bf16_f32 v146, v44, v45
    v_cvt_pk_bf16_f32 v147, v46, v47
    buffer_load_dwordx4 v26, s[24:27], s7 offen offset:2048 sc1 lds
    v_cvt_pk_bf16_f32 v148, v48, v49
    v_cvt_pk_bf16_f32 v149, v50, v51
    v_cvt_pk_bf16_f32 v150, v52, v53
    v_cvt_pk_bf16_f32 v151, v54, v55
    s_add_u32 s55, s91, 20480
    s_cmp_eq_u32 s88, 0
    s_cbranch_scc1 L_gs_8
    buffer_store_dwordx4 v[144:147], v24, s[24:27], s91 offen
    buffer_store_dwordx4 v[148:151], v24, s[24:27], s55 offen
    s_branch L_ge_9
L_gs_8:
    buffer_store_dwordx4 v[144:147], v24, s[24:27], s91 offen sc0 sc1
    buffer_store_dwordx4 v[148:151], v24, s[24:27], s55 offen sc0 sc1
L_ge_9:
    s_nop 1
    v_cmp_eq_u32 vcc, 1, v15
    s_nop 1
    v_cndmask_b32 v56, v56, v60, vcc
    v_cndmask_b32 v57, v57, v61, vcc
    v_cndmask_b32 v58, v58, v62, vcc
    v_cndmask_b32 v59, v59, v63, vcc
    v_cndmask_b32 v72, v72, v76, vcc
    v_cmp_eq_u32 vcc, 2, v15
    s_nop 1
    v_cndmask_b32 v56, v56, v64, vcc
    v_cndmask_b32 v57, v57, v65, vcc
    v_cndmask_b32 v58, v58, v66, vcc
    v_cndmask_b32 v59, v59, v67, vcc
    v_cndmask_b32 v72, v72, v80, vcc
    v_cmp_eq_u32 vcc, 3, v15
    s_nop 1
    v_cndmask_b32 v56, v56, v68, vcc
    v_cndmask_b32 v57, v57, v69, vcc
    v_cndmask_b32 v58, v58, v70, vcc
    v_cndmask_b32 v59, v59, v71, vcc
    v_cndmask_b32 v72, v72, v84, vcc
    v_pk_mul_f32 v[56:57], v[56:57], v[72:73] op_sel_hi:[1,0]
    v_pk_mul_f32 v[58:59], v[58:59], v[72:73] op_sel_hi:[1,0]
    v_cvt_pk_bf16_f32 v152, v56, v57
    v_cvt_pk_bf16_f32 v153, v58, v59
    s_cmp_eq_u32 s88, 0
    s_cbranch_scc1 L_gs_10
    buffer_store_dwordx2 v[152:153], v25, s[24:27], s91 offen
    s_branch L_ge_11
L_gs_10:
    buffer_store_dwordx2 v[152:153], v25, s[24:27], s91 offen sc0 sc1
L_ge_11:
    s_nop 1
    v_accvgpr_read_b32 v184, a0
    v_accvgpr_read_b32 v185, a1
    v_accvgpr_read_b32 v186, a2
    v_accvgpr_read_b32 v187, a3
    v_accvgpr_read_b32 v188, a4
    v_accvgpr_read_b32 v189, a5
    v_accvgpr_read_b32 v190, a6
    v_accvgpr_read_b32 v191, a7
    v_accvgpr_read_b32 v192, a8
    v_accvgpr_read_b32 v193, a9
    v_accvgpr_read_b32 v194, a10
    v_accvgpr_read_b32 v195, a11
    v_accvgpr_read_b32 v196, a12
    v_accvgpr_read_b32 v197, a13
    v_accvgpr_read_b32 v198, a14
    v_accvgpr_read_b32 v199, a15
    s_waitcnt vmcnt(24)
    v_accvgpr_read_b32 v200, a16
    v_xor_b32 v9, s6, v185
    v_bitop3_b32 v9, v9, v187, s6 bitop3:0xf6
    v_bitop3_b32 v9, v9, v189, s6 bitop3:0xf6
    v_bitop3_b32 v9, v9, v191, s6 bitop3:0xf6
    v_bitop3_b32 v9, v9, v193, s6 bitop3:0xf6
    v_bitop3_b32 v9, v9, v195, s6 bitop3:0xf6
    v_bitop3_b32 v9, v9, v197, s6 bitop3:0xf6
    v_bitop3_b32 v9, v9, v199, s6 bitop3:0xf6
    v_cmp_ne_u32 vcc, 0, v9
    s_nop 0
    s_cbranch_vccz L_done_13
    s_mov_b32 s90, 0
L_poll_12:
    s_nop 1
    buffer_load_dwordx4 v[184:187], v27, s[24:27], s70 offen offset:0 sc1
    buffer_load_dwordx4 v[188:191], v27, s[24:27], s70 offen offset:512 sc1
    buffer_load_dwordx4 v[192:195], v27, s[24:27], s70 offen offset:1024 sc1
    buffer_load_dwordx4 v[196:199], v27, s[24:27], s70 offen offset:1536 sc1
    s_waitcnt vmcnt(0)
    v_xor_b32 v9, s6, v185
    v_bitop3_b32 v9, v9, v187, s6 bitop3:0xf6
    v_bitop3_b32 v9, v9, v189, s6 bitop3:0xf6
    v_bitop3_b32 v9, v9, v191, s6 bitop3:0xf6
    v_bitop3_b32 v9, v9, v193, s6 bitop3:0xf6
    v_bitop3_b32 v9, v9, v195, s6 bitop3:0xf6
    v_bitop3_b32 v9, v9, v197, s6 bitop3:0xf6
    v_bitop3_b32 v9, v9, v199, s6 bitop3:0xf6
    v_cmp_ne_u32 vcc, 0, v9
    s_nop 0
    s_cbranch_vccz L_done_13
    s_add_u32 s90, s90, 1
    s_cmp_lt_u32 s90, 40000
    s_cbranch_scc1 L_poll_12
L_done_13:
    s_nop 1
    v_add_f32 v184, v184, v188
    v_add_f32 v192, v192, v196
    v_add_f32 v186, v186, v190
    v_add_f32 v194, v194, v198
    v_add_f32 v184, v184, v192
    v_add_f32 v186, v186, v194
    s_cmp_eq_u32 s3, 2
    s_cselect_b32 s52, 1.0, 0
    s_cselect_b32 s53, 640, 0
    v_cvt_pk_bf16_f32 v184, 0, v184
    v_cvt_pk_bf16_f32 v186, 0, v186
    s_mul_i32 s54, s3, 320
    v_min_u32 v8, 39, v1
    v_add_f32 v184, s52, v184
    v_add_f32 v186, s52, v186
    s_add_u32 s54, s54, 162048
    v_cvt_pk_bf16_f32 v184, 0, v184
    v_cvt_pk_bf16_f32 v185, 0, v186
    v_lshlrev_b32 v188, 16, v200
    v_and_b32 v189, s84, v200
    v_lshl_add_u32 v8, v8, 3, s54
    v_pk_mul_f32 v[188:189], v[188:189], v[184:185]
    v_add_u32 v9, s53, v8
    ds_write_b64 v9, v[188:189]
    ds_write_b64 v8, v[184:185]
    s_waitcnt vmcnt(0)
    s_mov_b64 exec, 1
    s_cmp_eq_u32 s88, 0
    s_cbranch_scc1 L_gs_14
    buffer_store_dword v39, off, s[24:27], s59
    s_branch L_ge_15
L_gs_14:
    buffer_store_dword v39, off, s[24:27], s59 sc0 sc1
L_ge_15:
    s_nop 1
    s_mov_b64 exec, -1
    v_mul_u32_u24 v7, 160, v14
    v_lshl_add_u32 v7, v15, 3, v7
    v_add_u32 v7, s58, v7
    ds_read_b64 v[40:41], v7 offset:0
    ds_read_b64 v[42:43], v7 offset:32
    ds_read_b64 v[44:45], v7 offset:64
    ds_read_b64 v[46:47], v7 offset:96
    ds_read_b64 v[48:49], v7 offset:128
    s_waitcnt lgkmcnt(5)
    s_barrier
    s_mul_i32 s52, s86, 20480
    s_add_u32 s52, s52, 0x100000
    s_add_u32 s53, s52, 4096
    s_add_u32 s54, s52, 8192
    s_add_u32 s55, s52, 12288
    s_add_u32 s56, s52, 16384
    ds_read_b128 a[84:87], v4 offset:10752
    ds_read_b128 a[88:91], v4 offset:11008
    buffer_load_dword v9, v247, s[24:27], s57 offen sc1
    v_cmp_gt_u32 vcc, 40, v1
    v_add_f32 v38, v188, v189
    s_lshl_b32 s62, s87, 4
    s_add_u32 s62, s62, s3
    v_cndmask_b32 v38, 0, v38, vcc
    s_lshl_b32 s62, s62, 3
    s_add_u32 s62, s62, s61
    v_add_f32_dpp v38, v38, v38 quad_perm:[1,0,3,2] row_mask:0xf bank_mask:0xf
    ds_read_b128 a[92:95], v4 offset:11264
    s_nop 0
    v_add_f32_dpp v38, v38, v38 quad_perm:[2,3,0,1] row_mask:0xf bank_mask:0xf
    ds_read_b128 a[96:99], v4 offset:15360
    s_nop 0
    v_add_f32_dpp v38, v38, v38 row_ror:4 row_mask:0xf bank_mask:0xf
    ds_read_b128 a[100:103], v4 offset:15616
    s_nop 0
    v_add_f32_dpp v38, v38, v38 row_ror:8 row_mask:0xf bank_mask:0xf
    ds_read_b128 a[104:107], v4 offset:15872
    v_mov_b32 v184, v38
    s_nop 1
    v_permlane16_swap_b32 v38, v184
    v_add_f32 v38, v38, v184
    v_mov_b32 v184, v38
    s_nop 1
    v_permlane32_swap_b32 v38, v184
    v_add_f32 v38, v38, v184
    s_mov_b64 exec, 1
    s_cmp_eq_u32 s88, 0
    s_cbranch_scc1 L_gs_16
    buffer_store_dwordx2 v[38:39], off, s[24:27], s62 offset:8
    s_branch L_ge_17
L_gs_16:
    buffer_store_dwordx2 v[38:39], off, s[24:27], s62 offset:8 sc0 sc1
L_ge_17:
    s_nop 1
    s_mov_b64 exec, -1
    v_mov_b32 v2, v26
    v_lshlrev_b32 v3, 4, v15
    v_add_u32 v3, 162048, v3
    ds_read_b128 a[108:111], v4 offset:16128
    ds_read_b128 a[112:115], v4 offset:16384
    s_waitcnt vmcnt(1)
    v_cmp_ne_u32 vcc, s6, v9
    s_nop 0
    s_cbranch_vccz L_done_19
    s_mov_b32 s90, 0
L_poll_18:
    s_nop 1
    buffer_load_dword v9, v247, s[24:27], s57 offen sc1
    s_waitcnt vmcnt(0)
    v_cmp_ne_u32 vcc, s6, v9
    s_nop 0
    s_cbranch_vccz L_done_19
    s_add_u32 s90, s90, 1
    s_cmp_lt_u32 s90, 40000
    s_cbranch_scc1 L_poll_18
L_done_19:
    s_nop 1
    buffer_load_dwordx4 v[144:147], v2, s[24:27], s52 offen offset:0 sc1
    buffer_load_dwordx4 v[148:151], v2, s[24:27], s52 offen offset:1024 sc1
    buffer_load_dwordx4 v[152:155], v2, s[24:27], s52 offen offset:2048 sc1
    buffer_load_dwordx4 v[156:159], v2, s[24:27], s52 offen offset:3072 sc1
    buffer_load_dwordx4 v[160:163], v2, s[24:27], s53 offen offset:0 sc1
    buffer_load_dwordx4 v[164:167], v2, s[24:27], s53 offen offset:1024 sc1
    buffer_load_dwordx4 v[168:171], v2, s[24:27], s53 offen offset:2048 sc1
    buffer_load_dwordx4 v[172:175], v2, s[24:27], s53 offen offset:3072 sc1
    ds_read_b128 a[116:119], v4 offset:20480
    ds_read_b128 a[120:123], v4 offset:20736
    ds_read_b128 a[124:127], v4 offset:20992
    ds_read_b128 a[128:131], v4 offset:21248
    ds_read_b128 a[132:135], v4 offset:21504
    ds_read_b128 a[136:139], v4 offset:25600
    ds_read_b128 a[140:143], v4 offset:25856
    ds_read_b128 a[144:147], v4 offset:26112
    ds_read_b128 a[148:151], v4 offset:26368
    ds_read_b128 a[152:155], v4 offset:26624
    ds_read_b128 a[156:159], v4 offset:30720
    ds_read_b128 a[160:163], v4 offset:30976
    s_add_u32 m0, s78, 110592
    s_waitcnt vmcnt(7)
    v_mfma_f32_16x16x32_bf16 v[244:247], a[36:39], v[144:147], 0
    buffer_load_dwordx4 v[176:179], v2, s[24:27], s54 offen offset:0 sc1
    v_mfma_f32_16x16x32_bf16 v[248:251], a[40:43], v[144:147], 0
    ds_read_b128 a[164:167], v4 offset:31232
    v_add_u32 v16, 0, v0
    v_mfma_f32_16x16x32_bf16 v[140:143], a[44:47], v[144:147], 0
    ds_read_b128 a[168:171], v4 offset:31488
    v_mul_u32_u24 v5, 205, v16
    v_mfma_f32_16x16x32_bf16 v[20:23], a[48:51], v[144:147], 0
    buffer_load_dwordx4 v[180:183], v2, s[24:27], s54 offen offset:1024 sc1
    v_mfma_f32_16x16x32_bf16 v[36:39], a[52:55], v[144:147], 0
    ds_read_b128 a[172:175], v4 offset:31744
    s_waitcnt vmcnt(8)
    v_mfma_f32_16x16x32_bf16 v[244:247], a[56:59], v[148:151], v[244:247]
    ds_read_b128 a[176:179], v4 offset:35840
    v_lshrrev_b32 v5, 11, v5
    v_mfma_f32_16x16x32_bf16 v[248:251], a[60:63], v[148:151], v[248:251]
    buffer_load_dwordx4 v[184:187], v2, s[24:27], s54 offen offset:2048 sc1
    v_mfma_f32_16x16x32_bf16 v[140:143], a[64:67], v[148:151], v[140:143]
    ds_read_b128 a[180:183], v4 offset:36096
    v_mul_u32_u24 v5, 1120, v5
    v_mfma_f32_16x16x32_bf16 v[20:23], a[68:71], v[148:151], v[20:23]
    ds_read_b128 a[184:187], v4 offset:36352
    v_lshl_add_u32 v16, v16, 4, v5
    v_mfma_f32_16x16x32_bf16 v[36:39], a[72:75], v[148:151], v[36:39]
    ds_read_b128 a[188:191], v4 offset:36608
    s_waitcnt vmcnt(8) lgkmcnt(14)
    v_mfma_f32_16x16x32_bf16 v[244:247], a[76:79], v[152:155], v[244:247]
    buffer_load_dwordx4 v[188:191], v2, s[24:27], s54 offen offset:3072 sc1
    v_mfma_f32_16x16x32_bf16 v[248:251], a[80:83], v[152:155], v[248:251]
    ds_read_b128 a[192:195], v4 offset:36864
    v_add_u32 v17, 256, v0
    v_mfma_f32_16x16x32_bf16 v[140:143], a[84:87], v[152:155], v[140:143]
    ds_read_b128 a[196:199], v4 offset:40960
    v_mul_u32_u24 v5, 205, v17
    v_mfma_f32_16x16x32_bf16 v[20:23], a[88:91], v[152:155], v[20:23]
    buffer_load_dwordx4 v[192:195], v2, s[24:27], s55 offen offset:0 sc1
    v_mfma_f32_16x16x32_bf16 v[36:39], a[92:95], v[152:155], v[36:39]
    ds_read_b128 a[200:203], v4 offset:41216
    s_waitcnt vmcnt(9)
    v_mfma_f32_16x16x32_bf16 v[244:247], a[96:99], v[156:159], v[244:247]
    ds_read_b128 a[204:207], v4 offset:41472
    v_lshrrev_b32 v5, 11, v5
    v_mfma_f32_16x16x32_bf16 v[248:251], a[100:103], v[156:159], v[248:251]
    buffer_load_dwordx4 v[196:199], v2, s[24:27], s55 offen offset:1024 sc1
    v_mfma_f32_16x16x32_bf16 v[140:143], a[104:107], v[156:159], v[140:143]
    ds_read_b128 a[208:211], v4 offset:41728
    v_mul_u32_u24 v5, 1120, v5
    v_mfma_f32_16x16x32_bf16 v[20:23], a[108:111], v[156:159], v[20:23]
    ds_read_b128 a[212:215], v4 offset:41984
    v_lshl_add_u32 v17, v17, 4, v5
    v_mfma_f32_16x16x32_bf16 v[36:39], a[112:115], v[156:159], v[36:39]
    ds_read_b128 a[216:219], v4 offset:46080
    s_waitcnt vmcnt(9)
    v_mfma_f32_16x16x32_bf16 v[244:247], a[116:119], v[160:163], v[244:247]
    buffer_load_dwordx4 v[200:203], v2, s[24:27], s55 offen offset:2048 sc1
    v_mfma_f32_16x16x32_bf16 v[248:251], a[120:123], v[160:163], v[248:251]
    ds_read_b128 a[220:223], v4 offset:46336
    v_add_u32 v18, 512, v0
    v_mfma_f32_16x16x32_bf16 v[140:143], a[124:127], v[160:163], v[140:143]
    ds_read_b128 a[224:227], v4 offset:46592
    v_min_u32 v18, 639, v18
    v_mfma_f32_16x16x32_bf16 v[20:23], a[128:131], v[160:163], v[20:23]
    buffer_load_dwordx4 v[204:207], v2, s[24:27], s55 offen offset:3072 sc1
    v_mfma_f32_16x16x32_bf16 v[36:39], a[132:135], v[160:163], v[36:39]
    ds_read_b128 a[228:231], v4 offset:46848
    s_waitcnt vmcnt(10) lgkmcnt(14)
    v_mfma_f32_16x16x32_bf16 v[244:247], a[136:139], v[164:167], v[244:247]
    ds_read_b128 a[232:235], v4 offset:47104
    v_mul_u32_u24 v5, 205, v18
    v_mfma_f32_16x16x32_bf16 v[248:251], a[140:143], v[164:167], v[248:251]
    buffer_load_dwordx4 v[208:211], v2, s[24:27], s56 offen offset:0 sc1
    v_mfma_f32_16x16x32_bf16 v[140:143], a[144:147], v[164:167], v[140:143]
    ds_read_b128 a[236:239], v4 offset:51200
    v_lshrrev_b32 v5, 11, v5
    v_mfma_f32_16x16x32_bf16 v[20:23], a[148:151], v[164:167], v[20:23]
    ds_read_b128 a[240:243], v4 offset:51456
    v_mul_u32_u24 v5, 1120, v5
    v_mfma_f32_16x16x32_bf16 v[36:39], a[152:155], v[164:167], v[36:39]
    ds_read_b128 a[244:247], v4 offset:51712
    s_waitcnt vmcnt(10)
    v_mfma_f32_16x16x32_bf16 v[244:247], a[156:159], v[168:171], v[244:247]
    buffer_load_dwordx4 v[212:215], v2, s[24:27], s56 offen offset:1024 sc1
    v_mfma_f32_16x16x32_bf16 v[248:251], a[160:163], v[168:171], v[248:251]
    ds_read_b128 a[248:251], v4 offset:51968
    v_lshl_add_u32 v18, v18, 4, v5
    v_mfma_f32_16x16x32_bf16 v[140:143], a[164:167], v[168:171], v[140:143]
    ds_read_b128 a[252:255], v4 offset:52224
    s_lshl_b32 s62, s86, 11
    v_mfma_f32_16x16x32_bf16 v[20:23], a[168:171], v[168:171], v[20:23]
    buffer_load_dwordx4 v[216:219], v2, s[24:27], s56 offen offset:2048 sc1
    v_mfma_f32_16x16x32_bf16 v[36:39], a[172:175], v[168:171], v[36:39]
    ds_read_b128 v[60:63], v4 offset:56320
    s_waitcnt vmcnt(11) lgkmcnt(14)
    v_mfma_f32_16x16x32_bf16 v[244:247], a[176:179], v[172:175], v[244:247]
    ds_read_b128 v[64:67], v4 offset:56576
    s_add_u32 s62, s62, 0x10000
    v_mfma_f32_16x16x32_bf16 v[248:251], a[180:183], v[172:175], v[248:251]
    buffer_load_dwordx4 v[220:223], v2, s[24:27], s56 offen offset:3072 sc1
    v_mfma_f32_16x16x32_bf16 v[140:143], a[184:187], v[172:175], v[140:143]
    ds_read_b128 v[68:71], v4 offset:56832
    s_lshl_b32 s63, s87, 8
    v_mfma_f32_16x16x32_bf16 v[20:23], a[188:191], v[172:175], v[20:23]
    ds_read_b128 v[72:75], v4 offset:57088
    s_add_u32 s63, s63, s62
    v_mfma_f32_16x16x32_bf16 v[36:39], a[192:195], v[172:175], v[36:39]
    ds_read_b128 v[76:79], v4 offset:57344
    s_waitcnt vmcnt(11) lgkmcnt(14)
    v_mfma_f32_16x16x32_bf16 v[244:247], a[196:199], v[176:179], v[244:247]
    buffer_load_dwordx4 v31, s[40:43], 0 offen lds
    v_mfma_f32_16x16x32_bf16 v[248:251], a[200:203], v[176:179], v[248:251]
    ds_read_b128 v[100:103], v6 offset:0
    s_add_u32 m0, m0, 4096
    v_mfma_f32_16x16x32_bf16 v[140:143], a[204:207], v[176:179], v[140:143]
    ds_read_b128 v[104:107], v6 offset:256
    v_and_b32 v12, 7, v1
    v_mfma_f32_16x16x32_bf16 v[20:23], a[208:211], v[176:179], v[20:23]
    buffer_load_dwordx4 v31, s[40:43], s16 offen lds
    v_mfma_f32_16x16x32_bf16 v[36:39], a[212:215], v[176:179], v[36:39]
    ds_read_b128 v[108:111], v6 offset:512
    s_waitcnt vmcnt(12) lgkmcnt(13)
    v_mfma_f32_16x16x32_bf16 v[244:247], a[216:219], v[180:183], v[244:247]
    ds_read_b128 v[112:115], v6 offset:768
    s_add_u32 m0, m0, 4096
    v_mfma_f32_16x16x32_bf16 v[248:251], a[220:223], v[180:183], v[248:251]
    buffer_load_dwordx4 v32, s[40:43], s17 offen lds
    v_mfma_f32_16x16x32_bf16 v[140:143], a[224:227], v[180:183], v[140:143]
    ds_read_b128 v[116:119], v6 offset:1024
    s_add_u32 m0, m0, 4096
    v_mfma_f32_16x16x32_bf16 v[20:23], a[228:231], v[180:183], v[20:23]
    ds_read_b128 v[120:123], v6 offset:5120
    v_lshlrev_b32 v12, 7, v12
    v_mfma_f32_16x16x32_bf16 v[36:39], a[232:235], v[180:183], v[36:39]
    ds_read_b128 v[124:127], v6 offset:5376
    s_waitcnt vmcnt(12) lgkmcnt(12)
    v_mfma_f32_16x16x32_bf16 v[244:247], a[236:239], v[184:187], v[244:247]
    buffer_load_dwordx4 v31, s[44:47], 0 offen lds
    v_mfma_f32_16x16x32_bf16 v[248:251], a[240:243], v[184:187], v[248:251]
    ds_read_b128 v[128:131], v6 offset:5632
    s_add_u32 m0, m0, 4096
    v_mfma_f32_16x16x32_bf16 v[140:143], a[244:247], v[184:187], v[140:143]
    ds_read_b128 v[132:135], v6 offset:5888
    v_lshlrev_b32 v80, 16, v40
    v_mfma_f32_16x16x32_bf16 v[20:23], a[248:251], v[184:187], v[20:23]
    buffer_load_dwordx4 v31, s[44:47], s16 offen lds
    v_mfma_f32_16x16x32_bf16 v[36:39], a[252:255], v[184:187], v[36:39]
    ds_read_b128 v[136:139], v6 offset:6144
    s_waitcnt vmcnt(13) lgkmcnt(10)
    v_mfma_f32_16x16x32_bf16 v[244:247], v[60:63], v[188:191], v[244:247]
    ds_read_b128 a[36:39], v6 offset:10240
    s_add_u32 m0, m0, 4096
    v_mfma_f32_16x16x32_bf16 v[248:251], v[64:67], v[188:191], v[248:251]
    buffer_load_dwordx4 v32, s[44:47], s17 offen lds
    v_mfma_f32_16x16x32_bf16 v[140:143], v[68:71], v[188:191], v[140:143]
    ds_read_b128 a[40:43], v6 offset:10496
    s_add_u32 m0, m0, 4096
    v_mfma_f32_16x16x32_bf16 v[20:23], v[72:75], v[188:191], v[20:23]
    ds_read_b128 a[44:47], v6 offset:10752
    v_and_b32 v81, s84, v40
    v_mfma_f32_16x16x32_bf16 v[36:39], v[76:79], v[188:191], v[36:39]
    ds_read_b128 a[48:51], v6 offset:11008
    s_waitcnt vmcnt(13) lgkmcnt(9)
    v_mfma_f32_16x16x32_bf16 v[244:247], v[100:103], v[192:195], v[244:247]
    ds_read_b128 a[52:55], v6 offset:11264
    v_lshlrev_b32 v82, 16, v41
    v_mfma_f32_16x16x32_bf16 v[248:251], v[104:107], v[192:195], v[248:251]
    ds_read_b128 a[56:59], v6 offset:15360
    v_and_b32 v83, s84, v41
    v_mfma_f32_16x16x32_bf16 v[140:143], v[108:111], v[192:195], v[140:143]
    ds_read_b128 a[60:63], v6 offset:15616
    v_lshlrev_b32 v84, 16, v42
    v_mfma_f32_16x16x32_bf16 v[20:23], v[112:115], v[192:195], v[20:23]
    ds_read_b128 a[64:67], v6 offset:15872
    v_and_b32 v85, s84, v42
    v_mfma_f32_16x16x32_bf16 v[36:39], v[116:119], v[192:195], v[36:39]
    ds_read_b128 a[68:71], v6 offset:16128
    s_waitcnt vmcnt(12) lgkmcnt(9)
    v_mfma_f32_16x16x32_bf16 v[244:247], v[120:123], v[196:199], v[244:247]
    ds_read_b128 a[72:75], v6 offset:16384
    v_lshlrev_b32 v86, 16, v43
    v_mfma_f32_16x16x32_bf16 v[248:251], v[124:127], v[196:199], v[248:251]
    ds_read_b128 a[76:79], v6 offset:20480
    v_and_b32 v87, s84, v43
    v_mfma_f32_16x16x32_bf16 v[140:143], v[128:131], v[196:199], v[140:143]
    ds_read_b128 a[80:83], v6 offset:20736
    v_lshlrev_b32 v88, 16, v44
    v_mfma_f32_16x16x32_bf16 v[20:23], v[132:135], v[196:199], v[20:23]
    ds_read_b128 a[84:87], v6 offset:20992
    v_and_b32 v89, s84, v44
    v_mfma_f32_16x16x32_bf16 v[36:39], v[136:139], v[196:199], v[36:39]
    ds_read_b128 a[88:91], v6 offset:21248
    s_waitcnt vmcnt(11) lgkmcnt(9)
    v_mfma_f32_16x16x32_bf16 v[244:247], a[36:39], v[200:203], v[244:247]
    ds_read_b128 a[92:95], v6 offset:21504
    v_lshlrev_b32 v90, 16, v45
    v_mfma_f32_16x16x32_bf16 v[248:251], a[40:43], v[200:203], v[248:251]
    ds_read_b128 a[96:99], v6 offset:25600
    v_and_b32 v91, s84, v45
    v_mfma_f32_16x16x32_bf16 v[140:143], a[44:47], v[200:203], v[140:143]
    ds_read_b128 a[100:103], v6 offset:25856
    v_lshlrev_b32 v92, 16, v46
    v_mfma_f32_16x16x32_bf16 v[20:23], a[48:51], v[200:203], v[20:23]
    ds_read_b128 a[104:107], v6 offset:26112
    v_and_b32 v93, s84, v46
    v_mfma_f32_16x16x32_bf16 v[36:39], a[52:55], v[200:203], v[36:39]
    ds_read_b128 a[108:111], v6 offset:26368
    s_waitcnt vmcnt(10) lgkmcnt(9)
    v_mfma_f32_16x16x32_bf16 v[244:247], a[56:59], v[204:207], v[244:247]
    ds_read_b128 a[112:115], v6 offset:26624
    v_lshlrev_b32 v94, 16, v47
    v_mfma_f32_16x16x32_bf16 v[248:251], a[60:63], v[204:207], v[248:251]
    ds_read_b128 a[116:119], v6 offset:30720
    v_and_b32 v95, s84, v47
    v_mfma_f32_16x16x32_bf16 v[140:143], a[64:67], v[204:207], v[140:143]
    ds_read_b128 a[120:123], v6 offset:30976
    v_lshlrev_b32 v96, 16, v48
    v_mfma_f32_16x16x32_bf16 v[20:23], a[68:71], v[204:207], v[20:23]
    ds_read_b128 a[124:127], v6 offset:31232
    v_and_b32 v97, s84, v48
    v_mfma_f32_16x16x32_bf16 v[36:39], a[72:75], v[204:207], v[36:39]
    ds_read_b128 a[128:131], v6 offset:31488
    s_waitcnt vmcnt(9) lgkmcnt(9)
    v_mfma_f32_16x16x32_bf16 v[244:247], a[76:79], v[208:211], v[244:247]
    ds_read_b128 a[132:135], v6 offset:31744
    v_lshlrev_b32 v98, 16, v49
    v_mfma_f32_16x16x32_bf16 v[248:251], a[80:83], v[208:211], v[248:251]
    ds_read_b128 a[136:139], v6 offset:35840
    v_and_b32 v99, s84, v49
    v_mfma_f32_16x16x32_bf16 v[140:143], a[84:87], v[208:211], v[140:143]
    ds_read_b128 a[140:143], v6 offset:36096
    v_mfma_f32_16x16x32_bf16 v[20:23], a[88:91], v[208:211], v[20:23]
    ds_read_b128 a[144:147], v6 offset:36352
    v_mfma_f32_16x16x32_bf16 v[36:39], a[92:95], v[208:211], v[36:39]
    ds_read_b128 a[148:151], v6 offset:36608
    s_waitcnt vmcnt(8) lgkmcnt(9)
    v_mfma_f32_16x16x32_bf16 v[244:247], a[96:99], v[212:215], v[244:247]
    ds_read_b128 a[152:155], v6 offset:36864
    v_mfma_f32_16x16x32_bf16 v[248:251], a[100:103], v[212:215], v[248:251]
    ds_read_b128 v[224:227], v3 offset:1280
    v_mfma_f32_16x16x32_bf16 v[140:143], a[104:107], v[212:215], v[140:143]
    ds_read_b128 v[228:231], v3 offset:1344
    v_mfma_f32_16x16x32_bf16 v[20:23], a[108:111], v[212:215], v[20:23]
    ds_read_b128 v[232:235], v3 offset:1408
    v_mfma_f32_16x16x32_bf16 v[36:39], a[112:115], v[212:215], v[36:39]
    ds_read_b128 v[236:239], v3 offset:1472
    s_waitcnt vmcnt(7) lgkmcnt(9)
    v_mfma_f32_16x16x32_bf16 v[244:247], a[116:119], v[216:219], v[244:247]
    ds_read_b128 v[240:243], v3 offset:1536
    v_mfma_f32_16x16x32_bf16 v[248:251], a[120:123], v[216:219], v[248:251]
    ds_read_b128 v[40:43], v3 offset:0
    v_mfma_f32_16x16x32_bf16 v[140:143], a[124:127], v[216:219], v[140:143]
    ds_read_b128 v[44:47], v3 offset:64
    v_mfma_f32_16x16x32_bf16 v[20:23], a[128:131], v[216:219], v[20:23]
    ds_read_b128 v[48:51], v3 offset:128
    v_mfma_f32_16x16x32_bf16 v[36:39], a[132:135], v[216:219], v[36:39]
    ds_read_b128 v[52:55], v3 offset:192
    s_waitcnt vmcnt(6) lgkmcnt(9)
    v_mfma_f32_16x16x32_bf16 v[244:247], a[136:139], v[220:223], v[244:247]
    ds_read_b128 v[56:59], v3 offset:256
    v_mfma_f32_16x16x32_bf16 v[248:251], a[140:143], v[220:223], v[248:251]
    v_mfma_f32_16x16x32_bf16 v[140:143], a[144:147], v[220:223], v[140:143]
    v_mfma_f32_16x16x32_bf16 v[20:23], a[148:151], v[220:223], v[20:23]
    v_mfma_f32_16x16x32_bf16 v[36:39], a[152:155], v[220:223], v[36:39]
    s_waitcnt lgkmcnt(4)
    s_nop 1
    v_pk_fma_f32 v[80:81], v[244:245], v[40:41], v[80:81]
    v_pk_fma_f32 v[82:83], v[246:247], v[42:43], v[82:83]
    s_waitcnt lgkmcnt(3)
    v_pk_fma_f32 v[84:85], v[248:249], v[44:45], v[84:85]
    v_pk_fma_f32 v[86:87], v[250:251], v[46:47], v[86:87]
    s_waitcnt lgkmcnt(2)
    v_pk_fma_f32 v[88:89], v[140:141], v[48:49], v[88:89]
    v_pk_fma_f32 v[90:91], v[142:143], v[50:51], v[90:91]
    s_waitcnt lgkmcnt(1)
    v_pk_fma_f32 v[92:93], v[20:21], v[52:53], v[92:93]
    v_pk_fma_f32 v[94:95], v[22:23], v[54:55], v[94:95]
    s_waitcnt lgkmcnt(0)
    v_pk_fma_f32 v[96:97], v[36:37], v[56:57], v[96:97]
    v_pk_fma_f32 v[98:99], v[38:39], v[58:59], v[98:99]
    v_pk_add_f32 v[156:157], v[80:81], v[82:83]
    v_pk_mul_f32 v[158:159], v[80:81], v[80:81]
    v_pk_mul_f32 v[160:161], v[80:81], v[224:225]
    v_pk_fma_f32 v[158:159], v[82:83], v[82:83], v[158:159]
    v_pk_fma_f32 v[160:161], v[82:83], v[226:227], v[160:161]
    v_pk_add_f32 v[156:157], v[156:157], v[84:85]
    v_pk_fma_f32 v[158:159], v[84:85], v[84:85], v[158:159]
    v_pk_fma_f32 v[160:161], v[84:85], v[228:229], v[160:161]
    v_pk_add_f32 v[156:157], v[156:157], v[86:87]
    v_pk_fma_f32 v[158:159], v[86:87], v[86:87], v[158:159]
    v_pk_fma_f32 v[160:161], v[86:87], v[230:231], v[160:161]
    v_pk_add_f32 v[156:157], v[156:157], v[88:89]
    v_pk_fma_f32 v[158:159], v[88:89], v[88:89], v[158:159]
    v_pk_fma_f32 v[160:161], v[88:89], v[232:233], v[160:161]
    v_pk_add_f32 v[156:157], v[156:157], v[90:91]
    v_pk_fma_f32 v[158:159], v[90:91], v[90:91], v[158:159]
    v_pk_fma_f32 v[160:161], v[90:91], v[234:235], v[160:161]
    v_pk_add_f32 v[156:157], v[156:157], v[92:93]
    v_pk_fma_f32 v[158:159], v[92:93], v[92:93], v[158:159]
    v_pk_fma_f32 v[160:161], v[92:93], v[236:237], v[160:161]
    v_pk_add_f32 v[156:157], v[156:157], v[94:95]
    v_pk_fma_f32 v[158:159], v[94:95], v[94:95], v[158:159]
    v_pk_fma_f32 v[160:161], v[94:95], v[238:239], v[160:161]
    v_pk_add_f32 v[156:157], v[156:157], v[96:97]
    v_pk_fma_f32 v[158:159], v[96:97], v[96:97], v[158:159]
    v_pk_fma_f32 v[160:161], v[96:97], v[240:241], v[160:161]
    v_pk_add_f32 v[156:157], v[156:157], v[98:99]
    v_pk_fma_f32 v[158:159], v[98:99], v[98:99], v[158:159]
    v_pk_fma_f32 v[160:161], v[98:99], v[242:243], v[160:161]
    v_add_f32 v164, v156, v157
    v_add_f32 v165, v158, v159
    v_add_f32 v166, v160, v161
    v_mov_b32 v167, s6
    v_mov_b32 v168, v164
    v_mov_b32 v169, v165
    v_mov_b32 v170, v166
    v_permlane16_swap_b32 v164, v168
    v_permlane16_swap_b32 v165, v169
    v_permlane16_swap_b32 v166, v170
    v_add_f32 v164, v164, v168
    v_add_f32 v165, v165, v169
    v_add_f32 v166, v166, v170
    v_mov_b32 v168, v164
    v_mov_b32 v169, v165
    v_mov_b32 v170, v166
    v_permlane32_swap_b32 v164, v168
    v_permlane32_swap_b32 v165, v169
    v_permlane32_swap_b32 v166, v170
    v_add_f32 v164, v164, v168
    v_add_f32 v165, v165, v169
    v_add_f32 v166, v166, v170
    s_mov_b64 exec, 0xffff
    s_cmp_eq_u32 s88, 0
    s_cbranch_scc1 L_gs_20
    buffer_store_dwordx4 v[164:167], v2, s[24:27], s63 offen
    s_branch L_ge_21
L_gs_20:
    buffer_store_dwordx4 v[164:167], v2, s[24:27], s63 offen sc0 sc1
L_ge_21:
    s_nop 1
    s_mov_b64 exec, -1
    buffer_load_dwordx4 v[148:151], v12, s[24:27], s61 offen offset:16 sc1
    ds_read_b128 v[60:63], v3 offset:320
    ds_read_b128 v[64:67], v3 offset:384
    ds_read_b128 v[68:71], v3 offset:448
    ds_read_b128 v[72:75], v3 offset:512
    ds_read_b128 v[76:79], v3 offset:576
    ds_read_b128 v[100:103], v3 offset:640
    ds_read_b128 v[104:107], v3 offset:704
    ds_read_b128 v[108:111], v3 offset:768
    ds_read_b128 v[112:115], v3 offset:832
    ds_read_b128 v[116:119], v3 offset:896
    ds_read_b128 v[120:123], v3 offset:960
    ds_read_b128 v[124:127], v3 offset:1024
    ds_read_b128 v[128:131], v3 offset:1088
    ds_read_b128 v[132:135], v3 offset:1152
    ds_read_b128 v[136:139], v3 offset:1216
    s_mov_b32 s55, 110592
    v_lshrrev_b32 v21, 2, v14
    v_lshl_add_u32 v21, v15, 3, v21
    v_and_b32 v22, 3, v1
    s_lshl_b32 s54, s3, 5
    s_add_u32 s55, s55, s54
    v_lshl_add_u32 v22, v22, 3, s55
    v_lshl_add_u32 v23, v21, 7, v22
    v_mul_u32_u24 v21, 160, v21
    v_add_u32 v22, v21, v22
    v_subrev_u32 v21, s54, v22
    buffer_load_dwordx4 v[164:167], v2, s[24:27], s62 offen sc1
    buffer_load_dwordx4 v[168:171], v2, s[24:27], s62 offen offset:1024 sc1
    s_lshl_b32 s64, s3, 2
    s_add_u32 s64, s64, 102400
    v_mov_b32 v24, s64
    v_mov_b32 v25, 102400
    s_mul_i32 s64, s95, 4224
    s_add_u32 s64, s64, 0x400000
    v_mov_b32 v173, 0x3727c5ac
    s_movk_i32 s63, 0x7ff
    s_mov_b32 s52, 0x400000
    v_and_b32 v4, 31, v1
    v_mul_u32_u24 v4, 4224, v4
    s_mov_b32 s53, 102656
    v_lshl_add_u32 v3, v15, 3, s53
    v_add_u32 v28, s53, v2
    v_mul_u32_u24 v29, 0x30000, v15
    v_lshl_add_u32 v29, v14, 4, v29
    v_lshlrev_b32 v5, 3, v14
    v_mov_b32 v7, s6
    v_mov_b32 v144, 0
    v_mov_b32 v145, s6
    s_waitcnt vmcnt(2)
    v_xor_b32 v9, s6, v149
    v_bitop3_b32 v9, v9, v151, s6 bitop3:0xf6
    v_cmp_ne_u32 vcc, 0, v9
    s_nop 0
    s_cbranch_vccz L_done_23
    s_mov_b32 s90, 0
L_poll_22:
    s_nop 1
    buffer_load_dwordx4 v[148:151], v12, s[24:27], s61 offen offset:16 sc1
    s_waitcnt vmcnt(0)
    v_xor_b32 v9, s6, v149
    v_bitop3_b32 v9, v9, v151, s6 bitop3:0xf6
    v_cmp_ne_u32 vcc, 0, v9
    s_nop 0
    s_cbranch_vccz L_done_23
    s_add_u32 s90, s90, 1
    s_cmp_lt_u32 s90, 40000
    s_cbranch_scc1 L_poll_22
L_done_23:
    s_nop 1
    v_add_f32_dpp v148, v148, v148 quad_perm:[1,0,3,2] row_mask:0xf bank_mask:0xf
    v_add_f32_dpp v150, v150, v150 quad_perm:[1,0,3,2] row_mask:0xf bank_mask:0xf
    s_nop 0
    v_add_f32_dpp v148, v148, v148 quad_perm:[2,3,0,1] row_mask:0xf bank_mask:0xf
    v_add_f32_dpp v150, v150, v150 quad_perm:[2,3,0,1] row_mask:0xf bank_mask:0xf
    s_nop 0
    v_add_f32_dpp v148, v148, v148 row_ror:4 row_mask:0xf bank_mask:0xf
    v_add_f32_dpp v150, v150, v150 row_ror:4 row_mask:0xf bank_mask:0xf
    s_waitcnt vmcnt(1)
    v_xor_b32 v9, s6, v167
    s_waitcnt vmcnt(0)
    v_bitop3_b32 v9, v9, v171, s6 bitop3:0xf6
    v_cmp_ne_u32 vcc, 0, v9
    s_nop 0
    s_cbranch_vccz L_done_25
    s_mov_b32 s90, 0
L_poll_24:
    s_nop 1
    buffer_load_dwordx4 v[164:167], v2, s[24:27], s62 offen sc1
    buffer_load_dwordx4 v[168:171], v2, s[24:27], s62 offen offset:1024 sc1
    s_waitcnt vmcnt(0)
    v_xor_b32 v9, s6, v167
    v_bitop3_b32 v9, v9, v171, s6 bitop3:0xf6
    v_cmp_ne_u32 vcc, 0, v9
    s_nop 0
    s_cbranch_vccz L_done_25
    s_add_u32 s90, s90, 1
    s_cmp_lt_u32 s90, 40000
    s_cbranch_scc1 L_poll_24
L_done_25:
    s_nop 1
    v_add_f32 v164, v164, v168
    v_add_f32 v165, v165, v169
    v_add_f32 v166, v166, v170
    v_mov_b32 v168, v164
    v_mov_b32 v169, v165
    v_mov_b32 v170, v166
    v_permlane16_swap_b32 v164, v168
    v_permlane16_swap_b32 v165, v169
    v_permlane16_swap_b32 v166, v170
    v_add_f32 v164, v164, v168
    v_add_f32 v165, v165, v169
    v_add_f32 v166, v166, v170
    v_mov_b32 v168, v164
    v_mov_b32 v169, v165
    v_mov_b32 v170, v166
    v_permlane32_swap_b32 v164, v168
    v_permlane32_swap_b32 v165, v169
    v_permlane32_swap_b32 v166, v170
    v_add_f32 v164, v164, v168
    v_add_f32 v165, v165, v169
    v_add_f32 v166, v166, v170
    v_mul_f32 v168, 0x3acccccd, v164
    v_fmac_f32 v173, 0x3acccccd, v165
    v_fma_f32 v169, -v168, v168, v173
    v_max_f32 v169, 0x3727c5ac, v169
    v_rsq_f32 v170, v169
    v_fma_f32 v171, -v168, v150, v166
    v_fma_f32 v171, v171, v170, v148
    v_ashrrev_i32 v172, 31, v171
    v_or_b32 v172, 0x80000000, v172
    v_xor_b32 v172, v172, v171
    v_bfi_b32 v172, s63, v35, v172
    v_mul_f32 v168, v168, v170
    v_sub_f32 v168, 0, v168
    v_max_u32_dpp v174, v172, v172 quad_perm:[1,0,3,2] row_mask:0xf bank_mask:0xf
    v_pk_fma_f32 v[176:177], v[80:81], v[170:171], v[168:169] op_sel_hi:[1,0,0]
    v_pk_fma_f32 v[178:179], v[82:83], v[170:171], v[168:169] op_sel_hi:[1,0,0]
    v_max_u32_dpp v174, v174, v174 quad_perm:[2,3,0,1] row_mask:0xf bank_mask:0xf
    v_pk_fma_f32 v[180:181], v[84:85], v[170:171], v[168:169] op_sel_hi:[1,0,0]
    v_pk_fma_f32 v[182:183], v[86:87], v[170:171], v[168:169] op_sel_hi:[1,0,0]
    v_max_u32_dpp v174, v174, v174 row_ror:4 row_mask:0xf bank_mask:0xf
    v_pk_fma_f32 v[184:185], v[88:89], v[170:171], v[168:169] op_sel_hi:[1,0,0]
    v_pk_fma_f32 v[186:187], v[90:91], v[170:171], v[168:169] op_sel_hi:[1,0,0]
    v_max_u32_dpp v174, v174, v174 row_ror:8 row_mask:0xf bank_mask:0xf
    ds_write_b32 v24, v174
    s_or_b32 s53, s87, s3
    s_waitcnt lgkmcnt(0)
    s_barrier
    s_cmp_lg_u32 s53, 0
    s_cbranch_scc1 L_skip_26
    ds_read_b128 v[8:11], v25
    s_mov_b64 exec, 0xffff
    s_waitcnt lgkmcnt(0)
    v_max3_u32 v6, v8, v9, v10
    v_max_u32 v6, v6, v11
    buffer_store_dwordx2 v[6:7], v5, s[24:27], s64 offen sc0 sc1
    s_mov_b64 exec, -1
L_skip_26:
    s_nop 1
    ds_read_b128 v[8:11], v25
    buffer_load_dwordx4 v16, s[32:35], s89 offen lds
    s_add_u32 m0, m0, 4096
    s_nop 0
    buffer_load_dwordx4 v17, s[32:35], s89 offen lds
    s_add_u32 m0, m0, 4096
    s_nop 0
    buffer_load_dwordx4 v18, s[32:35], s89 offen lds
    s_add_u32 m0, m0, 4096
    v_pk_fma_f32 v[188:189], v[92:93], v[170:171], v[168:169] op_sel_hi:[1,0,0]
    v_pk_fma_f32 v[190:191], v[94:95], v[170:171], v[168:169] op_sel_hi:[1,0,0]
    v_pk_fma_f32 v[192:193], v[96:97], v[170:171], v[168:169] op_sel_hi:[1,0,0]
    v_pk_fma_f32 v[194:195], v[98:99], v[170:171], v[168:169] op_sel_hi:[1,0,0]
    v_pk_fma_f32 v[176:177], v[176:177], v[100:101], v[60:61]
    v_pk_fma_f32 v[178:179], v[178:179], v[102:103], v[62:63]
    v_pk_fma_f32 v[180:181], v[180:181], v[104:105], v[64:65]
    v_pk_fma_f32 v[182:183], v[182:183], v[106:107], v[66:67]
    v_pk_fma_f32 v[184:185], v[184:185], v[108:109], v[68:69]
    v_pk_fma_f32 v[186:187], v[186:187], v[110:111], v[70:71]
    v_pk_fma_f32 v[188:189], v[188:189], v[112:113], v[72:73]
    v_pk_fma_f32 v[190:191], v[190:191], v[114:115], v[74:75]
    v_pk_fma_f32 v[192:193], v[192:193], v[116:117], v[76:77]
    v_pk_fma_f32 v[194:195], v[194:195], v[118:119], v[78:79]
    v_cvt_pk_bf16_f32 v196, v176, v177
    v_cvt_pk_bf16_f32 v197, v178, v179
    v_cvt_pk_bf16_f32 v198, v180, v181
    v_cvt_pk_bf16_f32 v199, v182, v183
    v_cvt_pk_bf16_f32 v200, v184, v185
    v_cvt_pk_bf16_f32 v201, v186, v187
    v_cvt_pk_bf16_f32 v202, v188, v189
    v_cvt_pk_bf16_f32 v203, v190, v191
    v_cvt_pk_bf16_f32 v204, v192, v193
    v_cvt_pk_bf16_f32 v205, v194, v195
    s_waitcnt lgkmcnt(0)
    v_max3_u32 v174, v8, v9, v10
    v_pk_fma_f32 v[176:177], v[176:177], v[120:121], v[80:81]
    v_pk_fma_f32 v[178:179], v[178:179], v[122:123], v[82:83]
    v_pk_fma_f32 v[180:181], v[180:181], v[124:125], v[84:85]
    v_pk_fma_f32 v[182:183], v[182:183], v[126:127], v[86:87]
    v_pk_fma_f32 v[184:185], v[184:185], v[128:129], v[88:89]
    v_pk_fma_f32 v[186:187], v[186:187], v[130:131], v[90:91]
    v_pk_fma_f32 v[188:189], v[188:189], v[132:133], v[92:93]
    v_pk_fma_f32 v[190:191], v[190:191], v[134:135], v[94:95]
    v_pk_fma_f32 v[192:193], v[192:193], v[136:137], v[96:97]
    v_pk_fma_f32 v[194:195], v[194:195], v[138:139], v[98:99]
    v_max_u32 v174, v174, v11
    v_cvt_pk_bf16_f32 v206, v176, v177
    v_cvt_pk_bf16_f32 v207, v178, v179
    v_cvt_pk_bf16_f32 v208, v180, v181
    v_cvt_pk_bf16_f32 v209, v182, v183
    v_cvt_pk_bf16_f32 v210, v184, v185
    v_cvt_pk_bf16_f32 v211, v186, v187
    v_cvt_pk_bf16_f32 v212, v188, v189
    v_cvt_pk_bf16_f32 v213, v190, v191
    v_cvt_pk_bf16_f32 v214, v192, v193
    v_cvt_pk_bf16_f32 v215, v194, v195
    v_cmp_eq_u32 vcc, v172, v174
    s_nop 0
    s_cbranch_vccz L_nc_27
    s_mov_b64 exec, vcc
    ds_write_b64 v3, v[196:197] offset:0
    ds_write_b64 v3, v[198:199] offset:32
    ds_write_b64 v3, v[200:201] offset:64
    ds_write_b64 v3, v[202:203] offset:96
    ds_write_b64 v3, v[204:205] offset:128
    ds_write_b64 v3, v[206:207] offset:256
    ds_write_b64 v3, v[208:209] offset:288
    ds_write_b64 v3, v[210:211] offset:320
    ds_write_b64 v3, v[212:213] offset:352
    ds_write_b64 v3, v[214:215] offset:384
    s_mov_b64 exec, 0x03ff03ff
    ds_read_b128 v[8:11], v28
    s_waitcnt lgkmcnt(0)
    v_min_u32 v8, -2, v8
    v_min_u32 v9, -2, v9
    v_min_u32 v10, -2, v10
    v_min_u32 v11, -2, v11
    buffer_store_dwordx4 v[8:11], v29, s[24:27], s92 offen sc0 sc1
    s_mov_b64 exec, -1
L_nc_27:
    s_nop 1
    v_lshlrev_b32 v5, 4, v15
    v_min_u32 v6, 16, v5
    s_mul_i32 s58, s94, 160
    s_add_u32 s58, s58, 0x60000
    s_lshl_b32 s64, s95, 13
    s_add_u32 s64, s64, 0x680000
    s_lshl_b32 s65, s94, 10
    s_lshl_b32 s66, s3, 8
    s_add_u32 s65, s65, s66
    s_add_u32 s65, s65, s64
    s_lshl_b32 s66, s3, 11
    s_add_u32 s64, s64, s66
    v_mov_b32 v58, s6
    v_mov_b32 v59, s6
    s_lshl_b32 s54, s3, 9
    s_add_u32 s54, s54, 103424
    v_lshl_add_u32 v7, v1, 3, s54
    v_lshlrev_b32 v8, 3, v1
    v_add_u32 v8, 103424, v8
    s_lshl_b32 s54, s3, 7
    s_add_u32 s54, s54, 105472
    v_lshl_add_u32 v12, v1, 1, s54
    v_add_u32 v13, s54, v5
    s_cmp_ge_u32 s93, 216
    s_cbranch_scc1 L_F_28
    s_mov_b32 s90, 0
    s_mov_b32 exec_hi, 0
    buffer_load_dwordx2 v[144:145], v4, s[24:27], s52 offen sc1
    s_mov_b32 exec_hi, -1
    ds_read_b64_tr_b16 a[56:57], v23 offset:0
    ds_read_b64_tr_b16 a[58:59], v23 offset:512
    ds_read_b64_tr_b16 a[60:61], v23 offset:4096
    ds_read_b64_tr_b16 a[62:63], v23 offset:4608
    ds_read_b64_tr_b16 a[64:65], v23 offset:8192
    ds_read_b64_tr_b16 a[66:67], v23 offset:8704
    ds_read_b64_tr_b16 a[68:69], v23 offset:12288
    ds_read_b64_tr_b16 a[70:71], v23 offset:12800
    ds_read_b64_tr_b16 a[72:73], v23 offset:16384
    ds_read_b64_tr_b16 a[74:75], v23 offset:16896
    ds_read_b64_tr_b16 a[76:77], v23 offset:20480
    ds_read_b64_tr_b16 a[78:79], v23 offset:20992
    s_waitcnt vmcnt(0)
    v_cmp_eq_u32 s[98:99], s6, v145
    s_nop 1
    v_cndmask_b32 v144, 0, v144, s[98:99]
    s_nop 1
    v_max_u32_dpp v144, v144, v144 quad_perm:[1,0,3,2] row_mask:0xf bank_mask:0xf
    s_nop 1
    v_max_u32_dpp v144, v144, v144 quad_perm:[2,3,0,1] row_mask:0xf bank_mask:0xf
    s_nop 1
    v_max_u32_dpp v144, v144, v144 row_ror:4 row_mask:0xf bank_mask:0xf
    s_nop 1
    v_max_u32_dpp v144, v144, v144 row_ror:8 row_mask:0xf bank_mask:0xf
    s_nop 0
    v_readlane_b32 s60, v144, 0
    v_readlane_b32 s55, v144, 16
    s_nop 0
    s_max_u32 s60, s60, s55
    s_and_b32 s61, s60, 0x7ff
    s_lshr_b32 s62, s61, 5
    s_lshl_b32 s62, s62, 1
    s_and_b32 s55, s61, 1
    s_add_u32 s62, s62, s55
    s_mul_i32 s62, s62, 1280
    s_add_u32 s63, s58, s62
    s_mov_b32 exec_hi, 0
    buffer_load_dwordx2 v[144:145], v4, s[24:27], s52 offen sc1
    s_mov_b32 exec_hi, -1
    buffer_load_dwordx4 v[44:47], v5, s[24:27], s63 offen sc1
    buffer_load_dwordx4 v[48:51], v5, s[24:27], s63 offen offset:64 sc1
    buffer_load_dwordx4 v[52:55], v6, s[24:27], s63 offen offset:128 sc1
    s_branch L_ki_32
L_k_30:
    s_nop 0
    s_and_b32 s61, s60, 0x7ff
    s_lshr_b32 s62, s61, 5
    s_lshl_b32 s62, s62, 1
    s_and_b32 s55, s61, 1
    s_add_u32 s62, s62, s55
    s_mul_i32 s62, s62, 1280
    s_add_u32 s63, s58, s62
    s_mov_b32 exec_hi, 0
    buffer_load_dwordx2 v[144:145], v4, s[24:27], s52 offen sc1
    s_mov_b32 exec_hi, -1
    buffer_load_dwordx4 v[44:47], v5, s[24:27], s63 offen sc1
    buffer_load_dwordx4 v[48:51], v5, s[24:27], s63 offen offset:64 sc1
    buffer_load_dwordx4 v[52:55], v6, s[24:27], s63 offen offset:128 sc1
    s_add_u32 s90, s90, 1
L_ki_32:
    s_waitcnt vmcnt(0)
    v_max3_u32 v9, v44, v48, v52
    v_cmp_ne_u32 s[98:99], s6, v145
    v_cmp_lt_u32 s[56:57], s60, v144
    s_nop 0
    s_or_b64 s[98:99], s[98:99], s[56:57]
    v_cmp_eq_u32 vcc, -1, v9
    s_nop 0
    s_or_b64 vcc, vcc, s[98:99]
    s_cbranch_vccz L_kd_31
    v_cmp_eq_u32 s[98:99], s6, v145
    s_nop 1
    v_cndmask_b32 v144, 0, v144, s[98:99]
    s_nop 1
    v_max_u32_dpp v144, v144, v144 quad_perm:[1,0,3,2] row_mask:0xf bank_mask:0xf
    s_nop 1
    v_max_u32_dpp v144, v144, v144 quad_perm:[2,3,0,1] row_mask:0xf bank_mask:0xf
    s_nop 1
    v_max_u32_dpp v144, v144, v144 row_ror:4 row_mask:0xf bank_mask:0xf
    s_nop 1
    v_max_u32_dpp v144, v144, v144 row_ror:8 row_mask:0xf bank_mask:0xf
    s_nop 0
    v_readlane_b32 s60, v144, 0
    v_readlane_b32 s55, v144, 16
    s_nop 0
    s_max_u32 s60, s60, s55
    s_cmp_lt_u32 s90, 40000
    s_cbranch_scc1 L_k_30
L_kd_31:
    s_waitcnt lgkmcnt(10)
    v_mfma_f32_16x16x32_bf16 v[60:63], v[44:47], a[56:59], 0
    s_waitcnt lgkmcnt(4)
    v_mfma_f32_16x16x32_bf16 v[64:67], v[44:47], a[68:71], 0
    v_mfma_f32_16x16x32_bf16 v[60:63], v[48:51], a[60:63], v[60:63]
    s_waitcnt lgkmcnt(2)
    v_mfma_f32_16x16x32_bf16 v[64:67], v[48:51], a[72:75], v[64:67]
    v_mfma_f32_16x16x32_bf16 v[60:63], v[52:55], a[64:67], v[60:63]
    s_waitcnt lgkmcnt(0)
    v_mfma_f32_16x16x32_bf16 v[64:67], v[52:55], a[76:79], v[64:67]
    s_mov_b64 exec, 0xffff
    s_nop 4
    v_mov_b32 v56, v60
    s_nop 0
    v_mov_b32 v57, v64
    s_cmp_eq_u32 s88, 0
    s_cbranch_scc1 L_gs_33
    buffer_store_dwordx4 v[56:59], v2, s[24:27], s65 offen
    s_branch L_ge_34
L_gs_33:
    buffer_store_dwordx4 v[56:59], v2, s[24:27], s65 offen sc0 sc1
L_ge_34:
    s_nop 1
    s_mov_b64 exec, -1
    s_barrier
    ds_read_b64_tr_b16 a[80:81], v22 offset:24576
    ds_read_b64_tr_b16 a[82:83], v22 offset:25216
    ds_read_b64_tr_b16 a[84:85], v22 offset:29696
    ds_read_b64_tr_b16 a[86:87], v22 offset:30336
    ds_read_b64_tr_b16 a[88:89], v21 offset:24704
    ds_read_b64_tr_b16 a[90:91], v21 offset:25344
    ds_read_b64_tr_b16 a[92:93], v21 offset:29824
    ds_read_b64_tr_b16 a[94:95], v21 offset:30464
    s_mul_i32 s66, s94, 20480
    s_lshl_b32 s67, s95, 7
    s_add_u32 s66, s66, s67
    s_add_u32 s66, s66, 0x6c0000
    s_lshl_b32 s67, s3, 12
    s_add_u32 s67, s67, s66
    s_add_u32 s66, s66, 16384
    v_lshlrev_b32 v3, 3, v14
    s_mov_b32 s90, 0
L_poll_35:
    s_nop 1
    buffer_load_dwordx4 v[44:47], v2, s[24:27], s64 offen sc1
    buffer_load_dwordx4 v[48:51], v2, s[24:27], s64 offen offset:1024 sc1
    s_waitcnt vmcnt(0)
    v_xor_b32 v9, s6, v46
    v_bitop3_b32 v9, v9, v50, s6 bitop3:0xf6
    v_cmp_ne_u32 vcc, 0, v9
    s_nop 0
    s_cbranch_vccz L_done_36
    s_add_u32 s90, s90, 1
    s_cmp_lt_u32 s90, 40000
    s_cbranch_scc1 L_poll_35
L_done_36:
    s_nop 1
    v_pk_add_f32 v[44:45], v[44:45], v[48:49]
    ds_write_b64 v7, v[44:45]
    s_waitcnt lgkmcnt(0)
    s_barrier
    ds_read_b64 v[44:45], v8 offset:0
    ds_read_b64 v[46:47], v8 offset:512
    ds_read_b64 v[48:49], v8 offset:1024
    ds_read_b64 v[50:51], v8 offset:1536
    s_waitcnt lgkmcnt(2)
    v_pk_add_f32 v[44:45], v[44:45], v[46:47]
    s_waitcnt lgkmcnt(0)
    v_pk_add_f32 v[48:49], v[48:49], v[50:51]
    v_pk_add_f32 v[44:45], v[44:45], v[48:49]
    v_mul_f32 v48, 0xbfb8aa3b, v44
    v_exp_f32 v48, v48
    v_mul_f32 v44, v44, v45
    v_add_f32 v48, 1.0, v48
    v_rcp_f32 v48, v48
    s_nop 0
    v_mul_f32 v48, v48, v44
    v_cvt_pk_bf16_f32 v48, v48, v48
    ds_write_b16 v12, v48
    ds_read_b128 v[44:47], v13
    ds_read_b128 v[48:51], v13 offset:64
    s_waitcnt lgkmcnt(1)
    v_mfma_f32_16x16x32_bf16 v[60:63], v[44:47], a[80:83], 0
    v_mfma_f32_16x16x32_bf16 v[64:67], v[44:47], a[88:91], 0
    s_waitcnt lgkmcnt(0)
    v_mfma_f32_16x16x32_bf16 v[60:63], v[48:51], a[84:87], v[60:63]
    v_mfma_f32_16x16x32_bf16 v[64:67], v[48:51], a[92:95], v[64:67]
    s_mov_b64 exec, 0xffff
    s_nop 5
    v_mov_b32 v61, s6
    buffer_store_dwordx2 v[60:61], v3, s[24:27], s67 offen sc0 sc1
    s_cmp_lg_u32 s3, 0
    s_cbranch_scc1 L_skip_37
    v_mov_b32 v65, s6
    buffer_store_dwordx2 v[64:65], v3, s[24:27], s66 offen sc0 sc1
    s_cmp_lg_u32 s93, 0
    s_cbranch_scc1 L_skip_38
    s_mov_b64 exec, 1
    buffer_store_dword v61, off, s[24:27], 0 sc0 sc1
L_skip_38:
    s_nop 1
L_skip_37:
    s_nop 1
    s_mov_b64 exec, -1
    v_cmp_ne_u32 vcc, s61, v35
    s_nop 0
    s_mov_b64 exec, vcc
    buffer_store_dwordx2 v[206:207], v30, s[28:31], 0 offen offset:0
    buffer_store_dwordx2 v[208:209], v30, s[28:31], 0 offen offset:32
    buffer_store_dwordx2 v[210:211], v30, s[28:31], 0 offen offset:64
    buffer_store_dwordx2 v[212:213], v30, s[28:31], 0 offen offset:96
    buffer_store_dwordx2 v[214:215], v30, s[28:31], 0 offen offset:128
    s_mov_b64 exec, -1
    s_branch L_fin_29
L_F_28:
    s_nop 0
    s_sub_u32 s58, s93, 216
    v_and_b32 v8, 7, v1
    s_lshl_b32 s54, s58, 5
    v_lshl_add_u32 v5, v8, 2, s54
    s_lshl_b32 s55, s58, 4
    s_add_u32 s55, s55, 3200
    v_lshl_add_u32 v6, v8, 1, s55
    v_lshrrev_b32 v7, 6, v6
    v_and_b32 v6, 63, v6
    v_lshlrev_b32 v6, 3, v6
    v_lshl_add_u32 v6, v7, 11, v6
    s_mov_b32 s90, 0
L_poll_39:
    s_nop 1
    s_mov_b32 exec_hi, 0
    buffer_load_dwordx2 v[144:145], v4, s[24:27], s52 offen sc1
    s_mov_b32 exec_hi, -1
    buffer_load_dwordx4 v[104:107], v6, s[24:27], s70 offen offset:0 sc1
    buffer_load_dwordx4 v[108:111], v6, s[24:27], s70 offen offset:512 sc1
    buffer_load_dwordx4 v[112:115], v6, s[24:27], s70 offen offset:1024 sc1
    buffer_load_dwordx4 v[116:119], v6, s[24:27], s70 offen offset:1536 sc1
    s_waitcnt vmcnt(0)
    v_xor_b32 v9, s6, v145
    v_bitop3_b32 v9, v9, v105, s6 bitop3:0xf6
    v_bitop3_b32 v9, v9, v107, s6 bitop3:0xf6
    v_bitop3_b32 v9, v9, v109, s6 bitop3:0xf6
    v_bitop3_b32 v9, v9, v111, s6 bitop3:0xf6
    v_bitop3_b32 v9, v9, v113, s6 bitop3:0xf6
    v_bitop3_b32 v9, v9, v115, s6 bitop3:0xf6
    v_bitop3_b32 v9, v9, v117, s6 bitop3:0xf6
    v_bitop3_b32 v9, v9, v119, s6 bitop3:0xf6
    v_cmp_ne_u32 vcc, 0, v9
    s_nop 0
    s_cbranch_vccz L_done_40
    s_add_u32 s90, s90, 1
    s_cmp_lt_u32 s90, 40000
    s_cbranch_scc1 L_poll_39
L_done_40:
    s_nop 1
    v_cmp_eq_u32 s[98:99], s6, v145
    s_nop 1
    v_cndmask_b32 v144, 0, v144, s[98:99]
    s_nop 1
    v_max_u32_dpp v144, v144, v144 quad_perm:[1,0,3,2] row_mask:0xf bank_mask:0xf
    s_nop 1
    v_max_u32_dpp v144, v144, v144 quad_perm:[2,3,0,1] row_mask:0xf bank_mask:0xf
    s_nop 1
    v_max_u32_dpp v144, v144, v144 row_ror:4 row_mask:0xf bank_mask:0xf
    s_nop 1
    v_max_u32_dpp v144, v144, v144 row_ror:8 row_mask:0xf bank_mask:0xf
    s_nop 0
    v_readlane_b32 s60, v144, 0
    v_readlane_b32 s55, v144, 16
    s_nop 0
    s_max_u32 s60, s60, s55
    s_and_b32 s61, s60, 0x7ff
    s_lshr_b32 s62, s61, 5
    s_lshl_b32 s62, s62, 1
    s_and_b32 s55, s61, 1
    s_add_u32 s62, s62, s55
    s_mul_i32 s62, s62, 1280
    v_cmp_ne_u32 vcc, s61, v35
    s_nop 0
    s_mov_b64 exec, vcc
    buffer_store_dwordx2 v[206:207], v30, s[28:31], 0 offen offset:0
    buffer_store_dwordx2 v[208:209], v30, s[28:31], 0 offen offset:32
    buffer_store_dwordx2 v[210:211], v30, s[28:31], 0 offen offset:64
    buffer_store_dwordx2 v[212:213], v30, s[28:31], 0 offen offset:96
    buffer_store_dwordx2 v[214:215], v30, s[28:31], 0 offen offset:128
    s_mov_b64 exec, -1
    s_cmp_lg_u32 s3, 0
    s_cbranch_scc1 L_fin_29
    s_add_u32 s63, s62, 0x90000
    v_add_f32 v104, v104, v108
    v_add_f32 v112, v112, v116
    v_add_f32 v106, v106, v110
    v_add_f32 v114, v114, v118
    v_add_f32 v104, v104, v112
    v_add_f32 v106, v106, v114
    v_cvt_pk_bf16_f32 v102, v104, v106
    v_lshlrev_b32 v108, 16, v102
    v_and_b32 v109, s84, v102
    s_andn2_b32 s64, s60, 0x7ff
    s_ashr_i32 s65, s64, 31
    s_not_b32 s65, s65
    s_or_b32 s65, s65, 0x80000000
    s_xor_b32 s64, s64, s65
    v_mov_b32 v110, s64
    v_mul_f32 v110, 0xbfb8aa3b, v110
    v_exp_f32 v110, v110
    s_nop 0
    v_add_f32 v110, 1.0, v110
    v_rcp_f32 v110, v110
    s_nop 0
    v_pk_mul_f32 v[108:109], v[108:109], v[110:111] op_sel_hi:[1,0]
    s_lshl_b32 s55, s58, 12
    s_add_u32 s55, s55, 0x6c0000
    v_min_u32 v7, 368, v2
    v_cmp_gt_u32 s[56:57], 24, v1
    s_mul_i32 s61, s61, 1280
    s_mov_b32 s90, 0
L_poll_41:
    s_nop 1
    buffer_load_dword v101, v5, s[24:27], s63 offen sc1
    s_waitcnt vmcnt(0)
    v_cmp_eq_u32 vcc, -1, v101
    s_nop 0
    s_cbranch_vccz L_done_42
    s_add_u32 s90, s90, 1
    s_cmp_lt_u32 s90, 40000
    s_cbranch_scc1 L_poll_41
L_done_42:
    s_nop 1
    v_lshlrev_b32 v106, 16, v101
    v_and_b32 v107, s84, v101
    s_mov_b32 s90, 0
L_poll_43:
    s_nop 1
    buffer_load_dwordx4 v[44:47], v2, s[24:27], s55 offen offset:0 sc1
    buffer_load_dwordx4 v[48:51], v2, s[24:27], s55 offen offset:1024 sc1
    buffer_load_dwordx4 v[52:55], v2, s[24:27], s55 offen offset:2048 sc1
    buffer_load_dwordx4 v[56:59], v7, s[24:27], s55 offen offset:3072 sc1
    s_waitcnt vmcnt(0)
    v_xor_b32 v9, s6, v45
    v_bitop3_b32 v9, v9, v47, s6 bitop3:0xf6
    v_bitop3_b32 v9, v9, v49, s6 bitop3:0xf6
    v_bitop3_b32 v9, v9, v51, s6 bitop3:0xf6
    v_bitop3_b32 v9, v9, v53, s6 bitop3:0xf6
    v_bitop3_b32 v9, v9, v55, s6 bitop3:0xf6
    v_bitop3_b32 v9, v9, v57, s6 bitop3:0xf6
    v_bitop3_b32 v9, v9, v59, s6 bitop3:0xf6
    v_cmp_ne_u32 vcc, 0, v9
    s_nop 0
    s_cbranch_vccz L_done_44
    s_add_u32 s90, s90, 1
    s_cmp_lt_u32 s90, 40000
    s_cbranch_scc1 L_poll_43
L_done_44:
    s_nop 1
    v_cndmask_b32 v56, 0, v56, s[56:57]
    v_cndmask_b32 v58, 0, v58, s[56:57]
    v_add_f32 v44, v44, v48
    v_add_f32 v52, v52, v56
    v_add_f32 v46, v46, v50
    v_add_f32 v54, v54, v58
    v_add_f32 v44, v44, v52
    v_add_f32 v45, v46, v54
    s_nop 0
    v_add_f32_dpp v44, v44, v44 row_ror:8 row_mask:0xf bank_mask:0xf
    v_add_f32_dpp v45, v45, v45 row_ror:8 row_mask:0xf bank_mask:0xf
    v_mov_b32 v46, v44
    v_mov_b32 v47, v45
    s_nop 0
    v_permlane16_swap_b32 v44, v46
    v_permlane16_swap_b32 v45, v47
    v_add_f32 v44, v44, v46
    v_add_f32 v45, v45, v47
    v_mov_b32 v46, v44
    v_mov_b32 v47, v45
    s_nop 0
    v_permlane32_swap_b32 v44, v46
    v_permlane32_swap_b32 v45, v47
    v_add_f32 v44, v44, v46
    v_add_f32 v45, v45, v47
    v_pk_fma_f32 v[44:45], v[44:45], v[108:109], v[106:107]
    v_cvt_pk_bf16_f32 v46, v44, v45
    s_mov_b64 exec, 0xff
    buffer_store_dword v46, v5, s[28:31], s61 offen
L_fin_29:
    s_nop 0
    s_endpgm
L_slow:
    s_nop 7
    v_add_u32 v2, s48, v14
    v_lshlrev_b32 v3, 4, v2
    v_subrev_u32 v2, 16, v2
    v_max_i32 v2, 0, v2
    v_lshlrev_b32 v4, 4, v2
    s_mov_b32 s90, 0
L_poll_45:
    s_nop 1
    buffer_load_dword v253, v13, s[24:27], s69 offen offset:12 sc1
    buffer_load_dwordx4 v[184:187], v4, s[24:27], s65 offen sc1
    buffer_load_dwordx4 v[188:191], v3, s[24:27], s65 offen offset:0 sc1
    buffer_load_dwordx4 v[192:195], v3, s[24:27], s65 offen offset:256 sc1
    buffer_load_dwordx4 v[196:199], v3, s[24:27], s65 offen offset:512 sc1
    buffer_load_dwordx4 v[200:203], v3, s[24:27], s65 offen offset:768 sc1
    buffer_load_dwordx4 v[204:207], v3, s[24:27], s65 offen offset:1024 sc1
    buffer_load_dwordx4 v[208:211], v3, s[24:27], s65 offen offset:1280 sc1
    buffer_load_dwordx4 v[212:215], v3, s[24:27], s65 offen offset:1536 sc1
    buffer_load_dwordx4 v[216:219], v3, s[24:27], s65 offen offset:1792 sc1
    s_waitcnt vmcnt(0)
    v_xor_b32 v2, s6, v187
    v_bitop3_b32 v2, v2, v191, s6 bitop3:0xf6
    v_bitop3_b32 v2, v2, v195, s6 bitop3:0xf6
    v_bitop3_b32 v2, v2, v199, s6 bitop3:0xf6
    v_bitop3_b32 v2, v2, v203, s6 bitop3:0xf6
    v_bitop3_b32 v2, v2, v207, s6 bitop3:0xf6
    v_bitop3_b32 v2, v2, v211, s6 bitop3:0xf6
    v_bitop3_b32 v2, v2, v215, s6 bitop3:0xf6
    v_bitop3_b32 v2, v2, v219, s6 bitop3:0xf6
    v_bitop3_b32 v2, v2, v253, s6 bitop3:0xf6
    v_cmp_ne_u32 vcc, 0, v2
    s_nop 0
    s_cbranch_vccz L_done_46
    s_add_u32 s90, s90, 1
    s_cmp_lt_u32 s90, 40000
    s_cbranch_scc1 L_poll_45
L_done_46:
    s_nop 1
    s_branch L_slow_back
L_exit:
    s_endpgm
L_code_end:
.section .rodata,"a"
.p2align 6
.amdhsa_kernel adaLN_cond__sliding_local_dilated__moe_arch_mod__prompt_kernel
  .amdhsa_next_free_vgpr 512
  .amdhsa_next_free_sgpr 102
  .amdhsa_accum_offset 256
  .amdhsa_group_segment_fixed_size 0
  .amdhsa_kernarg_size 104
  .amdhsa_user_sgpr_count 2
  .amdhsa_user_sgpr_kernarg_segment_ptr 1
  .amdhsa_system_sgpr_workgroup_id_x 1
.end_amdhsa_kernel
```
